```python
import torch

def _softmax(x, axis=-1):
    return torch.softmax(x, dim=axis)
def _gelu(x):
    return torch.nn.functional.gelu(x, approximate="tanh")
def _silu(x):
    return torch.nn.functional.silu(x)
def _sigmoid(x):
    return torch.sigmoid(x)
def _layernorm(x, axis=-1, eps=1e-5):
    m = x.mean(dim=axis, keepdim=True)
    v = x.var(dim=axis, keepdim=True, unbiased=False)
    return (x - m) / torch.sqrt(v + eps)
def _scatter_add(tgt, idx, src, axis=0):
    return tgt.clone().index_add_(axis, idx, src)
def _segment_sum(src, seg, n):
    out = torch.zeros((n,) + src.shape[1:], dtype=src.dtype)
    return out.index_add_(0, seg, src)
def _pad(x, pw):
    flat = tuple(v for pair in reversed(pw) for v in pair)
    return torch.nn.functional.pad(x, flat)

kernel_name = 'recurrent_scan__ssm_conv_s5__mixer_token_mlp__prompt'

def setup_inputs():

    _w = (lambda a: (lambda t: t.to(torch.bfloat16) if t.is_floating_point() else t)(torch.as_tensor(a)))
    def _A_setup():
        B, S, D = 1, 2048, 512
        P = D
        Lambda_re = -0.5 * (lambda _x: torch.exp(torch.as_tensor(_x)))((lambda *s: torch.randn(*s, dtype=torch.bfloat16) * 0.4)(P))
        Lambda_im = (lambda *s: torch.randn(*s, dtype=torch.bfloat16) * 0.4)(P) * 1.0
        B_re = (lambda *s: torch.randn(*s, dtype=torch.bfloat16) * 0.4)(P, D) * (D ** -0.5)
        B_im = (lambda *s: torch.randn(*s, dtype=torch.bfloat16) * 0.4)(P, D) * (D ** -0.5)
        C_re = (lambda *s: torch.randn(*s, dtype=torch.bfloat16) * 0.4)(D, P) * (P ** -0.5)
        C_im = (lambda *s: torch.randn(*s, dtype=torch.bfloat16) * 0.4)(D, P) * (P ** -0.5)
        log_dt = (lambda *s: torch.randn(*s, dtype=torch.bfloat16) * 0.4)(P) * 0.3 - 2.0
        Dskip = (lambda *s: torch.randn(*s, dtype=torch.bfloat16) * 0.2)(D)
        return {
            "x": _w((lambda *s: torch.randn(*s, dtype=torch.bfloat16) * 0.05)(B, S, D)),
            "Lambda_re": _w(Lambda_re),
            "Lambda_im": _w(Lambda_im),
            "B_re": _w(B_re),
            "B_im": _w(B_im),
            "C_re": _w(C_re),
            "C_im": _w(C_im),
            "log_dt": _w(log_dt),
            "Dskip": _w(Dskip),
        }
    _A_in = _A_setup()

    def _B_setup():
        B, S, D, F = 1, 2048, 512, 1792
        return {
            "x": _w((lambda *s: torch.randn(*s, dtype=torch.bfloat16) * 0.05)(B, S, D)),
            "w1": _w((lambda *s: torch.randn(*s, dtype=torch.bfloat16) * 0.4)(S, F) * (S ** -0.5)),
            "b1": _w((lambda *s: torch.randn(*s, dtype=torch.bfloat16) * 3.2)(F) * 0.02),
            "w2": _w((lambda *s: torch.randn(*s, dtype=torch.bfloat16) * 0.4)(F, S) * (F ** -0.5)),
            "b2": _w((lambda *s: torch.randn(*s, dtype=torch.bfloat16) * 0.8)(S) * 0.02),
        }
    _B_in = _B_setup()

    return {
        "A_x": _A_in["x"],
        "A_Lambda_re": _A_in["Lambda_re"],
        "A_Lambda_im": _A_in["Lambda_im"],
        "A_B_re": _A_in["B_re"],
        "A_B_im": _A_in["B_im"],
        "A_C_re": _A_in["C_re"],
        "A_C_im": _A_in["C_im"],
        "A_log_dt": _A_in["log_dt"],
        "A_Dskip": _A_in["Dskip"],
        "B_x": _B_in["x"],
        "B_w1": _B_in["w1"],
        "B_b1": _B_in["b1"],
        "B_w2": _B_in["w2"],
        "B_b2": _B_in["b2"],
    }

def reference(A_x, A_Lambda_re, A_Lambda_im, A_B_re, A_B_im, A_C_re, A_C_im, A_log_dt, A_Dskip, B_x, B_w1, B_b1, B_w2, B_b2):
    def _A_ref(x, Lambda_re, Lambda_im, B_re, B_im, C_re, C_im, log_dt, Dskip):
        Bsz, L, H = x.shape
        Lam = Lambda_re + 1j * Lambda_im
        Bmat = B_re + 1j * B_im
        Cmat = C_re + 1j * C_im
        dt = torch.exp(log_dt)
        Lam_bar = torch.exp(dt * Lam)
        B_bar = ((Lam_bar - 1.0) / Lam)[:, None] * Bmat
        Bu = torch.einsum("bld,pd->blp", x + 0j, B_bar)
        h = torch.zeros_like(Bu[:, 0, :])
        hs = []
        for t in range(L):
            h = Lam_bar[None, :] * h + Bu[:, t, :]
            hs.append(h)
        hseq = torch.stack(hs, 1)
        y = 2.0 * torch.einsum("blp,dp->bld", hseq, Cmat).real + x * Dskip[None, None, :]
        return y

    def _B_ref(x, w1, b1, w2, b2):
        B, S, D = x.shape
        h = _layernorm(x, axis=-1)
        u = torch.einsum("bsd,sf->bdf", h, w1) + b1
        u = _gelu(u)
        y = torch.einsum("bdf,fs->bds", u, w2) + b2
        return (lambda x, *d: x.permute(*d))(y, 0, 2, 1)

    x = A_x
    xn = _layernorm(x, axis=-1)
    s = _A_ref(xn, A_Lambda_re, A_Lambda_im, A_B_re, A_B_im, A_C_re, A_C_im, A_log_dt, A_Dskip)
    g = _silu(_B_ref(xn, B_w1, B_b1, B_w2, B_b2))
    return x + s * g
```

```asm
; @launch kernel=k1_kernel grid=(256,1,1) block=(256,1,1) lds=131072
; @launch kernel=k2_kernel grid=(256,1,1) block=(256,1,1) lds=131072
; @launch kernel=k3_kernel grid=(256,1,1) block=(256,1,1) lds=131072
.amdgcn_target "amdgcn-amd-amdhsa--gfx950"
.text
.globl k1_kernel
.p2align 8
.type k1_kernel,@function
k1_kernel:
    s_cmp_ge_u32 s2, 256
    s_cbranch_scc1 k1_end
    s_load_dwordx2 s[24:25], s[0:1], 0
    s_load_dwordx4 s[68:71], s[0:1], 8
    s_load_dwordx4 s[72:75], s[0:1], 24
    s_load_dwordx2 s[76:77], s[0:1], 56
    s_load_dwordx2 s[28:29], s[0:1], 128
    s_and_b32 s30, s2, 7
    s_lshr_b32 s31, s2, 3
    s_lshr_b32 s32, s31, 3
    s_lshl_b32 s33, s30, 2
    s_add_u32 s33, s33, s32
    s_and_b32 s34, s31, 7
    v_and_b32 v1, 63, v0
    v_lshrrev_b32 v2, 6, v0
    s_nop 0
    v_readfirstlane_b32 s40, v2
    s_and_b32 s41, s40, 1
    s_lshr_b32 s42, s40, 1
    s_waitcnt lgkmcnt(0)
    s_mov_b32 s4, s24
    s_mov_b32 s5, s25
    s_and_b32 s5, s5, 0xffff
    s_mov_b32 s6, 2097152
    s_mov_b32 s7, 0x00020000
    s_mov_b32 s8, s72
    s_mov_b32 s9, s73
    s_and_b32 s9, s9, 0xffff
    s_mov_b32 s10, 524288
    s_mov_b32 s11, 0x00020000
    s_mov_b32 s12, s74
    s_mov_b32 s13, s75
    s_and_b32 s13, s13, 0xffff
    s_mov_b32 s14, 524288
    s_mov_b32 s15, 0x00020000
    s_mov_b32 s16, s28
    s_mov_b32 s17, s29
    s_and_b32 s17, s17, 0xffff
    s_mov_b32 s18, 2097152
    s_mov_b32 s19, 0x00020000
    s_add_u32 s20, s28, 2097152
    s_addc_u32 s21, s29, 0
    s_and_b32 s21, s21, 0xffff
    s_mov_b32 s22, 2097152
    s_mov_b32 s23, 0x00020000
    s_add_u32 s48, s28, 4194304
    s_addc_u32 s49, s29, 0
    s_and_b32 s49, s49, 0xffff
    s_mov_b32 s50, 8388608
    s_mov_b32 s51, 0x00020000
    s_add_u32 s52, s28, 12582912
    s_addc_u32 s53, s29, 0
    s_and_b32 s53, s53, 0xffff
    s_mov_b32 s54, 131072
    s_mov_b32 s55, 0x00020000
    s_mov_b32 s56, s68
    s_mov_b32 s57, s69
    s_and_b32 s57, s57, 0xffff
    s_mov_b32 s58, 1024
    s_mov_b32 s59, 0x00020000
    s_mov_b32 s60, s70
    s_mov_b32 s61, s71
    s_and_b32 s61, s61, 0xffff
    s_mov_b32 s62, 1024
    s_mov_b32 s63, 0x00020000
    s_mov_b32 s64, s76
    s_mov_b32 s65, s77
    s_and_b32 s65, s65, 0xffff
    s_mov_b32 s66, 1024
    s_mov_b32 s67, 0x00020000
    s_add_u32 s80, s34, 0
    s_and_b32 s80, s80, 7
    s_lshl_b32 s88, s80, 13
    s_lshl_b32 s80, s80, 7
    s_add_u32 s81, s34, 1
    s_and_b32 s81, s81, 7
    s_lshl_b32 s89, s81, 13
    s_lshl_b32 s81, s81, 7
    s_add_u32 s82, s34, 2
    s_and_b32 s82, s82, 7
    s_lshl_b32 s90, s82, 13
    s_lshl_b32 s82, s82, 7
    s_add_u32 s83, s34, 3
    s_and_b32 s83, s83, 7
    s_lshl_b32 s91, s83, 13
    s_lshl_b32 s83, s83, 7
    s_add_u32 s84, s34, 4
    s_and_b32 s84, s84, 7
    s_lshl_b32 s92, s84, 13
    s_lshl_b32 s84, s84, 7
    s_add_u32 s85, s34, 5
    s_and_b32 s85, s85, 7
    s_lshl_b32 s93, s85, 13
    s_lshl_b32 s85, s85, 7
    s_add_u32 s86, s34, 6
    s_and_b32 s86, s86, 7
    s_lshl_b32 s94, s86, 13
    s_lshl_b32 s86, s86, 7
    s_add_u32 s87, s34, 7
    s_and_b32 s87, s87, 7
    s_lshl_b32 s95, s87, 13
    s_lshl_b32 s87, s87, 7
    v_lshrrev_b32 v2, 3, v1
    v_and_b32 v3, 7, v1
    s_lshl_b32 s43, s40, 4
    s_add_u32 s43, s43, 0
    v_add_u32 v4, s43, v2
    s_lshl_b32 s43, s33, 6
    v_add_u32 v5, s43, v4
    v_lshlrev_b32 v5, 10, v5
    v_lshlrev_b32 v6, 4, v3
    v_add_u32 v10, v5, v6
    v_lshrrev_b32 v5, 1, v4
    v_and_b32 v5, 7, v5
    v_xor_b32 v5, v5, v3
    v_lshlrev_b32 v5, 4, v5
    v_lshlrev_b32 v6, 7, v4
    v_add_u32 v12, v5, v6
    s_lshl_b32 s43, s40, 4
    s_add_u32 s43, s43, 8
    v_add_u32 v4, s43, v2
    s_lshl_b32 s43, s33, 6
    v_add_u32 v5, s43, v4
    v_lshlrev_b32 v5, 10, v5
    v_lshlrev_b32 v6, 4, v3
    v_add_u32 v11, v5, v6
    v_lshrrev_b32 v5, 1, v4
    v_and_b32 v5, 7, v5
    v_xor_b32 v5, v5, v3
    v_lshlrev_b32 v5, 4, v5
    v_lshlrev_b32 v6, 7, v4
    v_add_u32 v13, v5, v6
    buffer_load_dwordx4 v[64:67], v10, s[4:7], s80 offen
    buffer_load_dwordx4 v[68:71], v10, s[4:7], s81 offen
    buffer_load_dwordx4 v[72:75], v10, s[4:7], s82 offen
    buffer_load_dwordx4 v[76:79], v10, s[4:7], s83 offen
    buffer_load_dwordx4 v[80:83], v10, s[4:7], s84 offen
    buffer_load_dwordx4 v[84:87], v10, s[4:7], s85 offen
    buffer_load_dwordx4 v[88:91], v10, s[4:7], s86 offen
    buffer_load_dwordx4 v[92:95], v10, s[4:7], s87 offen
    buffer_load_dwordx4 v[96:99], v11, s[4:7], s80 offen
    buffer_load_dwordx4 v[100:103], v11, s[4:7], s81 offen
    buffer_load_dwordx4 v[104:107], v11, s[4:7], s82 offen
    buffer_load_dwordx4 v[108:111], v11, s[4:7], s83 offen
    buffer_load_dwordx4 v[112:115], v11, s[4:7], s84 offen
    buffer_load_dwordx4 v[116:119], v11, s[4:7], s85 offen
    buffer_load_dwordx4 v[120:123], v11, s[4:7], s86 offen
    buffer_load_dwordx4 v[124:127], v11, s[4:7], s87 offen
    s_lshl_b32 s45, s34, 16
    v_lshrrev_b32 v2, 3, v1
    s_lshl_b32 s43, s40, 4
    v_add_u32 v2, s43, v2
    v_and_b32 v3, 7, v1
    v_lshrrev_b32 v4, 1, v2
    v_and_b32 v4, 7, v4
    v_xor_b32 v3, v3, v4
    v_lshlrev_b32 v3, 4, v3
    s_mov_b32 s43, 1024
    v_mul_lo_u32 v2, v2, s43
    v_add_u32 v14, v2, v3
    v_add_u32 v14, s45, v14
    v_lshrrev_b32 v2, 3, v1
    s_lshl_b32 s43, s40, 4
    s_add_u32 s43, s43, 8
    v_add_u32 v2, s43, v2
    v_and_b32 v3, 7, v1
    v_lshrrev_b32 v4, 1, v2
    v_and_b32 v4, 7, v4
    v_xor_b32 v3, v3, v4
    v_lshlrev_b32 v3, 4, v3
    s_mov_b32 s43, 1024
    v_mul_lo_u32 v2, v2, s43
    v_add_u32 v15, v2, v3
    v_add_u32 v15, s45, v15
    s_lshl_b32 s44, s40, 11
    s_mov_b32 s79, 0
    s_add_u32 m0, s44, 65536
    s_nop 0
    buffer_load_dwordx4 v14, s[8:11], s79 offen lds
    s_add_u32 m0, s44, 66560
    s_nop 0
    buffer_load_dwordx4 v15, s[8:11], s79 offen lds
    s_add_u32 m0, s44, 73728
    s_nop 0
    buffer_load_dwordx4 v14, s[12:15], s79 offen lds
    s_add_u32 m0, s44, 74752
    s_nop 0
    buffer_load_dwordx4 v15, s[12:15], s79 offen lds
    s_mov_b32 s79, 128
    s_add_u32 m0, s44, 81920
    s_nop 0
    buffer_load_dwordx4 v14, s[8:11], s79 offen lds
    s_add_u32 m0, s44, 82944
    s_nop 0
    buffer_load_dwordx4 v15, s[8:11], s79 offen lds
    s_add_u32 m0, s44, 90112
    s_nop 0
    buffer_load_dwordx4 v14, s[12:15], s79 offen lds
    s_add_u32 m0, s44, 91136
    s_nop 0
    buffer_load_dwordx4 v15, s[12:15], s79 offen lds
    s_mov_b32 s79, 256
    s_add_u32 m0, s44, 98304
    s_nop 0
    buffer_load_dwordx4 v14, s[8:11], s79 offen lds
    s_add_u32 m0, s44, 99328
    s_nop 0
    buffer_load_dwordx4 v15, s[8:11], s79 offen lds
    s_add_u32 m0, s44, 106496
    s_nop 0
    buffer_load_dwordx4 v14, s[12:15], s79 offen lds
    s_add_u32 m0, s44, 107520
    s_nop 0
    buffer_load_dwordx4 v15, s[12:15], s79 offen lds
    s_mov_b32 s79, 384
    s_add_u32 m0, s44, 114688
    s_nop 0
    buffer_load_dwordx4 v14, s[8:11], s79 offen lds
    s_add_u32 m0, s44, 115712
    s_nop 0
    buffer_load_dwordx4 v15, s[8:11], s79 offen lds
    s_add_u32 m0, s44, 122880
    s_nop 0
    buffer_load_dwordx4 v14, s[12:15], s79 offen lds
    s_add_u32 m0, s44, 123904
    s_nop 0
    buffer_load_dwordx4 v15, s[12:15], s79 offen lds
    v_and_b32 v2, 31, v1
    s_lshl_b32 s43, s41, 5
    v_add_u32 v2, s43, v2
    v_lshrrev_b32 v3, 1, v2
    v_and_b32 v3, 7, v3
    v_lshlrev_b32 v2, 7, v2
    v_lshrrev_b32 v4, 5, v1
    v_add_u32 v16, 0, v4
    v_xor_b32 v16, v16, v3
    v_lshlrev_b32 v16, 4, v16
    v_add_u32 v16, v16, v2
    v_add_u32 v20, 0x10000, v16
    v_add_u32 v17, 2, v4
    v_xor_b32 v17, v17, v3
    v_lshlrev_b32 v17, 4, v17
    v_add_u32 v17, v17, v2
    v_add_u32 v21, 0x10000, v17
    v_add_u32 v18, 4, v4
    v_xor_b32 v18, v18, v3
    v_lshlrev_b32 v18, 4, v18
    v_add_u32 v18, v18, v2
    v_add_u32 v22, 0x10000, v18
    v_add_u32 v19, 6, v4
    v_xor_b32 v19, v19, v3
    v_lshlrev_b32 v19, 4, v19
    v_add_u32 v19, v19, v2
    v_add_u32 v23, 0x10000, v19
    v_and_b32 v2, 31, v1
    s_lshl_b32 s43, s42, 5
    v_add_u32 v2, s43, v2
    v_lshrrev_b32 v3, 1, v2
    v_and_b32 v3, 7, v3
    v_lshlrev_b32 v2, 7, v2
    v_lshrrev_b32 v4, 5, v1
    v_add_u32 v24, 0, v4
    v_xor_b32 v24, v24, v3
    v_lshlrev_b32 v24, 4, v24
    v_add_u32 v24, v24, v2
    v_add_u32 v28, 0x10000, v24
    v_add_u32 v25, 2, v4
    v_xor_b32 v25, v25, v3
    v_lshlrev_b32 v25, 4, v25
    v_add_u32 v25, v25, v2
    v_add_u32 v29, 0x10000, v25
    v_add_u32 v26, 4, v4
    v_xor_b32 v26, v26, v3
    v_lshlrev_b32 v26, 4, v26
    v_add_u32 v26, v26, v2
    v_add_u32 v30, 0x10000, v26
    v_add_u32 v27, 6, v4
    v_xor_b32 v27, v27, v3
    v_lshlrev_b32 v27, 4, v27
    v_add_u32 v27, v27, v2
    v_add_u32 v31, 0x10000, v27
    s_load_dwordx2 s[96:97], s[0:1], 80
    s_lshl_b32 s43, s32, 3
    s_add_u32 s43, s43, s30
    s_min_u32 s43, s43, 27
    s_waitcnt lgkmcnt(0)
    s_mov_b32 s96, s96
    s_mov_b32 s97, s97
    s_and_b32 s97, s97, 0xffff
    s_mov_b32 s98, 7340032
    s_mov_b32 s99, 0x00020000
    s_lshl_b32 s45, s34, 8
    v_add_u32 v2, s45, v0
    s_mov_b32 s45, 3584
    v_mul_lo_u32 v2, v2, s45
    s_lshl_b32 s43, s43, 7
    v_add_u32 v2, s43, v2
    buffer_load_dwordx4 v[224:227], v2, s[96:99], 0 offen offset:0
    buffer_load_dwordx4 v[228:231], v2, s[96:99], 0 offen offset:16
    buffer_load_dwordx4 v[232:235], v2, s[96:99], 0 offen offset:32
    buffer_load_dwordx4 v[236:239], v2, s[96:99], 0 offen offset:48
    buffer_load_dwordx4 v[224:227], v2, s[96:99], 0 offen offset:64
    buffer_load_dwordx4 v[228:231], v2, s[96:99], 0 offen offset:80
    buffer_load_dwordx4 v[232:235], v2, s[96:99], 0 offen offset:96
    buffer_load_dwordx4 v[236:239], v2, s[96:99], 0 offen offset:112
    s_mov_b32 s46, 0x3f803f80
    s_mov_b32 s47, 989855744
    s_mov_b32 s96, 925353388
    s_waitcnt vmcnt(32)
    v_mov_b32 v2, 0
    v_mov_b32 v3, 0
    v_mov_b32 v4, 0
    v_mov_b32 v5, 0
    v_dot2_f32_bf16 v2, v64, s46, v2
    v_dot2_f32_bf16 v3, v65, s46, v3
    v_dot2_f32_bf16 v4, v66, s46, v4
    v_dot2_f32_bf16 v5, v67, s46, v5
    v_dot2_f32_bf16 v2, v68, s46, v2
    v_dot2_f32_bf16 v3, v69, s46, v3
    v_dot2_f32_bf16 v4, v70, s46, v4
    v_dot2_f32_bf16 v5, v71, s46, v5
    v_dot2_f32_bf16 v2, v72, s46, v2
    v_dot2_f32_bf16 v3, v73, s46, v3
    v_dot2_f32_bf16 v4, v74, s46, v4
    v_dot2_f32_bf16 v5, v75, s46, v5
    v_dot2_f32_bf16 v2, v76, s46, v2
    v_dot2_f32_bf16 v3, v77, s46, v3
    v_dot2_f32_bf16 v4, v78, s46, v4
    v_dot2_f32_bf16 v5, v79, s46, v5
    v_dot2_f32_bf16 v2, v80, s46, v2
    v_dot2_f32_bf16 v3, v81, s46, v3
    v_dot2_f32_bf16 v4, v82, s46, v4
    v_dot2_f32_bf16 v5, v83, s46, v5
    v_dot2_f32_bf16 v2, v84, s46, v2
    v_dot2_f32_bf16 v3, v85, s46, v3
    v_dot2_f32_bf16 v4, v86, s46, v4
    v_dot2_f32_bf16 v5, v87, s46, v5
    v_dot2_f32_bf16 v2, v88, s46, v2
    v_dot2_f32_bf16 v3, v89, s46, v3
    v_dot2_f32_bf16 v4, v90, s46, v4
    v_dot2_f32_bf16 v5, v91, s46, v5
    v_dot2_f32_bf16 v2, v92, s46, v2
    v_dot2_f32_bf16 v3, v93, s46, v3
    v_dot2_f32_bf16 v4, v94, s46, v4
    v_dot2_f32_bf16 v5, v95, s46, v5
    s_nop 2
    v_add_f32 v2, v2, v3
    v_add_f32 v4, v4, v5
    v_add_f32 v2, v2, v4
    s_nop 1
    v_add_f32_dpp v2, v2, v2 quad_perm:[1,0,3,2] row_mask:0xf bank_mask:0xf
    s_nop 1
    v_add_f32_dpp v2, v2, v2 quad_perm:[2,3,0,1] row_mask:0xf bank_mask:0xf
    s_nop 1
    v_add_f32_dpp v2, v2, v2 row_half_mirror row_mask:0xf bank_mask:0xf
    v_mul_f32 v2, s47, v2
    v_cvt_pk_bf16_f32 v3, v2, v2
    v_lshlrev_b32 v3, 16, v3
    v_sub_f32 v4, v2, v3
    v_sub_f32 v6, 0, v3
    v_sub_f32 v7, 0, v3
    v_mov_b32 v32, 0
    v_mov_b32 v33, 0
    v_mov_b32 v34, 0
    v_mov_b32 v35, 0
    v_mov_b32 v36, 0
    v_mov_b32 v37, 0
    v_mov_b32 v38, 0
    v_mov_b32 v39, 0
    v_lshlrev_b32 v128, 16, v64
    v_and_b32 v129, 0xffff0000, v64
    v_pk_add_f32 v[128:129], v[128:129], v[6:7]
    v_pk_fma_f32 v[32:33], v[128:129], v[128:129], v[32:33]
    v_lshlrev_b32 v130, 16, v65
    v_and_b32 v131, 0xffff0000, v65
    v_pk_add_f32 v[130:131], v[130:131], v[6:7]
    v_pk_fma_f32 v[34:35], v[130:131], v[130:131], v[34:35]
    v_lshlrev_b32 v132, 16, v66
    v_and_b32 v133, 0xffff0000, v66
    v_pk_add_f32 v[132:133], v[132:133], v[6:7]
    v_pk_fma_f32 v[36:37], v[132:133], v[132:133], v[36:37]
    v_lshlrev_b32 v134, 16, v67
    v_and_b32 v135, 0xffff0000, v67
    v_pk_add_f32 v[134:135], v[134:135], v[6:7]
    v_pk_fma_f32 v[38:39], v[134:135], v[134:135], v[38:39]
    v_lshlrev_b32 v136, 16, v68
    v_and_b32 v137, 0xffff0000, v68
    v_pk_add_f32 v[136:137], v[136:137], v[6:7]
    v_pk_fma_f32 v[32:33], v[136:137], v[136:137], v[32:33]
    v_lshlrev_b32 v138, 16, v69
    v_and_b32 v139, 0xffff0000, v69
    v_pk_add_f32 v[138:139], v[138:139], v[6:7]
    v_pk_fma_f32 v[34:35], v[138:139], v[138:139], v[34:35]
    v_lshlrev_b32 v140, 16, v70
    v_and_b32 v141, 0xffff0000, v70
    v_pk_add_f32 v[140:141], v[140:141], v[6:7]
    v_pk_fma_f32 v[36:37], v[140:141], v[140:141], v[36:37]
    v_lshlrev_b32 v142, 16, v71
    v_and_b32 v143, 0xffff0000, v71
    v_pk_add_f32 v[142:143], v[142:143], v[6:7]
    v_pk_fma_f32 v[38:39], v[142:143], v[142:143], v[38:39]
    v_lshlrev_b32 v144, 16, v72
    v_and_b32 v145, 0xffff0000, v72
    v_pk_add_f32 v[144:145], v[144:145], v[6:7]
    v_pk_fma_f32 v[32:33], v[144:145], v[144:145], v[32:33]
    v_lshlrev_b32 v146, 16, v73
    v_and_b32 v147, 0xffff0000, v73
    v_pk_add_f32 v[146:147], v[146:147], v[6:7]
    v_pk_fma_f32 v[34:35], v[146:147], v[146:147], v[34:35]
    v_lshlrev_b32 v148, 16, v74
    v_and_b32 v149, 0xffff0000, v74
    v_pk_add_f32 v[148:149], v[148:149], v[6:7]
    v_pk_fma_f32 v[36:37], v[148:149], v[148:149], v[36:37]
    v_lshlrev_b32 v150, 16, v75
    v_and_b32 v151, 0xffff0000, v75
    v_pk_add_f32 v[150:151], v[150:151], v[6:7]
    v_pk_fma_f32 v[38:39], v[150:151], v[150:151], v[38:39]
    v_lshlrev_b32 v152, 16, v76
    v_and_b32 v153, 0xffff0000, v76
    v_pk_add_f32 v[152:153], v[152:153], v[6:7]
    v_pk_fma_f32 v[32:33], v[152:153], v[152:153], v[32:33]
    v_lshlrev_b32 v154, 16, v77
    v_and_b32 v155, 0xffff0000, v77
    v_pk_add_f32 v[154:155], v[154:155], v[6:7]
    v_pk_fma_f32 v[34:35], v[154:155], v[154:155], v[34:35]
    v_lshlrev_b32 v156, 16, v78
    v_and_b32 v157, 0xffff0000, v78
    v_pk_add_f32 v[156:157], v[156:157], v[6:7]
    v_pk_fma_f32 v[36:37], v[156:157], v[156:157], v[36:37]
    v_lshlrev_b32 v158, 16, v79
    v_and_b32 v159, 0xffff0000, v79
    v_pk_add_f32 v[158:159], v[158:159], v[6:7]
    v_pk_fma_f32 v[38:39], v[158:159], v[158:159], v[38:39]
    v_lshlrev_b32 v160, 16, v80
    v_and_b32 v161, 0xffff0000, v80
    v_pk_add_f32 v[160:161], v[160:161], v[6:7]
    v_pk_fma_f32 v[32:33], v[160:161], v[160:161], v[32:33]
    v_lshlrev_b32 v162, 16, v81
    v_and_b32 v163, 0xffff0000, v81
    v_pk_add_f32 v[162:163], v[162:163], v[6:7]
    v_pk_fma_f32 v[34:35], v[162:163], v[162:163], v[34:35]
    v_lshlrev_b32 v164, 16, v82
    v_and_b32 v165, 0xffff0000, v82
    v_pk_add_f32 v[164:165], v[164:165], v[6:7]
    v_pk_fma_f32 v[36:37], v[164:165], v[164:165], v[36:37]
    v_lshlrev_b32 v166, 16, v83
    v_and_b32 v167, 0xffff0000, v83
    v_pk_add_f32 v[166:167], v[166:167], v[6:7]
    v_pk_fma_f32 v[38:39], v[166:167], v[166:167], v[38:39]
    v_lshlrev_b32 v168, 16, v84
    v_and_b32 v169, 0xffff0000, v84
    v_pk_add_f32 v[168:169], v[168:169], v[6:7]
    v_pk_fma_f32 v[32:33], v[168:169], v[168:169], v[32:33]
    v_lshlrev_b32 v170, 16, v85
    v_and_b32 v171, 0xffff0000, v85
    v_pk_add_f32 v[170:171], v[170:171], v[6:7]
    v_pk_fma_f32 v[34:35], v[170:171], v[170:171], v[34:35]
    v_lshlrev_b32 v172, 16, v86
    v_and_b32 v173, 0xffff0000, v86
    v_pk_add_f32 v[172:173], v[172:173], v[6:7]
    v_pk_fma_f32 v[36:37], v[172:173], v[172:173], v[36:37]
    v_lshlrev_b32 v174, 16, v87
    v_and_b32 v175, 0xffff0000, v87
    v_pk_add_f32 v[174:175], v[174:175], v[6:7]
    v_pk_fma_f32 v[38:39], v[174:175], v[174:175], v[38:39]
    v_lshlrev_b32 v176, 16, v88
    v_and_b32 v177, 0xffff0000, v88
    v_pk_add_f32 v[176:177], v[176:177], v[6:7]
    v_pk_fma_f32 v[32:33], v[176:177], v[176:177], v[32:33]
    v_lshlrev_b32 v178, 16, v89
    v_and_b32 v179, 0xffff0000, v89
    v_pk_add_f32 v[178:179], v[178:179], v[6:7]
    v_pk_fma_f32 v[34:35], v[178:179], v[178:179], v[34:35]
    v_lshlrev_b32 v180, 16, v90
    v_and_b32 v181, 0xffff0000, v90
    v_pk_add_f32 v[180:181], v[180:181], v[6:7]
    v_pk_fma_f32 v[36:37], v[180:181], v[180:181], v[36:37]
    v_lshlrev_b32 v182, 16, v91
    v_and_b32 v183, 0xffff0000, v91
    v_pk_add_f32 v[182:183], v[182:183], v[6:7]
    v_pk_fma_f32 v[38:39], v[182:183], v[182:183], v[38:39]
    v_lshlrev_b32 v184, 16, v92
    v_and_b32 v185, 0xffff0000, v92
    v_pk_add_f32 v[184:185], v[184:185], v[6:7]
    v_pk_fma_f32 v[32:33], v[184:185], v[184:185], v[32:33]
    v_lshlrev_b32 v186, 16, v93
    v_and_b32 v187, 0xffff0000, v93
    v_pk_add_f32 v[186:187], v[186:187], v[6:7]
    v_pk_fma_f32 v[34:35], v[186:187], v[186:187], v[34:35]
    v_lshlrev_b32 v188, 16, v94
    v_and_b32 v189, 0xffff0000, v94
    v_pk_add_f32 v[188:189], v[188:189], v[6:7]
    v_pk_fma_f32 v[36:37], v[188:189], v[188:189], v[36:37]
    v_lshlrev_b32 v190, 16, v95
    v_and_b32 v191, 0xffff0000, v95
    v_pk_add_f32 v[190:191], v[190:191], v[6:7]
    v_pk_fma_f32 v[38:39], v[190:191], v[190:191], v[38:39]
    v_pk_add_f32 v[32:33], v[32:33], v[34:35]
    v_pk_add_f32 v[36:37], v[36:37], v[38:39]
    v_pk_add_f32 v[32:33], v[32:33], v[36:37]
    v_add_f32 v5, v32, v33
    s_nop 1
    v_add_f32_dpp v5, v5, v5 quad_perm:[1,0,3,2] row_mask:0xf bank_mask:0xf
    s_nop 1
    v_add_f32_dpp v5, v5, v5 quad_perm:[2,3,0,1] row_mask:0xf bank_mask:0xf
    s_nop 1
    v_add_f32_dpp v5, v5, v5 row_half_mirror row_mask:0xf bank_mask:0xf
    v_mul_f32 v5, s47, v5
    v_fma_f32 v5, -v4, v4, v5
    v_cvt_pk_bf16_f32 v5, v5, v5
    v_lshlrev_b32 v5, 16, v5
    v_add_f32 v5, s96, v5
    v_cvt_pk_bf16_f32 v5, v5, v5
    v_lshlrev_b32 v5, 16, v5
    v_sqrt_f32 v5, v5
    s_nop 0
    v_cvt_pk_bf16_f32 v5, v5, v5
    v_lshlrev_b32 v5, 16, v5
    v_rcp_f32 v6, v5
    s_nop 0
    v_mov_b32 v7, v6
    v_cvt_pk_bf16_f32 v64, v128, v129
    v_lshlrev_b32 v128, 16, v64
    v_and_b32 v129, 0xffff0000, v64
    v_pk_mul_f32 v[128:129], v[128:129], v[6:7]
    v_cvt_pk_bf16_f32 v64, v128, v129
    v_cvt_pk_bf16_f32 v65, v130, v131
    v_lshlrev_b32 v130, 16, v65
    v_and_b32 v131, 0xffff0000, v65
    v_pk_mul_f32 v[130:131], v[130:131], v[6:7]
    v_cvt_pk_bf16_f32 v65, v130, v131
    v_cvt_pk_bf16_f32 v66, v132, v133
    v_lshlrev_b32 v132, 16, v66
    v_and_b32 v133, 0xffff0000, v66
    v_pk_mul_f32 v[132:133], v[132:133], v[6:7]
    v_cvt_pk_bf16_f32 v66, v132, v133
    v_cvt_pk_bf16_f32 v67, v134, v135
    v_lshlrev_b32 v134, 16, v67
    v_and_b32 v135, 0xffff0000, v67
    v_pk_mul_f32 v[134:135], v[134:135], v[6:7]
    v_cvt_pk_bf16_f32 v67, v134, v135
    v_cvt_pk_bf16_f32 v68, v136, v137
    v_lshlrev_b32 v136, 16, v68
    v_and_b32 v137, 0xffff0000, v68
    v_pk_mul_f32 v[136:137], v[136:137], v[6:7]
    v_cvt_pk_bf16_f32 v68, v136, v137
    v_cvt_pk_bf16_f32 v69, v138, v139
    v_lshlrev_b32 v138, 16, v69
    v_and_b32 v139, 0xffff0000, v69
    v_pk_mul_f32 v[138:139], v[138:139], v[6:7]
    v_cvt_pk_bf16_f32 v69, v138, v139
    v_cvt_pk_bf16_f32 v70, v140, v141
    v_lshlrev_b32 v140, 16, v70
    v_and_b32 v141, 0xffff0000, v70
    v_pk_mul_f32 v[140:141], v[140:141], v[6:7]
    v_cvt_pk_bf16_f32 v70, v140, v141
    v_cvt_pk_bf16_f32 v71, v142, v143
    v_lshlrev_b32 v142, 16, v71
    v_and_b32 v143, 0xffff0000, v71
    v_pk_mul_f32 v[142:143], v[142:143], v[6:7]
    v_cvt_pk_bf16_f32 v71, v142, v143
    v_cvt_pk_bf16_f32 v72, v144, v145
    v_lshlrev_b32 v144, 16, v72
    v_and_b32 v145, 0xffff0000, v72
    v_pk_mul_f32 v[144:145], v[144:145], v[6:7]
    v_cvt_pk_bf16_f32 v72, v144, v145
    v_cvt_pk_bf16_f32 v73, v146, v147
    v_lshlrev_b32 v146, 16, v73
    v_and_b32 v147, 0xffff0000, v73
    v_pk_mul_f32 v[146:147], v[146:147], v[6:7]
    v_cvt_pk_bf16_f32 v73, v146, v147
    v_cvt_pk_bf16_f32 v74, v148, v149
    v_lshlrev_b32 v148, 16, v74
    v_and_b32 v149, 0xffff0000, v74
    v_pk_mul_f32 v[148:149], v[148:149], v[6:7]
    v_cvt_pk_bf16_f32 v74, v148, v149
    v_cvt_pk_bf16_f32 v75, v150, v151
    v_lshlrev_b32 v150, 16, v75
    v_and_b32 v151, 0xffff0000, v75
    v_pk_mul_f32 v[150:151], v[150:151], v[6:7]
    v_cvt_pk_bf16_f32 v75, v150, v151
    v_cvt_pk_bf16_f32 v76, v152, v153
    v_lshlrev_b32 v152, 16, v76
    v_and_b32 v153, 0xffff0000, v76
    v_pk_mul_f32 v[152:153], v[152:153], v[6:7]
    v_cvt_pk_bf16_f32 v76, v152, v153
    v_cvt_pk_bf16_f32 v77, v154, v155
    v_lshlrev_b32 v154, 16, v77
    v_and_b32 v155, 0xffff0000, v77
    v_pk_mul_f32 v[154:155], v[154:155], v[6:7]
    v_cvt_pk_bf16_f32 v77, v154, v155
    v_cvt_pk_bf16_f32 v78, v156, v157
    v_lshlrev_b32 v156, 16, v78
    v_and_b32 v157, 0xffff0000, v78
    v_pk_mul_f32 v[156:157], v[156:157], v[6:7]
    v_cvt_pk_bf16_f32 v78, v156, v157
    v_cvt_pk_bf16_f32 v79, v158, v159
    v_lshlrev_b32 v158, 16, v79
    v_and_b32 v159, 0xffff0000, v79
    v_pk_mul_f32 v[158:159], v[158:159], v[6:7]
    v_cvt_pk_bf16_f32 v79, v158, v159
    v_cvt_pk_bf16_f32 v80, v160, v161
    v_lshlrev_b32 v160, 16, v80
    v_and_b32 v161, 0xffff0000, v80
    v_pk_mul_f32 v[160:161], v[160:161], v[6:7]
    v_cvt_pk_bf16_f32 v80, v160, v161
    v_cvt_pk_bf16_f32 v81, v162, v163
    v_lshlrev_b32 v162, 16, v81
    v_and_b32 v163, 0xffff0000, v81
    v_pk_mul_f32 v[162:163], v[162:163], v[6:7]
    v_cvt_pk_bf16_f32 v81, v162, v163
    v_cvt_pk_bf16_f32 v82, v164, v165
    v_lshlrev_b32 v164, 16, v82
    v_and_b32 v165, 0xffff0000, v82
    v_pk_mul_f32 v[164:165], v[164:165], v[6:7]
    v_cvt_pk_bf16_f32 v82, v164, v165
    v_cvt_pk_bf16_f32 v83, v166, v167
    v_lshlrev_b32 v166, 16, v83
    v_and_b32 v167, 0xffff0000, v83
    v_pk_mul_f32 v[166:167], v[166:167], v[6:7]
    v_cvt_pk_bf16_f32 v83, v166, v167
    v_cvt_pk_bf16_f32 v84, v168, v169
    v_lshlrev_b32 v168, 16, v84
    v_and_b32 v169, 0xffff0000, v84
    v_pk_mul_f32 v[168:169], v[168:169], v[6:7]
    v_cvt_pk_bf16_f32 v84, v168, v169
    v_cvt_pk_bf16_f32 v85, v170, v171
    v_lshlrev_b32 v170, 16, v85
    v_and_b32 v171, 0xffff0000, v85
    v_pk_mul_f32 v[170:171], v[170:171], v[6:7]
    v_cvt_pk_bf16_f32 v85, v170, v171
    v_cvt_pk_bf16_f32 v86, v172, v173
    v_lshlrev_b32 v172, 16, v86
    v_and_b32 v173, 0xffff0000, v86
    v_pk_mul_f32 v[172:173], v[172:173], v[6:7]
    v_cvt_pk_bf16_f32 v86, v172, v173
    v_cvt_pk_bf16_f32 v87, v174, v175
    v_lshlrev_b32 v174, 16, v87
    v_and_b32 v175, 0xffff0000, v87
    v_pk_mul_f32 v[174:175], v[174:175], v[6:7]
    v_cvt_pk_bf16_f32 v87, v174, v175
    v_cvt_pk_bf16_f32 v88, v176, v177
    v_lshlrev_b32 v176, 16, v88
    v_and_b32 v177, 0xffff0000, v88
    v_pk_mul_f32 v[176:177], v[176:177], v[6:7]
    v_cvt_pk_bf16_f32 v88, v176, v177
    v_cvt_pk_bf16_f32 v89, v178, v179
    v_lshlrev_b32 v178, 16, v89
    v_and_b32 v179, 0xffff0000, v89
    v_pk_mul_f32 v[178:179], v[178:179], v[6:7]
    v_cvt_pk_bf16_f32 v89, v178, v179
    v_cvt_pk_bf16_f32 v90, v180, v181
    v_lshlrev_b32 v180, 16, v90
    v_and_b32 v181, 0xffff0000, v90
    v_pk_mul_f32 v[180:181], v[180:181], v[6:7]
    v_cvt_pk_bf16_f32 v90, v180, v181
    v_cvt_pk_bf16_f32 v91, v182, v183
    v_lshlrev_b32 v182, 16, v91
    v_and_b32 v183, 0xffff0000, v91
    v_pk_mul_f32 v[182:183], v[182:183], v[6:7]
    v_cvt_pk_bf16_f32 v91, v182, v183
    v_cvt_pk_bf16_f32 v92, v184, v185
    v_lshlrev_b32 v184, 16, v92
    v_and_b32 v185, 0xffff0000, v92
    v_pk_mul_f32 v[184:185], v[184:185], v[6:7]
    v_cvt_pk_bf16_f32 v92, v184, v185
    v_cvt_pk_bf16_f32 v93, v186, v187
    v_lshlrev_b32 v186, 16, v93
    v_and_b32 v187, 0xffff0000, v93
    v_pk_mul_f32 v[186:187], v[186:187], v[6:7]
    v_cvt_pk_bf16_f32 v93, v186, v187
    v_cvt_pk_bf16_f32 v94, v188, v189
    v_lshlrev_b32 v188, 16, v94
    v_and_b32 v189, 0xffff0000, v94
    v_pk_mul_f32 v[188:189], v[188:189], v[6:7]
    v_cvt_pk_bf16_f32 v94, v188, v189
    v_cvt_pk_bf16_f32 v95, v190, v191
    v_lshlrev_b32 v190, 16, v95
    v_and_b32 v191, 0xffff0000, v95
    v_pk_mul_f32 v[190:191], v[190:191], v[6:7]
    v_cvt_pk_bf16_f32 v95, v190, v191
    v_add_u32 v2, s88, v12
    ds_write_b128 v2, v[64:67]
    v_add_u32 v2, s89, v12
    ds_write_b128 v2, v[68:71]
    v_add_u32 v2, s90, v12
    ds_write_b128 v2, v[72:75]
    v_add_u32 v2, s91, v12
    ds_write_b128 v2, v[76:79]
    v_add_u32 v2, s92, v12
    ds_write_b128 v2, v[80:83]
    v_add_u32 v2, s93, v12
    ds_write_b128 v2, v[84:87]
    v_add_u32 v2, s94, v12
    ds_write_b128 v2, v[88:91]
    v_add_u32 v2, s95, v12
    ds_write_b128 v2, v[92:95]
    buffer_store_dwordx4 v[64:67], v10, s[16:19], s80 offen
    v_mov_b32 v2, 0
    v_mov_b32 v32, 0
    v_mov_b32 v3, 0
    v_mov_b32 v33, 0
    v_mov_b32 v4, 0
    v_mov_b32 v34, 0
    v_mov_b32 v5, 0
    v_mov_b32 v35, 0
    v_dot2_f32_bf16 v2, v64, s46, v2
    v_dot2_f32_bf16 v32, v64, v64, v32
    v_dot2_f32_bf16 v3, v65, s46, v3
    v_dot2_f32_bf16 v33, v65, v65, v33
    v_dot2_f32_bf16 v4, v66, s46, v4
    v_dot2_f32_bf16 v34, v66, v66, v34
    v_dot2_f32_bf16 v5, v67, s46, v5
    v_dot2_f32_bf16 v35, v67, v67, v35
    v_dot2_f32_bf16 v2, v68, s46, v2
    v_dot2_f32_bf16 v32, v68, v68, v32
    v_dot2_f32_bf16 v3, v69, s46, v3
    v_dot2_f32_bf16 v33, v69, v69, v33
    v_dot2_f32_bf16 v4, v70, s46, v4
    v_dot2_f32_bf16 v34, v70, v70, v34
    v_dot2_f32_bf16 v5, v71, s46, v5
    v_dot2_f32_bf16 v35, v71, v71, v35
    v_dot2_f32_bf16 v2, v72, s46, v2
    v_dot2_f32_bf16 v32, v72, v72, v32
    v_dot2_f32_bf16 v3, v73, s46, v3
    v_dot2_f32_bf16 v33, v73, v73, v33
    v_dot2_f32_bf16 v4, v74, s46, v4
    v_dot2_f32_bf16 v34, v74, v74, v34
    v_dot2_f32_bf16 v5, v75, s46, v5
    v_dot2_f32_bf16 v35, v75, v75, v35
    v_dot2_f32_bf16 v2, v76, s46, v2
    v_dot2_f32_bf16 v32, v76, v76, v32
    v_dot2_f32_bf16 v3, v77, s46, v3
    v_dot2_f32_bf16 v33, v77, v77, v33
    v_dot2_f32_bf16 v4, v78, s46, v4
    v_dot2_f32_bf16 v34, v78, v78, v34
    v_dot2_f32_bf16 v5, v79, s46, v5
    v_dot2_f32_bf16 v35, v79, v79, v35
    v_dot2_f32_bf16 v2, v80, s46, v2
    v_dot2_f32_bf16 v32, v80, v80, v32
    v_dot2_f32_bf16 v3, v81, s46, v3
    v_dot2_f32_bf16 v33, v81, v81, v33
    v_dot2_f32_bf16 v4, v82, s46, v4
    v_dot2_f32_bf16 v34, v82, v82, v34
    v_dot2_f32_bf16 v5, v83, s46, v5
    v_dot2_f32_bf16 v35, v83, v83, v35
    v_dot2_f32_bf16 v2, v84, s46, v2
    v_dot2_f32_bf16 v32, v84, v84, v32
    v_dot2_f32_bf16 v3, v85, s46, v3
    v_dot2_f32_bf16 v33, v85, v85, v33
    v_dot2_f32_bf16 v4, v86, s46, v4
    v_dot2_f32_bf16 v34, v86, v86, v34
    v_dot2_f32_bf16 v5, v87, s46, v5
    v_dot2_f32_bf16 v35, v87, v87, v35
    v_dot2_f32_bf16 v2, v88, s46, v2
    v_dot2_f32_bf16 v32, v88, v88, v32
    v_dot2_f32_bf16 v3, v89, s46, v3
    v_dot2_f32_bf16 v33, v89, v89, v33
    v_dot2_f32_bf16 v4, v90, s46, v4
    v_dot2_f32_bf16 v34, v90, v90, v34
    v_dot2_f32_bf16 v5, v91, s46, v5
    v_dot2_f32_bf16 v35, v91, v91, v35
    v_dot2_f32_bf16 v2, v92, s46, v2
    v_dot2_f32_bf16 v32, v92, v92, v32
    v_dot2_f32_bf16 v3, v93, s46, v3
    v_dot2_f32_bf16 v33, v93, v93, v33
    v_dot2_f32_bf16 v4, v94, s46, v4
    v_dot2_f32_bf16 v34, v94, v94, v34
    v_dot2_f32_bf16 v5, v95, s46, v5
    v_dot2_f32_bf16 v35, v95, v95, v35
    s_nop 2
    v_add_f32 v2, v2, v3
    v_add_f32 v4, v4, v5
    v_add_f32 v2, v2, v4
    v_add_f32 v32, v32, v33
    v_add_f32 v34, v34, v35
    v_add_f32 v32, v32, v34
    s_nop 1
    v_add_f32_dpp v2, v2, v2 quad_perm:[1,0,3,2] row_mask:0xf bank_mask:0xf
    s_nop 1
    v_add_f32_dpp v2, v2, v2 quad_perm:[2,3,0,1] row_mask:0xf bank_mask:0xf
    s_nop 1
    v_add_f32_dpp v2, v2, v2 row_half_mirror row_mask:0xf bank_mask:0xf
    s_nop 1
    v_add_f32_dpp v32, v32, v32 quad_perm:[1,0,3,2] row_mask:0xf bank_mask:0xf
    s_nop 1
    v_add_f32_dpp v32, v32, v32 quad_perm:[2,3,0,1] row_mask:0xf bank_mask:0xf
    s_nop 1
    v_add_f32_dpp v32, v32, v32 row_half_mirror row_mask:0xf bank_mask:0xf
    v_mul_f32 v2, s47, v2
    v_mul_f32 v32, s47, v32
    v_fma_f32 v32, -v2, v2, v32
    v_cvt_pk_bf16_f32 v3, v2, v2
    v_lshlrev_b32 v3, 16, v3
    v_cvt_pk_bf16_f32 v32, v32, v32
    v_lshlrev_b32 v32, 16, v32
    v_add_f32 v32, s96, v32
    v_cvt_pk_bf16_f32 v32, v32, v32
    v_lshlrev_b32 v32, 16, v32
    v_sqrt_f32 v32, v32
    s_nop 0
    v_cvt_pk_bf16_f32 v32, v32, v32
    v_lshlrev_b32 v32, 16, v32
    v_rcp_f32 v34, v32
    v_sub_f32 v6, 0, v3
    v_sub_f32 v7, 0, v3
    v_mov_b32 v35, v34
    v_lshlrev_b32 v128, 16, v64
    v_and_b32 v129, 0xffff0000, v64
    v_pk_add_f32 v[128:129], v[128:129], v[6:7]
    v_cvt_pk_bf16_f32 v36, v128, v129
    v_lshlrev_b32 v128, 16, v36
    v_and_b32 v129, 0xffff0000, v36
    v_pk_mul_f32 v[128:129], v[128:129], v[34:35]
    v_cvt_pk_bf16_f32 v36, v128, v129
    v_lshlrev_b32 v130, 16, v65
    v_and_b32 v131, 0xffff0000, v65
    v_pk_add_f32 v[130:131], v[130:131], v[6:7]
    v_cvt_pk_bf16_f32 v37, v130, v131
    v_lshlrev_b32 v130, 16, v37
    v_and_b32 v131, 0xffff0000, v37
    v_pk_mul_f32 v[130:131], v[130:131], v[34:35]
    v_cvt_pk_bf16_f32 v37, v130, v131
    v_lshlrev_b32 v132, 16, v66
    v_and_b32 v133, 0xffff0000, v66
    v_pk_add_f32 v[132:133], v[132:133], v[6:7]
    v_cvt_pk_bf16_f32 v38, v132, v133
    v_lshlrev_b32 v132, 16, v38
    v_and_b32 v133, 0xffff0000, v38
    v_pk_mul_f32 v[132:133], v[132:133], v[34:35]
    v_cvt_pk_bf16_f32 v38, v132, v133
    v_lshlrev_b32 v134, 16, v67
    v_and_b32 v135, 0xffff0000, v67
    v_pk_add_f32 v[134:135], v[134:135], v[6:7]
    v_cvt_pk_bf16_f32 v39, v134, v135
    v_lshlrev_b32 v134, 16, v39
    v_and_b32 v135, 0xffff0000, v39
    v_pk_mul_f32 v[134:135], v[134:135], v[34:35]
    v_cvt_pk_bf16_f32 v39, v134, v135
    buffer_store_dwordx4 v[36:39], v10, s[20:23], s80 offen
    s_nop 1
    s_waitcnt vmcnt(26)
    v_mov_b32 v2, 0
    v_mov_b32 v3, 0
    v_mov_b32 v4, 0
    v_mov_b32 v5, 0
    v_dot2_f32_bf16 v2, v96, s46, v2
    v_dot2_f32_bf16 v3, v97, s46, v3
    v_dot2_f32_bf16 v4, v98, s46, v4
    v_dot2_f32_bf16 v5, v99, s46, v5
    v_dot2_f32_bf16 v2, v100, s46, v2
    v_dot2_f32_bf16 v3, v101, s46, v3
    v_dot2_f32_bf16 v4, v102, s46, v4
    v_dot2_f32_bf16 v5, v103, s46, v5
    v_dot2_f32_bf16 v2, v104, s46, v2
    v_dot2_f32_bf16 v3, v105, s46, v3
    v_dot2_f32_bf16 v4, v106, s46, v4
    v_dot2_f32_bf16 v5, v107, s46, v5
    v_dot2_f32_bf16 v2, v108, s46, v2
    v_dot2_f32_bf16 v3, v109, s46, v3
    v_dot2_f32_bf16 v4, v110, s46, v4
    v_dot2_f32_bf16 v5, v111, s46, v5
    v_dot2_f32_bf16 v2, v112, s46, v2
    v_dot2_f32_bf16 v3, v113, s46, v3
    v_dot2_f32_bf16 v4, v114, s46, v4
    v_dot2_f32_bf16 v5, v115, s46, v5
    v_dot2_f32_bf16 v2, v116, s46, v2
    v_dot2_f32_bf16 v3, v117, s46, v3
    v_dot2_f32_bf16 v4, v118, s46, v4
    v_dot2_f32_bf16 v5, v119, s46, v5
    v_dot2_f32_bf16 v2, v120, s46, v2
    v_dot2_f32_bf16 v3, v121, s46, v3
    v_dot2_f32_bf16 v4, v122, s46, v4
    v_dot2_f32_bf16 v5, v123, s46, v5
    v_dot2_f32_bf16 v2, v124, s46, v2
    v_dot2_f32_bf16 v3, v125, s46, v3
    v_dot2_f32_bf16 v4, v126, s46, v4
    v_dot2_f32_bf16 v5, v127, s46, v5
    s_nop 2
    v_add_f32 v2, v2, v3
    v_add_f32 v4, v4, v5
    v_add_f32 v2, v2, v4
    s_nop 1
    v_add_f32_dpp v2, v2, v2 quad_perm:[1,0,3,2] row_mask:0xf bank_mask:0xf
    s_nop 1
    v_add_f32_dpp v2, v2, v2 quad_perm:[2,3,0,1] row_mask:0xf bank_mask:0xf
    s_nop 1
    v_add_f32_dpp v2, v2, v2 row_half_mirror row_mask:0xf bank_mask:0xf
    v_mul_f32 v2, s47, v2
    v_cvt_pk_bf16_f32 v3, v2, v2
    v_lshlrev_b32 v3, 16, v3
    v_sub_f32 v4, v2, v3
    v_sub_f32 v6, 0, v3
    v_sub_f32 v7, 0, v3
    v_mov_b32 v32, 0
    v_mov_b32 v33, 0
    v_mov_b32 v34, 0
    v_mov_b32 v35, 0
    v_mov_b32 v36, 0
    v_mov_b32 v37, 0
    v_mov_b32 v38, 0
    v_mov_b32 v39, 0
    v_lshlrev_b32 v128, 16, v96
    v_and_b32 v129, 0xffff0000, v96
    v_pk_add_f32 v[128:129], v[128:129], v[6:7]
    v_pk_fma_f32 v[32:33], v[128:129], v[128:129], v[32:33]
    v_lshlrev_b32 v130, 16, v97
    v_and_b32 v131, 0xffff0000, v97
    v_pk_add_f32 v[130:131], v[130:131], v[6:7]
    v_pk_fma_f32 v[34:35], v[130:131], v[130:131], v[34:35]
    v_lshlrev_b32 v132, 16, v98
    v_and_b32 v133, 0xffff0000, v98
    v_pk_add_f32 v[132:133], v[132:133], v[6:7]
    v_pk_fma_f32 v[36:37], v[132:133], v[132:133], v[36:37]
    v_lshlrev_b32 v134, 16, v99
    v_and_b32 v135, 0xffff0000, v99
    v_pk_add_f32 v[134:135], v[134:135], v[6:7]
    v_pk_fma_f32 v[38:39], v[134:135], v[134:135], v[38:39]
    v_lshlrev_b32 v136, 16, v100
    v_and_b32 v137, 0xffff0000, v100
    v_pk_add_f32 v[136:137], v[136:137], v[6:7]
    v_pk_fma_f32 v[32:33], v[136:137], v[136:137], v[32:33]
    v_lshlrev_b32 v138, 16, v101
    v_and_b32 v139, 0xffff0000, v101
    v_pk_add_f32 v[138:139], v[138:139], v[6:7]
    v_pk_fma_f32 v[34:35], v[138:139], v[138:139], v[34:35]
    v_lshlrev_b32 v140, 16, v102
    v_and_b32 v141, 0xffff0000, v102
    v_pk_add_f32 v[140:141], v[140:141], v[6:7]
    v_pk_fma_f32 v[36:37], v[140:141], v[140:141], v[36:37]
    v_lshlrev_b32 v142, 16, v103
    v_and_b32 v143, 0xffff0000, v103
    v_pk_add_f32 v[142:143], v[142:143], v[6:7]
    v_pk_fma_f32 v[38:39], v[142:143], v[142:143], v[38:39]
    v_lshlrev_b32 v144, 16, v104
    v_and_b32 v145, 0xffff0000, v104
    v_pk_add_f32 v[144:145], v[144:145], v[6:7]
    v_pk_fma_f32 v[32:33], v[144:145], v[144:145], v[32:33]
    v_lshlrev_b32 v146, 16, v105
    v_and_b32 v147, 0xffff0000, v105
    v_pk_add_f32 v[146:147], v[146:147], v[6:7]
    v_pk_fma_f32 v[34:35], v[146:147], v[146:147], v[34:35]
    v_lshlrev_b32 v148, 16, v106
    v_and_b32 v149, 0xffff0000, v106
    v_pk_add_f32 v[148:149], v[148:149], v[6:7]
    v_pk_fma_f32 v[36:37], v[148:149], v[148:149], v[36:37]
    v_lshlrev_b32 v150, 16, v107
    v_and_b32 v151, 0xffff0000, v107
    v_pk_add_f32 v[150:151], v[150:151], v[6:7]
    v_pk_fma_f32 v[38:39], v[150:151], v[150:151], v[38:39]
    v_lshlrev_b32 v152, 16, v108
    v_and_b32 v153, 0xffff0000, v108
    v_pk_add_f32 v[152:153], v[152:153], v[6:7]
    v_pk_fma_f32 v[32:33], v[152:153], v[152:153], v[32:33]
    v_lshlrev_b32 v154, 16, v109
    v_and_b32 v155, 0xffff0000, v109
    v_pk_add_f32 v[154:155], v[154:155], v[6:7]
    v_pk_fma_f32 v[34:35], v[154:155], v[154:155], v[34:35]
    v_lshlrev_b32 v156, 16, v110
    v_and_b32 v157, 0xffff0000, v110
    v_pk_add_f32 v[156:157], v[156:157], v[6:7]
    v_pk_fma_f32 v[36:37], v[156:157], v[156:157], v[36:37]
    v_lshlrev_b32 v158, 16, v111
    v_and_b32 v159, 0xffff0000, v111
    v_pk_add_f32 v[158:159], v[158:159], v[6:7]
    v_pk_fma_f32 v[38:39], v[158:159], v[158:159], v[38:39]
    v_lshlrev_b32 v160, 16, v112
    v_and_b32 v161, 0xffff0000, v112
    v_pk_add_f32 v[160:161], v[160:161], v[6:7]
    v_pk_fma_f32 v[32:33], v[160:161], v[160:161], v[32:33]
    v_lshlrev_b32 v162, 16, v113
    v_and_b32 v163, 0xffff0000, v113
    v_pk_add_f32 v[162:163], v[162:163], v[6:7]
    v_pk_fma_f32 v[34:35], v[162:163], v[162:163], v[34:35]
    v_lshlrev_b32 v164, 16, v114
    v_and_b32 v165, 0xffff0000, v114
    v_pk_add_f32 v[164:165], v[164:165], v[6:7]
    v_pk_fma_f32 v[36:37], v[164:165], v[164:165], v[36:37]
    v_lshlrev_b32 v166, 16, v115
    v_and_b32 v167, 0xffff0000, v115
    v_pk_add_f32 v[166:167], v[166:167], v[6:7]
    v_pk_fma_f32 v[38:39], v[166:167], v[166:167], v[38:39]
    v_lshlrev_b32 v168, 16, v116
    v_and_b32 v169, 0xffff0000, v116
    v_pk_add_f32 v[168:169], v[168:169], v[6:7]
    v_pk_fma_f32 v[32:33], v[168:169], v[168:169], v[32:33]
    v_lshlrev_b32 v170, 16, v117
    v_and_b32 v171, 0xffff0000, v117
    v_pk_add_f32 v[170:171], v[170:171], v[6:7]
    v_pk_fma_f32 v[34:35], v[170:171], v[170:171], v[34:35]
    v_lshlrev_b32 v172, 16, v118
    v_and_b32 v173, 0xffff0000, v118
    v_pk_add_f32 v[172:173], v[172:173], v[6:7]
    v_pk_fma_f32 v[36:37], v[172:173], v[172:173], v[36:37]
    v_lshlrev_b32 v174, 16, v119
    v_and_b32 v175, 0xffff0000, v119
    v_pk_add_f32 v[174:175], v[174:175], v[6:7]
    v_pk_fma_f32 v[38:39], v[174:175], v[174:175], v[38:39]
    v_lshlrev_b32 v176, 16, v120
    v_and_b32 v177, 0xffff0000, v120
    v_pk_add_f32 v[176:177], v[176:177], v[6:7]
    v_pk_fma_f32 v[32:33], v[176:177], v[176:177], v[32:33]
    v_lshlrev_b32 v178, 16, v121
    v_and_b32 v179, 0xffff0000, v121
    v_pk_add_f32 v[178:179], v[178:179], v[6:7]
    v_pk_fma_f32 v[34:35], v[178:179], v[178:179], v[34:35]
    v_lshlrev_b32 v180, 16, v122
    v_and_b32 v181, 0xffff0000, v122
    v_pk_add_f32 v[180:181], v[180:181], v[6:7]
    v_pk_fma_f32 v[36:37], v[180:181], v[180:181], v[36:37]
    v_lshlrev_b32 v182, 16, v123
    v_and_b32 v183, 0xffff0000, v123
    v_pk_add_f32 v[182:183], v[182:183], v[6:7]
    v_pk_fma_f32 v[38:39], v[182:183], v[182:183], v[38:39]
    v_lshlrev_b32 v184, 16, v124
    v_and_b32 v185, 0xffff0000, v124
    v_pk_add_f32 v[184:185], v[184:185], v[6:7]
    v_pk_fma_f32 v[32:33], v[184:185], v[184:185], v[32:33]
    v_lshlrev_b32 v186, 16, v125
    v_and_b32 v187, 0xffff0000, v125
    v_pk_add_f32 v[186:187], v[186:187], v[6:7]
    v_pk_fma_f32 v[34:35], v[186:187], v[186:187], v[34:35]
    v_lshlrev_b32 v188, 16, v126
    v_and_b32 v189, 0xffff0000, v126
    v_pk_add_f32 v[188:189], v[188:189], v[6:7]
    v_pk_fma_f32 v[36:37], v[188:189], v[188:189], v[36:37]
    v_lshlrev_b32 v190, 16, v127
    v_and_b32 v191, 0xffff0000, v127
    v_pk_add_f32 v[190:191], v[190:191], v[6:7]
    v_pk_fma_f32 v[38:39], v[190:191], v[190:191], v[38:39]
    v_pk_add_f32 v[32:33], v[32:33], v[34:35]
    v_pk_add_f32 v[36:37], v[36:37], v[38:39]
    v_pk_add_f32 v[32:33], v[32:33], v[36:37]
    v_add_f32 v5, v32, v33
    s_nop 1
    v_add_f32_dpp v5, v5, v5 quad_perm:[1,0,3,2] row_mask:0xf bank_mask:0xf
    s_nop 1
    v_add_f32_dpp v5, v5, v5 quad_perm:[2,3,0,1] row_mask:0xf bank_mask:0xf
    s_nop 1
    v_add_f32_dpp v5, v5, v5 row_half_mirror row_mask:0xf bank_mask:0xf
    v_mul_f32 v5, s47, v5
    v_fma_f32 v5, -v4, v4, v5
    v_cvt_pk_bf16_f32 v5, v5, v5
    v_lshlrev_b32 v5, 16, v5
    v_add_f32 v5, s96, v5
    v_cvt_pk_bf16_f32 v5, v5, v5
    v_lshlrev_b32 v5, 16, v5
    v_sqrt_f32 v5, v5
    s_nop 0
    v_cvt_pk_bf16_f32 v5, v5, v5
    v_lshlrev_b32 v5, 16, v5
    v_rcp_f32 v6, v5
    s_nop 0
    v_mov_b32 v7, v6
    v_cvt_pk_bf16_f32 v96, v128, v129
    v_lshlrev_b32 v128, 16, v96
    v_and_b32 v129, 0xffff0000, v96
    v_pk_mul_f32 v[128:129], v[128:129], v[6:7]
    v_cvt_pk_bf16_f32 v96, v128, v129
    v_cvt_pk_bf16_f32 v97, v130, v131
    v_lshlrev_b32 v130, 16, v97
    v_and_b32 v131, 0xffff0000, v97
    v_pk_mul_f32 v[130:131], v[130:131], v[6:7]
    v_cvt_pk_bf16_f32 v97, v130, v131
    v_cvt_pk_bf16_f32 v98, v132, v133
    v_lshlrev_b32 v132, 16, v98
    v_and_b32 v133, 0xffff0000, v98
    v_pk_mul_f32 v[132:133], v[132:133], v[6:7]
    v_cvt_pk_bf16_f32 v98, v132, v133
    v_cvt_pk_bf16_f32 v99, v134, v135
    v_lshlrev_b32 v134, 16, v99
    v_and_b32 v135, 0xffff0000, v99
    v_pk_mul_f32 v[134:135], v[134:135], v[6:7]
    v_cvt_pk_bf16_f32 v99, v134, v135
    v_cvt_pk_bf16_f32 v100, v136, v137
    v_lshlrev_b32 v136, 16, v100
    v_and_b32 v137, 0xffff0000, v100
    v_pk_mul_f32 v[136:137], v[136:137], v[6:7]
    v_cvt_pk_bf16_f32 v100, v136, v137
    v_cvt_pk_bf16_f32 v101, v138, v139
    v_lshlrev_b32 v138, 16, v101
    v_and_b32 v139, 0xffff0000, v101
    v_pk_mul_f32 v[138:139], v[138:139], v[6:7]
    v_cvt_pk_bf16_f32 v101, v138, v139
    v_cvt_pk_bf16_f32 v102, v140, v141
    v_lshlrev_b32 v140, 16, v102
    v_and_b32 v141, 0xffff0000, v102
    v_pk_mul_f32 v[140:141], v[140:141], v[6:7]
    v_cvt_pk_bf16_f32 v102, v140, v141
    v_cvt_pk_bf16_f32 v103, v142, v143
    v_lshlrev_b32 v142, 16, v103
    v_and_b32 v143, 0xffff0000, v103
    v_pk_mul_f32 v[142:143], v[142:143], v[6:7]
    v_cvt_pk_bf16_f32 v103, v142, v143
    v_cvt_pk_bf16_f32 v104, v144, v145
    v_lshlrev_b32 v144, 16, v104
    v_and_b32 v145, 0xffff0000, v104
    v_pk_mul_f32 v[144:145], v[144:145], v[6:7]
    v_cvt_pk_bf16_f32 v104, v144, v145
    v_cvt_pk_bf16_f32 v105, v146, v147
    v_lshlrev_b32 v146, 16, v105
    v_and_b32 v147, 0xffff0000, v105
    v_pk_mul_f32 v[146:147], v[146:147], v[6:7]
    v_cvt_pk_bf16_f32 v105, v146, v147
    v_cvt_pk_bf16_f32 v106, v148, v149
    v_lshlrev_b32 v148, 16, v106
    v_and_b32 v149, 0xffff0000, v106
    v_pk_mul_f32 v[148:149], v[148:149], v[6:7]
    v_cvt_pk_bf16_f32 v106, v148, v149
    v_cvt_pk_bf16_f32 v107, v150, v151
    v_lshlrev_b32 v150, 16, v107
    v_and_b32 v151, 0xffff0000, v107
    v_pk_mul_f32 v[150:151], v[150:151], v[6:7]
    v_cvt_pk_bf16_f32 v107, v150, v151
    v_cvt_pk_bf16_f32 v108, v152, v153
    v_lshlrev_b32 v152, 16, v108
    v_and_b32 v153, 0xffff0000, v108
    v_pk_mul_f32 v[152:153], v[152:153], v[6:7]
    v_cvt_pk_bf16_f32 v108, v152, v153
    v_cvt_pk_bf16_f32 v109, v154, v155
    v_lshlrev_b32 v154, 16, v109
    v_and_b32 v155, 0xffff0000, v109
    v_pk_mul_f32 v[154:155], v[154:155], v[6:7]
    v_cvt_pk_bf16_f32 v109, v154, v155
    v_cvt_pk_bf16_f32 v110, v156, v157
    v_lshlrev_b32 v156, 16, v110
    v_and_b32 v157, 0xffff0000, v110
    v_pk_mul_f32 v[156:157], v[156:157], v[6:7]
    v_cvt_pk_bf16_f32 v110, v156, v157
    v_cvt_pk_bf16_f32 v111, v158, v159
    v_lshlrev_b32 v158, 16, v111
    v_and_b32 v159, 0xffff0000, v111
    v_pk_mul_f32 v[158:159], v[158:159], v[6:7]
    v_cvt_pk_bf16_f32 v111, v158, v159
    v_cvt_pk_bf16_f32 v112, v160, v161
    v_lshlrev_b32 v160, 16, v112
    v_and_b32 v161, 0xffff0000, v112
    v_pk_mul_f32 v[160:161], v[160:161], v[6:7]
    v_cvt_pk_bf16_f32 v112, v160, v161
    v_cvt_pk_bf16_f32 v113, v162, v163
    v_lshlrev_b32 v162, 16, v113
    v_and_b32 v163, 0xffff0000, v113
    v_pk_mul_f32 v[162:163], v[162:163], v[6:7]
    v_cvt_pk_bf16_f32 v113, v162, v163
    v_cvt_pk_bf16_f32 v114, v164, v165
    v_lshlrev_b32 v164, 16, v114
    v_and_b32 v165, 0xffff0000, v114
    v_pk_mul_f32 v[164:165], v[164:165], v[6:7]
    v_cvt_pk_bf16_f32 v114, v164, v165
    v_cvt_pk_bf16_f32 v115, v166, v167
    v_lshlrev_b32 v166, 16, v115
    v_and_b32 v167, 0xffff0000, v115
    v_pk_mul_f32 v[166:167], v[166:167], v[6:7]
    v_cvt_pk_bf16_f32 v115, v166, v167
    v_cvt_pk_bf16_f32 v116, v168, v169
    v_lshlrev_b32 v168, 16, v116
    v_and_b32 v169, 0xffff0000, v116
    v_pk_mul_f32 v[168:169], v[168:169], v[6:7]
    v_cvt_pk_bf16_f32 v116, v168, v169
    v_cvt_pk_bf16_f32 v117, v170, v171
    v_lshlrev_b32 v170, 16, v117
    v_and_b32 v171, 0xffff0000, v117
    v_pk_mul_f32 v[170:171], v[170:171], v[6:7]
    v_cvt_pk_bf16_f32 v117, v170, v171
    v_cvt_pk_bf16_f32 v118, v172, v173
    v_lshlrev_b32 v172, 16, v118
    v_and_b32 v173, 0xffff0000, v118
    v_pk_mul_f32 v[172:173], v[172:173], v[6:7]
    v_cvt_pk_bf16_f32 v118, v172, v173
    v_cvt_pk_bf16_f32 v119, v174, v175
    v_lshlrev_b32 v174, 16, v119
    v_and_b32 v175, 0xffff0000, v119
    v_pk_mul_f32 v[174:175], v[174:175], v[6:7]
    v_cvt_pk_bf16_f32 v119, v174, v175
    v_cvt_pk_bf16_f32 v120, v176, v177
    v_lshlrev_b32 v176, 16, v120
    v_and_b32 v177, 0xffff0000, v120
    v_pk_mul_f32 v[176:177], v[176:177], v[6:7]
    v_cvt_pk_bf16_f32 v120, v176, v177
    v_cvt_pk_bf16_f32 v121, v178, v179
    v_lshlrev_b32 v178, 16, v121
    v_and_b32 v179, 0xffff0000, v121
    v_pk_mul_f32 v[178:179], v[178:179], v[6:7]
    v_cvt_pk_bf16_f32 v121, v178, v179
    v_cvt_pk_bf16_f32 v122, v180, v181
    v_lshlrev_b32 v180, 16, v122
    v_and_b32 v181, 0xffff0000, v122
    v_pk_mul_f32 v[180:181], v[180:181], v[6:7]
    v_cvt_pk_bf16_f32 v122, v180, v181
    v_cvt_pk_bf16_f32 v123, v182, v183
    v_lshlrev_b32 v182, 16, v123
    v_and_b32 v183, 0xffff0000, v123
    v_pk_mul_f32 v[182:183], v[182:183], v[6:7]
    v_cvt_pk_bf16_f32 v123, v182, v183
    v_cvt_pk_bf16_f32 v124, v184, v185
    v_lshlrev_b32 v184, 16, v124
    v_and_b32 v185, 0xffff0000, v124
    v_pk_mul_f32 v[184:185], v[184:185], v[6:7]
    v_cvt_pk_bf16_f32 v124, v184, v185
    v_cvt_pk_bf16_f32 v125, v186, v187
    v_lshlrev_b32 v186, 16, v125
    v_and_b32 v187, 0xffff0000, v125
    v_pk_mul_f32 v[186:187], v[186:187], v[6:7]
    v_cvt_pk_bf16_f32 v125, v186, v187
    v_cvt_pk_bf16_f32 v126, v188, v189
    v_lshlrev_b32 v188, 16, v126
    v_and_b32 v189, 0xffff0000, v126
    v_pk_mul_f32 v[188:189], v[188:189], v[6:7]
    v_cvt_pk_bf16_f32 v126, v188, v189
    v_cvt_pk_bf16_f32 v127, v190, v191
    v_lshlrev_b32 v190, 16, v127
    v_and_b32 v191, 0xffff0000, v127
    v_pk_mul_f32 v[190:191], v[190:191], v[6:7]
    v_cvt_pk_bf16_f32 v127, v190, v191
    v_add_u32 v2, s88, v13
    ds_write_b128 v2, v[96:99]
    v_add_u32 v2, s89, v13
    ds_write_b128 v2, v[100:103]
    v_add_u32 v2, s90, v13
    ds_write_b128 v2, v[104:107]
    v_add_u32 v2, s91, v13
    ds_write_b128 v2, v[108:111]
    v_add_u32 v2, s92, v13
    ds_write_b128 v2, v[112:115]
    v_add_u32 v2, s93, v13
    ds_write_b128 v2, v[116:119]
    v_add_u32 v2, s94, v13
    ds_write_b128 v2, v[120:123]
    v_add_u32 v2, s95, v13
    ds_write_b128 v2, v[124:127]
    buffer_store_dwordx4 v[96:99], v11, s[16:19], s80 offen
    v_mov_b32 v2, 0
    v_mov_b32 v32, 0
    v_mov_b32 v3, 0
    v_mov_b32 v33, 0
    v_mov_b32 v4, 0
    v_mov_b32 v34, 0
    v_mov_b32 v5, 0
    v_mov_b32 v35, 0
    v_dot2_f32_bf16 v2, v96, s46, v2
    v_dot2_f32_bf16 v32, v96, v96, v32
    v_dot2_f32_bf16 v3, v97, s46, v3
    v_dot2_f32_bf16 v33, v97, v97, v33
    v_dot2_f32_bf16 v4, v98, s46, v4
    v_dot2_f32_bf16 v34, v98, v98, v34
    v_dot2_f32_bf16 v5, v99, s46, v5
    v_dot2_f32_bf16 v35, v99, v99, v35
    v_dot2_f32_bf16 v2, v100, s46, v2
    v_dot2_f32_bf16 v32, v100, v100, v32
    v_dot2_f32_bf16 v3, v101, s46, v3
    v_dot2_f32_bf16 v33, v101, v101, v33
    v_dot2_f32_bf16 v4, v102, s46, v4
    v_dot2_f32_bf16 v34, v102, v102, v34
    v_dot2_f32_bf16 v5, v103, s46, v5
    v_dot2_f32_bf16 v35, v103, v103, v35
    v_dot2_f32_bf16 v2, v104, s46, v2
    v_dot2_f32_bf16 v32, v104, v104, v32
    v_dot2_f32_bf16 v3, v105, s46, v3
    v_dot2_f32_bf16 v33, v105, v105, v33
    v_dot2_f32_bf16 v4, v106, s46, v4
    v_dot2_f32_bf16 v34, v106, v106, v34
    v_dot2_f32_bf16 v5, v107, s46, v5
    v_dot2_f32_bf16 v35, v107, v107, v35
    v_dot2_f32_bf16 v2, v108, s46, v2
    v_dot2_f32_bf16 v32, v108, v108, v32
    v_dot2_f32_bf16 v3, v109, s46, v3
    v_dot2_f32_bf16 v33, v109, v109, v33
    v_dot2_f32_bf16 v4, v110, s46, v4
    v_dot2_f32_bf16 v34, v110, v110, v34
    v_dot2_f32_bf16 v5, v111, s46, v5
    v_dot2_f32_bf16 v35, v111, v111, v35
    v_dot2_f32_bf16 v2, v112, s46, v2
    v_dot2_f32_bf16 v32, v112, v112, v32
    v_dot2_f32_bf16 v3, v113, s46, v3
    v_dot2_f32_bf16 v33, v113, v113, v33
    v_dot2_f32_bf16 v4, v114, s46, v4
    v_dot2_f32_bf16 v34, v114, v114, v34
    v_dot2_f32_bf16 v5, v115, s46, v5
    v_dot2_f32_bf16 v35, v115, v115, v35
    v_dot2_f32_bf16 v2, v116, s46, v2
    v_dot2_f32_bf16 v32, v116, v116, v32
    v_dot2_f32_bf16 v3, v117, s46, v3
    v_dot2_f32_bf16 v33, v117, v117, v33
    v_dot2_f32_bf16 v4, v118, s46, v4
    v_dot2_f32_bf16 v34, v118, v118, v34
    v_dot2_f32_bf16 v5, v119, s46, v5
    v_dot2_f32_bf16 v35, v119, v119, v35
    v_dot2_f32_bf16 v2, v120, s46, v2
    v_dot2_f32_bf16 v32, v120, v120, v32
    v_dot2_f32_bf16 v3, v121, s46, v3
    v_dot2_f32_bf16 v33, v121, v121, v33
    v_dot2_f32_bf16 v4, v122, s46, v4
    v_dot2_f32_bf16 v34, v122, v122, v34
    v_dot2_f32_bf16 v5, v123, s46, v5
    v_dot2_f32_bf16 v35, v123, v123, v35
    v_dot2_f32_bf16 v2, v124, s46, v2
    v_dot2_f32_bf16 v32, v124, v124, v32
    v_dot2_f32_bf16 v3, v125, s46, v3
    v_dot2_f32_bf16 v33, v125, v125, v33
    v_dot2_f32_bf16 v4, v126, s46, v4
    v_dot2_f32_bf16 v34, v126, v126, v34
    v_dot2_f32_bf16 v5, v127, s46, v5
    v_dot2_f32_bf16 v35, v127, v127, v35
    s_nop 2
    v_add_f32 v2, v2, v3
    v_add_f32 v4, v4, v5
    v_add_f32 v2, v2, v4
    v_add_f32 v32, v32, v33
    v_add_f32 v34, v34, v35
    v_add_f32 v32, v32, v34
    s_nop 1
    v_add_f32_dpp v2, v2, v2 quad_perm:[1,0,3,2] row_mask:0xf bank_mask:0xf
    s_nop 1
    v_add_f32_dpp v2, v2, v2 quad_perm:[2,3,0,1] row_mask:0xf bank_mask:0xf
    s_nop 1
    v_add_f32_dpp v2, v2, v2 row_half_mirror row_mask:0xf bank_mask:0xf
    s_nop 1
    v_add_f32_dpp v32, v32, v32 quad_perm:[1,0,3,2] row_mask:0xf bank_mask:0xf
    s_nop 1
    v_add_f32_dpp v32, v32, v32 quad_perm:[2,3,0,1] row_mask:0xf bank_mask:0xf
    s_nop 1
    v_add_f32_dpp v32, v32, v32 row_half_mirror row_mask:0xf bank_mask:0xf
    v_mul_f32 v2, s47, v2
    v_mul_f32 v32, s47, v32
    v_fma_f32 v32, -v2, v2, v32
    v_cvt_pk_bf16_f32 v3, v2, v2
    v_lshlrev_b32 v3, 16, v3
    v_cvt_pk_bf16_f32 v32, v32, v32
    v_lshlrev_b32 v32, 16, v32
    v_add_f32 v32, s96, v32
    v_cvt_pk_bf16_f32 v32, v32, v32
    v_lshlrev_b32 v32, 16, v32
    v_sqrt_f32 v32, v32
    s_nop 0
    v_cvt_pk_bf16_f32 v32, v32, v32
    v_lshlrev_b32 v32, 16, v32
    v_rcp_f32 v34, v32
    v_sub_f32 v6, 0, v3
    v_sub_f32 v7, 0, v3
    v_mov_b32 v35, v34
    v_lshlrev_b32 v128, 16, v96
    v_and_b32 v129, 0xffff0000, v96
    v_pk_add_f32 v[128:129], v[128:129], v[6:7]
    v_cvt_pk_bf16_f32 v36, v128, v129
    v_lshlrev_b32 v128, 16, v36
    v_and_b32 v129, 0xffff0000, v36
    v_pk_mul_f32 v[128:129], v[128:129], v[34:35]
    v_cvt_pk_bf16_f32 v36, v128, v129
    v_lshlrev_b32 v130, 16, v97
    v_and_b32 v131, 0xffff0000, v97
    v_pk_add_f32 v[130:131], v[130:131], v[6:7]
    v_cvt_pk_bf16_f32 v37, v130, v131
    v_lshlrev_b32 v130, 16, v37
    v_and_b32 v131, 0xffff0000, v37
    v_pk_mul_f32 v[130:131], v[130:131], v[34:35]
    v_cvt_pk_bf16_f32 v37, v130, v131
    v_lshlrev_b32 v132, 16, v98
    v_and_b32 v133, 0xffff0000, v98
    v_pk_add_f32 v[132:133], v[132:133], v[6:7]
    v_cvt_pk_bf16_f32 v38, v132, v133
    v_lshlrev_b32 v132, 16, v38
    v_and_b32 v133, 0xffff0000, v38
    v_pk_mul_f32 v[132:133], v[132:133], v[34:35]
    v_cvt_pk_bf16_f32 v38, v132, v133
    v_lshlrev_b32 v134, 16, v99
    v_and_b32 v135, 0xffff0000, v99
    v_pk_add_f32 v[134:135], v[134:135], v[6:7]
    v_cvt_pk_bf16_f32 v39, v134, v135
    v_lshlrev_b32 v134, 16, v39
    v_and_b32 v135, 0xffff0000, v39
    v_pk_mul_f32 v[134:135], v[134:135], v[34:35]
    v_cvt_pk_bf16_f32 v39, v134, v135
    buffer_store_dwordx4 v[36:39], v11, s[20:23], s80 offen
    s_nop 1
    v_mov_b32 v32, 0
    v_mov_b32 v48, 0
    v_mov_b32 v33, 0
    v_mov_b32 v49, 0
    v_mov_b32 v34, 0
    v_mov_b32 v50, 0
    v_mov_b32 v35, 0
    v_mov_b32 v51, 0
    v_mov_b32 v36, 0
    v_mov_b32 v52, 0
    v_mov_b32 v37, 0
    v_mov_b32 v53, 0
    v_mov_b32 v38, 0
    v_mov_b32 v54, 0
    v_mov_b32 v39, 0
    v_mov_b32 v55, 0
    v_mov_b32 v40, 0
    v_mov_b32 v56, 0
    v_mov_b32 v41, 0
    v_mov_b32 v57, 0
    v_mov_b32 v42, 0
    v_mov_b32 v58, 0
    v_mov_b32 v43, 0
    v_mov_b32 v59, 0
    v_mov_b32 v44, 0
    v_mov_b32 v60, 0
    v_mov_b32 v45, 0
    v_mov_b32 v61, 0
    v_mov_b32 v46, 0
    v_mov_b32 v62, 0
    v_mov_b32 v47, 0
    v_mov_b32 v63, 0
    s_waitcnt vmcnt(24)
    s_waitcnt lgkmcnt(0)
    s_barrier
    ds_read_b128 v[64:67], v16 offset:0
    ds_read_b128 v[80:83], v28 offset:0
    ds_read_b128 v[96:99], v28 offset:8192
    ds_read_b128 v[68:71], v17 offset:0
    ds_read_b128 v[84:87], v29 offset:0
    ds_read_b128 v[100:103], v29 offset:8192
    ds_read_b128 v[72:75], v18 offset:0
    ds_read_b128 v[88:91], v30 offset:0
    ds_read_b128 v[104:107], v30 offset:8192
    ds_read_b128 v[76:79], v19 offset:0
    ds_read_b128 v[92:95], v31 offset:0
    ds_read_b128 v[108:111], v31 offset:8192
    s_waitcnt vmcnt(20)
    s_waitcnt lgkmcnt(0)
    s_barrier
    s_mov_b32 s79, 512
    s_add_u32 m0, s44, 65536
    s_nop 0
    buffer_load_dwordx4 v14, s[8:11], s79 offen lds
    s_add_u32 m0, s44, 66560
    s_nop 0
    buffer_load_dwordx4 v15, s[8:11], s79 offen lds
    s_add_u32 m0, s44, 73728
    s_nop 0
    buffer_load_dwordx4 v14, s[12:15], s79 offen lds
    s_add_u32 m0, s44, 74752
    s_nop 0
    buffer_load_dwordx4 v15, s[12:15], s79 offen lds
    ds_read_b128 v[112:115], v16 offset:8192
    ds_read_b128 v[128:131], v28 offset:16384
    ds_read_b128 v[144:147], v28 offset:24576
    ds_read_b128 v[116:119], v17 offset:8192
    ds_read_b128 v[132:135], v29 offset:16384
    ds_read_b128 v[148:151], v29 offset:24576
    ds_read_b128 v[120:123], v18 offset:8192
    ds_read_b128 v[136:139], v30 offset:16384
    ds_read_b128 v[152:155], v30 offset:24576
    ds_read_b128 v[124:127], v19 offset:8192
    ds_read_b128 v[140:143], v31 offset:16384
    ds_read_b128 v[156:159], v31 offset:24576
    v_mfma_f32_32x32x16_bf16 v[32:47], v[64:67], v[80:83], v[32:47]
    v_mfma_f32_32x32x16_bf16 v[48:63], v[64:67], v[96:99], v[48:63]
    v_mfma_f32_32x32x16_bf16 v[32:47], v[68:71], v[84:87], v[32:47]
    v_mfma_f32_32x32x16_bf16 v[48:63], v[68:71], v[100:103], v[48:63]
    v_mfma_f32_32x32x16_bf16 v[32:47], v[72:75], v[88:91], v[32:47]
    v_mfma_f32_32x32x16_bf16 v[48:63], v[72:75], v[104:107], v[48:63]
    v_mfma_f32_32x32x16_bf16 v[32:47], v[76:79], v[92:95], v[32:47]
    v_mfma_f32_32x32x16_bf16 v[48:63], v[76:79], v[108:111], v[48:63]
    s_waitcnt vmcnt(20)
    s_waitcnt lgkmcnt(0)
    s_barrier
    s_mov_b32 s79, 640
    s_add_u32 m0, s44, 81920
    s_nop 0
    buffer_load_dwordx4 v14, s[8:11], s79 offen lds
    s_add_u32 m0, s44, 82944
    s_nop 0
    buffer_load_dwordx4 v15, s[8:11], s79 offen lds
    s_add_u32 m0, s44, 90112
    s_nop 0
    buffer_load_dwordx4 v14, s[12:15], s79 offen lds
    s_add_u32 m0, s44, 91136
    s_nop 0
    buffer_load_dwordx4 v15, s[12:15], s79 offen lds
    ds_read_b128 v[64:67], v16 offset:16384
    ds_read_b128 v[80:83], v28 offset:32768
    ds_read_b128 v[96:99], v28 offset:40960
    ds_read_b128 v[68:71], v17 offset:16384
    ds_read_b128 v[84:87], v29 offset:32768
    ds_read_b128 v[100:103], v29 offset:40960
    ds_read_b128 v[72:75], v18 offset:16384
    ds_read_b128 v[88:91], v30 offset:32768
    ds_read_b128 v[104:107], v30 offset:40960
    ds_read_b128 v[76:79], v19 offset:16384
    ds_read_b128 v[92:95], v31 offset:32768
    ds_read_b128 v[108:111], v31 offset:40960
    v_mfma_f32_32x32x16_bf16 v[32:47], v[112:115], v[128:131], v[32:47]
    v_mfma_f32_32x32x16_bf16 v[48:63], v[112:115], v[144:147], v[48:63]
    v_mfma_f32_32x32x16_bf16 v[32:47], v[116:119], v[132:135], v[32:47]
    v_mfma_f32_32x32x16_bf16 v[48:63], v[116:119], v[148:151], v[48:63]
    v_mfma_f32_32x32x16_bf16 v[32:47], v[120:123], v[136:139], v[32:47]
    v_mfma_f32_32x32x16_bf16 v[48:63], v[120:123], v[152:155], v[48:63]
    v_mfma_f32_32x32x16_bf16 v[32:47], v[124:127], v[140:143], v[32:47]
    v_mfma_f32_32x32x16_bf16 v[48:63], v[124:127], v[156:159], v[48:63]
    s_waitcnt vmcnt(20)
    s_waitcnt lgkmcnt(0)
    s_barrier
    s_mov_b32 s79, 768
    s_add_u32 m0, s44, 98304
    s_nop 0
    buffer_load_dwordx4 v14, s[8:11], s79 offen lds
    s_add_u32 m0, s44, 99328
    s_nop 0
    buffer_load_dwordx4 v15, s[8:11], s79 offen lds
    s_add_u32 m0, s44, 106496
    s_nop 0
    buffer_load_dwordx4 v14, s[12:15], s79 offen lds
    s_add_u32 m0, s44, 107520
    s_nop 0
    buffer_load_dwordx4 v15, s[12:15], s79 offen lds
    ds_read_b128 v[112:115], v16 offset:24576
    ds_read_b128 v[128:131], v28 offset:49152
    ds_read_b128 v[144:147], v28 offset:57344
    ds_read_b128 v[116:119], v17 offset:24576
    ds_read_b128 v[132:135], v29 offset:49152
    ds_read_b128 v[148:151], v29 offset:57344
    ds_read_b128 v[120:123], v18 offset:24576
    ds_read_b128 v[136:139], v30 offset:49152
    ds_read_b128 v[152:155], v30 offset:57344
    ds_read_b128 v[124:127], v19 offset:24576
    ds_read_b128 v[140:143], v31 offset:49152
    ds_read_b128 v[156:159], v31 offset:57344
    v_mfma_f32_32x32x16_bf16 v[32:47], v[64:67], v[80:83], v[32:47]
    v_mfma_f32_32x32x16_bf16 v[48:63], v[64:67], v[96:99], v[48:63]
    v_mfma_f32_32x32x16_bf16 v[32:47], v[68:71], v[84:87], v[32:47]
    v_mfma_f32_32x32x16_bf16 v[48:63], v[68:71], v[100:103], v[48:63]
    v_mfma_f32_32x32x16_bf16 v[32:47], v[72:75], v[88:91], v[32:47]
    v_mfma_f32_32x32x16_bf16 v[48:63], v[72:75], v[104:107], v[48:63]
    v_mfma_f32_32x32x16_bf16 v[32:47], v[76:79], v[92:95], v[32:47]
    v_mfma_f32_32x32x16_bf16 v[48:63], v[76:79], v[108:111], v[48:63]
    s_waitcnt vmcnt(8)
    s_waitcnt lgkmcnt(0)
    s_barrier
    s_mov_b32 s79, 896
    s_add_u32 m0, s44, 114688
    s_nop 0
    buffer_load_dwordx4 v14, s[8:11], s79 offen lds
    s_add_u32 m0, s44, 115712
    s_nop 0
    buffer_load_dwordx4 v15, s[8:11], s79 offen lds
    s_add_u32 m0, s44, 122880
    s_nop 0
    buffer_load_dwordx4 v14, s[12:15], s79 offen lds
    s_add_u32 m0, s44, 123904
    s_nop 0
    buffer_load_dwordx4 v15, s[12:15], s79 offen lds
    ds_read_b128 v[64:67], v16 offset:32768
    ds_read_b128 v[80:83], v28 offset:0
    ds_read_b128 v[96:99], v28 offset:8192
    ds_read_b128 v[68:71], v17 offset:32768
    ds_read_b128 v[84:87], v29 offset:0
    ds_read_b128 v[100:103], v29 offset:8192
    ds_read_b128 v[72:75], v18 offset:32768
    ds_read_b128 v[88:91], v30 offset:0
    ds_read_b128 v[104:107], v30 offset:8192
    ds_read_b128 v[76:79], v19 offset:32768
    ds_read_b128 v[92:95], v31 offset:0
    ds_read_b128 v[108:111], v31 offset:8192
    v_mfma_f32_32x32x16_bf16 v[32:47], v[112:115], v[128:131], v[32:47]
    v_mfma_f32_32x32x16_bf16 v[48:63], v[112:115], v[144:147], v[48:63]
    v_mfma_f32_32x32x16_bf16 v[32:47], v[116:119], v[132:135], v[32:47]
    v_mfma_f32_32x32x16_bf16 v[48:63], v[116:119], v[148:151], v[48:63]
    v_mfma_f32_32x32x16_bf16 v[32:47], v[120:123], v[136:139], v[32:47]
    v_mfma_f32_32x32x16_bf16 v[48:63], v[120:123], v[152:155], v[48:63]
    v_mfma_f32_32x32x16_bf16 v[32:47], v[124:127], v[140:143], v[32:47]
    v_mfma_f32_32x32x16_bf16 v[48:63], v[124:127], v[156:159], v[48:63]
    s_waitcnt vmcnt(8)
    s_waitcnt lgkmcnt(0)
    s_barrier
    ds_read_b128 v[112:115], v16 offset:40960
    ds_read_b128 v[128:131], v28 offset:16384
    ds_read_b128 v[144:147], v28 offset:24576
    ds_read_b128 v[116:119], v17 offset:40960
    ds_read_b128 v[132:135], v29 offset:16384
    ds_read_b128 v[148:151], v29 offset:24576
    ds_read_b128 v[120:123], v18 offset:40960
    ds_read_b128 v[136:139], v30 offset:16384
    ds_read_b128 v[152:155], v30 offset:24576
    ds_read_b128 v[124:127], v19 offset:40960
    ds_read_b128 v[140:143], v31 offset:16384
    ds_read_b128 v[156:159], v31 offset:24576
    v_mfma_f32_32x32x16_bf16 v[32:47], v[64:67], v[80:83], v[32:47]
    v_mfma_f32_32x32x16_bf16 v[48:63], v[64:67], v[96:99], v[48:63]
    v_mfma_f32_32x32x16_bf16 v[32:47], v[68:71], v[84:87], v[32:47]
    v_mfma_f32_32x32x16_bf16 v[48:63], v[68:71], v[100:103], v[48:63]
    v_mfma_f32_32x32x16_bf16 v[32:47], v[72:75], v[88:91], v[32:47]
    v_mfma_f32_32x32x16_bf16 v[48:63], v[72:75], v[104:107], v[48:63]
    v_mfma_f32_32x32x16_bf16 v[32:47], v[76:79], v[92:95], v[32:47]
    v_mfma_f32_32x32x16_bf16 v[48:63], v[76:79], v[108:111], v[48:63]
    s_waitcnt vmcnt(4)
    s_waitcnt lgkmcnt(0)
    s_barrier
    ds_read_b128 v[64:67], v16 offset:49152
    ds_read_b128 v[80:83], v28 offset:32768
    ds_read_b128 v[96:99], v28 offset:40960
    ds_read_b128 v[68:71], v17 offset:49152
    ds_read_b128 v[84:87], v29 offset:32768
    ds_read_b128 v[100:103], v29 offset:40960
    ds_read_b128 v[72:75], v18 offset:49152
    ds_read_b128 v[88:91], v30 offset:32768
    ds_read_b128 v[104:107], v30 offset:40960
    ds_read_b128 v[76:79], v19 offset:49152
    ds_read_b128 v[92:95], v31 offset:32768
    ds_read_b128 v[108:111], v31 offset:40960
    v_mfma_f32_32x32x16_bf16 v[32:47], v[112:115], v[128:131], v[32:47]
    v_mfma_f32_32x32x16_bf16 v[48:63], v[112:115], v[144:147], v[48:63]
    v_mfma_f32_32x32x16_bf16 v[32:47], v[116:119], v[132:135], v[32:47]
    v_mfma_f32_32x32x16_bf16 v[48:63], v[116:119], v[148:151], v[48:63]
    v_mfma_f32_32x32x16_bf16 v[32:47], v[120:123], v[136:139], v[32:47]
    v_mfma_f32_32x32x16_bf16 v[48:63], v[120:123], v[152:155], v[48:63]
    v_mfma_f32_32x32x16_bf16 v[32:47], v[124:127], v[140:143], v[32:47]
    v_mfma_f32_32x32x16_bf16 v[48:63], v[124:127], v[156:159], v[48:63]
    s_waitcnt vmcnt(0)
    s_waitcnt lgkmcnt(0)
    s_barrier
    ds_read_b128 v[112:115], v16 offset:57344
    ds_read_b128 v[128:131], v28 offset:49152
    ds_read_b128 v[144:147], v28 offset:57344
    ds_read_b128 v[116:119], v17 offset:57344
    ds_read_b128 v[132:135], v29 offset:49152
    ds_read_b128 v[148:151], v29 offset:57344
    ds_read_b128 v[120:123], v18 offset:57344
    ds_read_b128 v[136:139], v30 offset:49152
    ds_read_b128 v[152:155], v30 offset:57344
    ds_read_b128 v[124:127], v19 offset:57344
    ds_read_b128 v[140:143], v31 offset:49152
    ds_read_b128 v[156:159], v31 offset:57344
    v_mfma_f32_32x32x16_bf16 v[32:47], v[64:67], v[80:83], v[32:47]
    v_mfma_f32_32x32x16_bf16 v[48:63], v[64:67], v[96:99], v[48:63]
    v_mfma_f32_32x32x16_bf16 v[32:47], v[68:71], v[84:87], v[32:47]
    v_mfma_f32_32x32x16_bf16 v[48:63], v[68:71], v[100:103], v[48:63]
    v_mfma_f32_32x32x16_bf16 v[32:47], v[72:75], v[88:91], v[32:47]
    v_mfma_f32_32x32x16_bf16 v[48:63], v[72:75], v[104:107], v[48:63]
    v_mfma_f32_32x32x16_bf16 v[32:47], v[76:79], v[92:95], v[32:47]
    v_mfma_f32_32x32x16_bf16 v[48:63], v[76:79], v[108:111], v[48:63]
    s_waitcnt lgkmcnt(0)
    s_barrier
    v_mfma_f32_32x32x16_bf16 v[32:47], v[112:115], v[128:131], v[32:47]
    v_mfma_f32_32x32x16_bf16 v[48:63], v[112:115], v[144:147], v[48:63]
    v_mfma_f32_32x32x16_bf16 v[32:47], v[116:119], v[132:135], v[32:47]
    v_mfma_f32_32x32x16_bf16 v[48:63], v[116:119], v[148:151], v[48:63]
    v_mfma_f32_32x32x16_bf16 v[32:47], v[120:123], v[136:139], v[32:47]
    v_mfma_f32_32x32x16_bf16 v[48:63], v[120:123], v[152:155], v[48:63]
    v_mfma_f32_32x32x16_bf16 v[32:47], v[124:127], v[140:143], v[32:47]
    v_mfma_f32_32x32x16_bf16 v[48:63], v[124:127], v[156:159], v[48:63]
    v_and_b32 v10, 31, v1
    s_lshl_b32 s43, s42, 5
    v_add_u32 v10, s43, v10
    s_lshl_b32 s43, s34, 6
    v_add_u32 v11, s43, v10
    v_lshlrev_b32 v11, 1, v11
    buffer_load_ushort v16, v11, s[56:59], 0 offen
    buffer_load_ushort v17, v11, s[60:63], 0 offen
    buffer_load_ushort v18, v11, s[64:67], 0 offen
    s_waitcnt vmcnt(0)
    v_lshlrev_b32 v16, 16, v16
    v_lshlrev_b32 v17, 16, v17
    v_lshlrev_b32 v18, 16, v18
    s_mov_b32 s43, 1069066811
    v_mul_f32 v12, s43, v18
    v_exp_f32 v12, v12
    s_nop 0
    v_cvt_pk_bf16_f32 v12, v12, v12
    v_lshlrev_b32 v12, 16, v12
    v_mul_f32 v13, v12, v16
    v_mul_f32 v14, v12, v17
    v_mul_f32 v13, s43, v13
    v_exp_f32 v13, v13
    v_mul_f32 v14, 0.15915494, v14
    v_fract_f32 v15, v14
    v_cos_f32 v2, v15
    v_sin_f32 v3, v15
    s_nop 0
    v_mul_f32 v2, v2, v13
    v_mul_f32 v3, v3, v13
    v_add_f32 v12, -1.0, v2
    v_mul_f32 v13, v16, v16
    v_fma_f32 v13, v17, v17, v13
    v_rcp_f32 v13, v13
    v_mul_f32 v4, v12, v16
    v_fma_f32 v4, v3, v17, v4
    v_mul_f32 v5, v3, v16
    v_fma_f32 v5, -v12, v17, v5
    v_mul_f32 v4, v4, v13
    v_mul_f32 v5, v5, v13
    v_lshrrev_b32 v11, 5, v1
    v_lshlrev_b32 v11, 2, v11
    s_lshl_b32 s43, s41, 5
    v_add_u32 v11, s43, v11
    v_lshlrev_b32 v11, 9, v11
    v_lshlrev_b32 v10, 3, v10
    v_add_u32 v11, v11, v10
    s_barrier
    v_mul_f32 v6, v5, v48
    v_mul_f32 v7, v5, v32
    v_fma_f32 v32, v4, v32, -v6
    v_fma_f32 v48, v4, v48, v7
    v_mul_f32 v6, v5, v49
    v_mul_f32 v7, v5, v33
    v_fma_f32 v33, v4, v33, -v6
    v_fma_f32 v49, v4, v49, v7
    v_mul_f32 v6, v5, v50
    v_mul_f32 v7, v5, v34
    v_fma_f32 v34, v4, v34, -v6
    v_fma_f32 v50, v4, v50, v7
    v_mul_f32 v6, v5, v51
    v_mul_f32 v7, v5, v35
    v_fma_f32 v35, v4, v35, -v6
    v_fma_f32 v51, v4, v51, v7
    v_mul_f32 v6, v5, v52
    v_mul_f32 v7, v5, v36
    v_fma_f32 v36, v4, v36, -v6
    v_fma_f32 v52, v4, v52, v7
    v_mul_f32 v6, v5, v53
    v_mul_f32 v7, v5, v37
    v_fma_f32 v37, v4, v37, -v6
    v_fma_f32 v53, v4, v53, v7
    v_mul_f32 v6, v5, v54
    v_mul_f32 v7, v5, v38
    v_fma_f32 v38, v4, v38, -v6
    v_fma_f32 v54, v4, v54, v7
    v_mul_f32 v6, v5, v55
    v_mul_f32 v7, v5, v39
    v_fma_f32 v39, v4, v39, -v6
    v_fma_f32 v55, v4, v55, v7
    v_mul_f32 v6, v5, v56
    v_mul_f32 v7, v5, v40
    v_fma_f32 v40, v4, v40, -v6
    v_fma_f32 v56, v4, v56, v7
    v_mul_f32 v6, v5, v57
    v_mul_f32 v7, v5, v41
    v_fma_f32 v41, v4, v41, -v6
    v_fma_f32 v57, v4, v57, v7
    v_mul_f32 v6, v5, v58
    v_mul_f32 v7, v5, v42
    v_fma_f32 v42, v4, v42, -v6
    v_fma_f32 v58, v4, v58, v7
    v_mul_f32 v6, v5, v59
    v_mul_f32 v7, v5, v43
    v_fma_f32 v43, v4, v43, -v6
    v_fma_f32 v59, v4, v59, v7
    v_mul_f32 v6, v5, v60
    v_mul_f32 v7, v5, v44
    v_fma_f32 v44, v4, v44, -v6
    v_fma_f32 v60, v4, v60, v7
    v_mul_f32 v6, v5, v61
    v_mul_f32 v7, v5, v45
    v_fma_f32 v45, v4, v45, -v6
    v_fma_f32 v61, v4, v61, v7
    v_mul_f32 v6, v5, v62
    v_mul_f32 v7, v5, v46
    v_fma_f32 v46, v4, v46, -v6
    v_fma_f32 v62, v4, v62, v7
    v_mul_f32 v6, v5, v63
    v_mul_f32 v7, v5, v47
    v_fma_f32 v47, v4, v47, -v6
    v_fma_f32 v63, v4, v63, v7
    v_mov_b32 v6, v32
    v_mov_b32 v7, v48
    ds_write_b64 v11, v[6:7] offset:0
    v_mov_b32 v6, v33
    v_mov_b32 v7, v49
    ds_write_b64 v11, v[6:7] offset:512
    v_mov_b32 v6, v34
    v_mov_b32 v7, v50
    ds_write_b64 v11, v[6:7] offset:1024
    v_mov_b32 v6, v35
    v_mov_b32 v7, v51
    ds_write_b64 v11, v[6:7] offset:1536
    v_mov_b32 v6, v36
    v_mov_b32 v7, v52
    ds_write_b64 v11, v[6:7] offset:4096
    v_mov_b32 v6, v37
    v_mov_b32 v7, v53
    ds_write_b64 v11, v[6:7] offset:4608
    v_mov_b32 v6, v38
    v_mov_b32 v7, v54
    ds_write_b64 v11, v[6:7] offset:5120
    v_mov_b32 v6, v39
    v_mov_b32 v7, v55
    ds_write_b64 v11, v[6:7] offset:5632
    v_mov_b32 v6, v40
    v_mov_b32 v7, v56
    ds_write_b64 v11, v[6:7] offset:8192
    v_mov_b32 v6, v41
    v_mov_b32 v7, v57
    ds_write_b64 v11, v[6:7] offset:8704
    v_mov_b32 v6, v42
    v_mov_b32 v7, v58
    ds_write_b64 v11, v[6:7] offset:9216
    v_mov_b32 v6, v43
    v_mov_b32 v7, v59
    ds_write_b64 v11, v[6:7] offset:9728
    v_mov_b32 v6, v44
    v_mov_b32 v7, v60
    ds_write_b64 v11, v[6:7] offset:12288
    v_mov_b32 v6, v45
    v_mov_b32 v7, v61
    ds_write_b64 v11, v[6:7] offset:12800
    v_mov_b32 v6, v46
    v_mov_b32 v7, v62
    ds_write_b64 v11, v[6:7] offset:13312
    v_mov_b32 v6, v47
    v_mov_b32 v7, v63
    ds_write_b64 v11, v[6:7] offset:13824
    s_lshl_b32 s43, s34, 6
    v_add_u32 v10, s43, v1
    v_lshlrev_b32 v10, 1, v10
    buffer_load_ushort v16, v10, s[56:59], 0 offen
    buffer_load_ushort v17, v10, s[60:63], 0 offen
    buffer_load_ushort v18, v10, s[64:67], 0 offen
    s_waitcnt vmcnt(0)
    v_lshlrev_b32 v16, 16, v16
    v_lshlrev_b32 v17, 16, v17
    v_lshlrev_b32 v18, 16, v18
    s_mov_b32 s43, 1069066811
    v_mul_f32 v12, s43, v18
    v_exp_f32 v12, v12
    s_nop 0
    v_cvt_pk_bf16_f32 v12, v12, v12
    v_lshlrev_b32 v12, 16, v12
    v_mul_f32 v13, v12, v16
    v_mul_f32 v14, v12, v17
    v_mul_f32 v13, s43, v13
    v_exp_f32 v13, v13
    v_mul_f32 v14, 0.15915494, v14
    v_fract_f32 v15, v14
    v_cos_f32 v2, v15
    v_sin_f32 v3, v15
    s_nop 0
    v_mul_f32 v2, v2, v13
    v_mul_f32 v3, v3, v13
    s_waitcnt lgkmcnt(0)
    s_barrier
    s_lshl_b32 s43, s40, 13
    v_lshlrev_b32 v10, 3, v1
    v_add_u32 v10, s43, v10
    ds_read_b64 v[64:65], v10 offset:0
    ds_read_b64 v[66:67], v10 offset:512
    ds_read_b64 v[68:69], v10 offset:1024
    ds_read_b64 v[70:71], v10 offset:1536
    ds_read_b64 v[72:73], v10 offset:2048
    ds_read_b64 v[74:75], v10 offset:2560
    ds_read_b64 v[76:77], v10 offset:3072
    ds_read_b64 v[78:79], v10 offset:3584
    ds_read_b64 v[80:81], v10 offset:4096
    ds_read_b64 v[82:83], v10 offset:4608
    ds_read_b64 v[84:85], v10 offset:5120
    ds_read_b64 v[86:87], v10 offset:5632
    ds_read_b64 v[88:89], v10 offset:6144
    ds_read_b64 v[90:91], v10 offset:6656
    ds_read_b64 v[92:93], v10 offset:7168
    ds_read_b64 v[94:95], v10 offset:7680
    v_mov_b32 v6, 0
    v_mov_b32 v7, 0
    s_waitcnt lgkmcnt(15)
    v_fma_f32 v8, -v3, v7, v64
    v_fma_f32 v9, v3, v6, v65
    v_fma_f32 v6, v2, v6, v8
    v_fma_f32 v7, v2, v7, v9
    s_waitcnt lgkmcnt(14)
    v_fma_f32 v8, -v3, v7, v66
    v_fma_f32 v9, v3, v6, v67
    v_fma_f32 v6, v2, v6, v8
    v_fma_f32 v7, v2, v7, v9
    s_waitcnt lgkmcnt(13)
    v_fma_f32 v8, -v3, v7, v68
    v_fma_f32 v9, v3, v6, v69
    v_fma_f32 v6, v2, v6, v8
    v_fma_f32 v7, v2, v7, v9
    s_waitcnt lgkmcnt(12)
    v_fma_f32 v8, -v3, v7, v70
    v_fma_f32 v9, v3, v6, v71
    v_fma_f32 v6, v2, v6, v8
    v_fma_f32 v7, v2, v7, v9
    s_waitcnt lgkmcnt(11)
    v_fma_f32 v8, -v3, v7, v72
    v_fma_f32 v9, v3, v6, v73
    v_fma_f32 v6, v2, v6, v8
    v_fma_f32 v7, v2, v7, v9
    s_waitcnt lgkmcnt(10)
    v_fma_f32 v8, -v3, v7, v74
    v_fma_f32 v9, v3, v6, v75
    v_fma_f32 v6, v2, v6, v8
    v_fma_f32 v7, v2, v7, v9
    s_waitcnt lgkmcnt(9)
    v_fma_f32 v8, -v3, v7, v76
    v_fma_f32 v9, v3, v6, v77
    v_fma_f32 v6, v2, v6, v8
    v_fma_f32 v7, v2, v7, v9
    s_waitcnt lgkmcnt(8)
    v_fma_f32 v8, -v3, v7, v78
    v_fma_f32 v9, v3, v6, v79
    v_fma_f32 v6, v2, v6, v8
    v_fma_f32 v7, v2, v7, v9
    s_waitcnt lgkmcnt(7)
    v_fma_f32 v8, -v3, v7, v80
    v_fma_f32 v9, v3, v6, v81
    v_fma_f32 v6, v2, v6, v8
    v_fma_f32 v7, v2, v7, v9
    s_waitcnt lgkmcnt(6)
    v_fma_f32 v8, -v3, v7, v82
    v_fma_f32 v9, v3, v6, v83
    v_fma_f32 v6, v2, v6, v8
    v_fma_f32 v7, v2, v7, v9
    s_waitcnt lgkmcnt(5)
    v_fma_f32 v8, -v3, v7, v84
    v_fma_f32 v9, v3, v6, v85
    v_fma_f32 v6, v2, v6, v8
    v_fma_f32 v7, v2, v7, v9
    s_waitcnt lgkmcnt(4)
    v_fma_f32 v8, -v3, v7, v86
    v_fma_f32 v9, v3, v6, v87
    v_fma_f32 v6, v2, v6, v8
    v_fma_f32 v7, v2, v7, v9
    s_waitcnt lgkmcnt(3)
    v_fma_f32 v8, -v3, v7, v88
    v_fma_f32 v9, v3, v6, v89
    v_fma_f32 v6, v2, v6, v8
    v_fma_f32 v7, v2, v7, v9
    s_waitcnt lgkmcnt(2)
    v_fma_f32 v8, -v3, v7, v90
    v_fma_f32 v9, v3, v6, v91
    v_fma_f32 v6, v2, v6, v8
    v_fma_f32 v7, v2, v7, v9
    s_waitcnt lgkmcnt(1)
    v_fma_f32 v8, -v3, v7, v92
    v_fma_f32 v9, v3, v6, v93
    v_fma_f32 v6, v2, v6, v8
    v_fma_f32 v7, v2, v7, v9
    s_waitcnt lgkmcnt(0)
    v_fma_f32 v8, -v3, v7, v94
    v_fma_f32 v9, v3, v6, v95
    v_fma_f32 v6, v2, v6, v8
    v_fma_f32 v7, v2, v7, v9
    s_lshl_b32 s43, s40, 9
    v_lshlrev_b32 v11, 3, v1
    v_add_u32 v13, s43, v11
    ds_write_b64 v13, v[6:7] offset:32768
    v_mov_b32 v14, v2
    v_mov_b32 v15, v3
    v_mul_f32 v8, v15, v15
    v_mul_f32 v9, v14, v15
    v_fma_f32 v14, v14, v14, -v8
    v_add_f32 v15, v9, v9
    v_mul_f32 v8, v15, v15
    v_mul_f32 v9, v14, v15
    v_fma_f32 v14, v14, v14, -v8
    v_add_f32 v15, v9, v9
    v_mul_f32 v8, v15, v15
    v_mul_f32 v9, v14, v15
    v_fma_f32 v14, v14, v14, -v8
    v_add_f32 v15, v9, v9
    v_mul_f32 v8, v15, v15
    v_mul_f32 v9, v14, v15
    v_fma_f32 v14, v14, v14, -v8
    v_add_f32 v15, v9, v9
    s_waitcnt lgkmcnt(0)
    s_barrier
    ds_read_b64 v[16:17], v11 offset:32768
    ds_read_b64 v[18:19], v11 offset:33280
    ds_read_b64 v[20:21], v11 offset:33792
    v_mov_b32 v6, 0
    v_mov_b32 v7, 0
    s_waitcnt lgkmcnt(0)
    s_cmp_le_u32 s40, 0
    s_cbranch_scc1 k1_carry_done
    v_fma_f32 v8, -v15, v7, v16
    v_fma_f32 v9, v15, v6, v17
    v_fma_f32 v6, v14, v6, v8
    v_fma_f32 v7, v14, v7, v9
    s_cmp_le_u32 s40, 1
    s_cbranch_scc1 k1_carry_done
    v_fma_f32 v8, -v15, v7, v18
    v_fma_f32 v9, v15, v6, v19
    v_fma_f32 v6, v14, v6, v8
    v_fma_f32 v7, v14, v7, v9
    s_cmp_le_u32 s40, 2
    s_cbranch_scc1 k1_carry_done
    v_fma_f32 v8, -v15, v7, v20
    v_fma_f32 v9, v15, v6, v21
    v_fma_f32 v6, v14, v6, v8
    v_fma_f32 v7, v14, v7, v9
k1_carry_done:
    s_lshl_b32 s43, s33, 6
    s_lshl_b32 s45, s40, 4
    s_add_u32 s43, s43, s45
    s_lshl_b32 s43, s43, 12
    s_lshl_b32 s45, s34, 8
    s_add_u32 s43, s43, s45
    v_lshlrev_b32 v12, 2, v1
    v_add_u32 v12, s43, v12
    v_fma_f32 v8, -v3, v7, v64
    v_fma_f32 v9, v3, v6, v65
    v_fma_f32 v6, v2, v6, v8
    v_fma_f32 v7, v2, v7, v9
    s_mov_b32 s43, 0
    buffer_store_dword v6, v12, s[48:51], s43 offen
    buffer_store_dword v7, v12, s[48:51], s43 offen offset:2048
    v_fma_f32 v8, -v3, v7, v66
    v_fma_f32 v9, v3, v6, v67
    v_fma_f32 v6, v2, v6, v8
    v_fma_f32 v7, v2, v7, v9
    s_mov_b32 s43, 4096
    buffer_store_dword v6, v12, s[48:51], s43 offen
    buffer_store_dword v7, v12, s[48:51], s43 offen offset:2048
    v_fma_f32 v8, -v3, v7, v68
    v_fma_f32 v9, v3, v6, v69
    v_fma_f32 v6, v2, v6, v8
    v_fma_f32 v7, v2, v7, v9
    s_mov_b32 s43, 8192
    buffer_store_dword v6, v12, s[48:51], s43 offen
    buffer_store_dword v7, v12, s[48:51], s43 offen offset:2048
    v_fma_f32 v8, -v3, v7, v70
    v_fma_f32 v9, v3, v6, v71
    v_fma_f32 v6, v2, v6, v8
    v_fma_f32 v7, v2, v7, v9
    s_mov_b32 s43, 12288
    buffer_store_dword v6, v12, s[48:51], s43 offen
    buffer_store_dword v7, v12, s[48:51], s43 offen offset:2048
    v_fma_f32 v8, -v3, v7, v72
    v_fma_f32 v9, v3, v6, v73
    v_fma_f32 v6, v2, v6, v8
    v_fma_f32 v7, v2, v7, v9
    s_mov_b32 s43, 16384
    buffer_store_dword v6, v12, s[48:51], s43 offen
    buffer_store_dword v7, v12, s[48:51], s43 offen offset:2048
    v_fma_f32 v8, -v3, v7, v74
    v_fma_f32 v9, v3, v6, v75
    v_fma_f32 v6, v2, v6, v8
    v_fma_f32 v7, v2, v7, v9
    s_mov_b32 s43, 20480
    buffer_store_dword v6, v12, s[48:51], s43 offen
    buffer_store_dword v7, v12, s[48:51], s43 offen offset:2048
    v_fma_f32 v8, -v3, v7, v76
    v_fma_f32 v9, v3, v6, v77
    v_fma_f32 v6, v2, v6, v8
    v_fma_f32 v7, v2, v7, v9
    s_mov_b32 s43, 24576
    buffer_store_dword v6, v12, s[48:51], s43 offen
    buffer_store_dword v7, v12, s[48:51], s43 offen offset:2048
    v_fma_f32 v8, -v3, v7, v78
    v_fma_f32 v9, v3, v6, v79
    v_fma_f32 v6, v2, v6, v8
    v_fma_f32 v7, v2, v7, v9
    s_mov_b32 s43, 28672
    buffer_store_dword v6, v12, s[48:51], s43 offen
    buffer_store_dword v7, v12, s[48:51], s43 offen offset:2048
    v_fma_f32 v8, -v3, v7, v80
    v_fma_f32 v9, v3, v6, v81
    v_fma_f32 v6, v2, v6, v8
    v_fma_f32 v7, v2, v7, v9
    s_mov_b32 s43, 32768
    buffer_store_dword v6, v12, s[48:51], s43 offen
    buffer_store_dword v7, v12, s[48:51], s43 offen offset:2048
    v_fma_f32 v8, -v3, v7, v82
    v_fma_f32 v9, v3, v6, v83
    v_fma_f32 v6, v2, v6, v8
    v_fma_f32 v7, v2, v7, v9
    s_mov_b32 s43, 36864
    buffer_store_dword v6, v12, s[48:51], s43 offen
    buffer_store_dword v7, v12, s[48:51], s43 offen offset:2048
    v_fma_f32 v8, -v3, v7, v84
    v_fma_f32 v9, v3, v6, v85
    v_fma_f32 v6, v2, v6, v8
    v_fma_f32 v7, v2, v7, v9
    s_mov_b32 s43, 40960
    buffer_store_dword v6, v12, s[48:51], s43 offen
    buffer_store_dword v7, v12, s[48:51], s43 offen offset:2048
    v_fma_f32 v8, -v3, v7, v86
    v_fma_f32 v9, v3, v6, v87
    v_fma_f32 v6, v2, v6, v8
    v_fma_f32 v7, v2, v7, v9
    s_mov_b32 s43, 45056
    buffer_store_dword v6, v12, s[48:51], s43 offen
    buffer_store_dword v7, v12, s[48:51], s43 offen offset:2048
    v_fma_f32 v8, -v3, v7, v88
    v_fma_f32 v9, v3, v6, v89
    v_fma_f32 v6, v2, v6, v8
    v_fma_f32 v7, v2, v7, v9
    s_mov_b32 s43, 49152
    buffer_store_dword v6, v12, s[48:51], s43 offen
    buffer_store_dword v7, v12, s[48:51], s43 offen offset:2048
    v_fma_f32 v8, -v3, v7, v90
    v_fma_f32 v9, v3, v6, v91
    v_fma_f32 v6, v2, v6, v8
    v_fma_f32 v7, v2, v7, v9
    s_mov_b32 s43, 53248
    buffer_store_dword v6, v12, s[48:51], s43 offen
    buffer_store_dword v7, v12, s[48:51], s43 offen offset:2048
    v_fma_f32 v8, -v3, v7, v92
    v_fma_f32 v9, v3, v6, v93
    v_fma_f32 v6, v2, v6, v8
    v_fma_f32 v7, v2, v7, v9
    s_mov_b32 s43, 57344
    buffer_store_dword v6, v12, s[48:51], s43 offen
    buffer_store_dword v7, v12, s[48:51], s43 offen offset:2048
    v_fma_f32 v8, -v3, v7, v94
    v_fma_f32 v9, v3, v6, v95
    v_fma_f32 v6, v2, v6, v8
    v_fma_f32 v7, v2, v7, v9
    s_mov_b32 s43, 61440
    buffer_store_dword v6, v12, s[48:51], s43 offen
    buffer_store_dword v7, v12, s[48:51], s43 offen offset:2048
    s_cmp_eq_u32 s40, 3
    s_cbranch_scc0 k1_end
    s_lshl_b32 s43, s33, 12
    s_lshl_b32 s45, s34, 8
    s_add_u32 s43, s43, s45
    v_lshlrev_b32 v12, 2, v1
    v_add_u32 v12, s43, v12
    buffer_store_dword v6, v12, s[52:55], 0 offen
    buffer_store_dword v7, v12, s[52:55], 0 offen offset:2048
k1_end:
    s_endpgm
.section .rodata,"a"
.p2align 6
.amdhsa_kernel k1_kernel
  .amdhsa_next_free_vgpr 256
  .amdhsa_next_free_sgpr 102
  .amdhsa_accum_offset 256
  .amdhsa_group_segment_fixed_size 0
  .amdhsa_kernarg_size 136
  .amdhsa_user_sgpr_count 2
  .amdhsa_user_sgpr_kernarg_segment_ptr 1
  .amdhsa_system_sgpr_workgroup_id_x 1
.end_amdhsa_kernel
.text
.globl k2_kernel
.p2align 8
.type k2_kernel,@function
k2_kernel:
    s_cmp_ge_u32 s2, 256
    s_cbranch_scc1 k2_end
    s_load_dwordx2 s[24:25], s[0:1], 80
    s_load_dwordx2 s[26:27], s[0:1], 88
    s_load_dwordx2 s[28:29], s[0:1], 128
    s_load_dwordx4 s[48:51], s[0:1], 8
    s_load_dwordx2 s[52:53], s[0:1], 56
    s_and_b32 s30, s2, 7
    s_lshr_b32 s31, s2, 3
    s_lshr_b32 s32, s31, 3
    s_and_b32 s33, s31, 7
    s_lshl_b32 s34, s32, 3
    s_add_u32 s34, s34, s30
    v_and_b32 v1, 63, v0
    v_lshrrev_b32 v2, 6, v0
    s_nop 0
    v_readfirstlane_b32 s40, v2
    s_and_b32 s41, s40, 1
    s_lshr_b32 s42, s40, 1
    s_waitcnt lgkmcnt(0)
    s_load_dwordx2 s[96:97], s[0:1], 96
    v_lshrrev_b32 v2, 5, v0
    v_and_b32 v3, 31, v0
    v_lshlrev_b32 v3, 4, v3
    s_mul_i32 s43, s31, 56
    v_add_u32 v2, s43, v2
    v_lshlrev_b32 v2, 12, v2
    v_add_u32 v2, v2, v3
    s_lshl_b32 s43, s30, 9
    v_add_u32 v2, s43, v2
    s_waitcnt lgkmcnt(0)
    s_mov_b32 s96, s96
    s_mov_b32 s97, s97
    s_and_b32 s97, s97, 0xffff
    s_mov_b32 s98, 7340032
    s_mov_b32 s99, 0x00020000
    s_mov_b32 s43, 0
    buffer_load_dwordx4 v[224:227], v2, s[96:99], s43 offen
    s_mov_b32 s43, 32768
    buffer_load_dwordx4 v[228:231], v2, s[96:99], s43 offen
    s_mov_b32 s43, 65536
    buffer_load_dwordx4 v[232:235], v2, s[96:99], s43 offen
    s_mov_b32 s43, 98304
    buffer_load_dwordx4 v[236:239], v2, s[96:99], s43 offen
    s_mov_b32 s43, 131072
    buffer_load_dwordx4 v[224:227], v2, s[96:99], s43 offen
    s_mov_b32 s43, 163840
    buffer_load_dwordx4 v[228:231], v2, s[96:99], s43 offen
    s_mov_b32 s43, 196608
    buffer_load_dwordx4 v[232:235], v2, s[96:99], s43 offen
    s_cmp_ge_u32 s30, 4
    s_cbranch_scc0 k2_gemm
    s_cmp_ge_u32 s31, 24
    s_cbranch_scc1 k2_fixup
k2_gemm:
    s_add_u32 s4, s28, 2097152
    s_addc_u32 s5, s29, 0
    s_and_b32 s5, s5, 0xffff
    s_mov_b32 s6, 2097152
    s_mov_b32 s7, 0x00020000
    s_mov_b32 s8, s24
    s_mov_b32 s9, s25
    s_and_b32 s9, s9, 0xffff
    s_mov_b32 s10, 7340032
    s_mov_b32 s11, 0x00020000
    s_add_u32 s12, s28, 17825792
    s_addc_u32 s13, s29, 0
    s_and_b32 s13, s13, 0xffff
    s_mov_b32 s14, 1835008
    s_mov_b32 s15, 0x00020000
    s_mov_b32 s16, s26
    s_mov_b32 s17, s27
    s_and_b32 s17, s17, 0xffff
    s_mov_b32 s18, 3584
    s_mov_b32 s19, 0x00020000
    s_lshl_b32 s45, s33, 7
    s_lshl_b32 s46, s34, 7
    v_lshrrev_b32 v2, 3, v1
    s_lshl_b32 s43, s40, 4
    v_add_u32 v2, s43, v2
    v_and_b32 v3, 7, v1
    v_lshrrev_b32 v4, 1, v2
    v_and_b32 v4, 1, v4
    v_lshlrev_b32 v4, 2, v4
    v_xor_b32 v3, v3, v4
    v_lshlrev_b32 v3, 4, v3
    s_mov_b32 s43, 1024
    v_mul_lo_u32 v2, v2, s43
    v_add_u32 v10, v2, v3
    v_add_u32 v10, s45, v10
    v_lshrrev_b32 v2, 3, v1
    s_lshl_b32 s43, s40, 4
    s_add_u32 s43, s43, 8
    v_add_u32 v2, s43, v2
    v_and_b32 v3, 7, v1
    v_lshrrev_b32 v4, 1, v2
    v_and_b32 v4, 1, v4
    v_lshlrev_b32 v4, 2, v4
    v_xor_b32 v3, v3, v4
    v_lshlrev_b32 v3, 4, v3
    s_mov_b32 s43, 1024
    v_mul_lo_u32 v2, v2, s43
    v_add_u32 v11, v2, v3
    v_add_u32 v11, s45, v11
    v_lshrrev_b32 v2, 3, v1
    s_lshl_b32 s43, s40, 4
    v_add_u32 v2, s43, v2
    v_and_b32 v3, 7, v1
    v_lshrrev_b32 v4, 1, v2
    v_and_b32 v4, 1, v4
    v_lshlrev_b32 v4, 2, v4
    v_xor_b32 v3, v3, v4
    v_lshlrev_b32 v3, 4, v3
    s_mov_b32 s43, 3584
    v_mul_lo_u32 v2, v2, s43
    v_add_u32 v12, v2, v3
    v_add_u32 v12, s46, v12
    v_lshrrev_b32 v2, 3, v1
    s_lshl_b32 s43, s40, 4
    s_add_u32 s43, s43, 8
    v_add_u32 v2, s43, v2
    v_and_b32 v3, 7, v1
    v_lshrrev_b32 v4, 1, v2
    v_and_b32 v4, 1, v4
    v_lshlrev_b32 v4, 2, v4
    v_xor_b32 v3, v3, v4
    v_lshlrev_b32 v3, 4, v3
    s_mov_b32 s43, 3584
    v_mul_lo_u32 v2, v2, s43
    v_add_u32 v13, v2, v3
    v_add_u32 v13, s46, v13
    v_lshrrev_b32 v2, 4, v1
    v_and_b32 v3, 15, v1
    v_lshrrev_b32 v4, 2, v3
    v_and_b32 v5, 3, v3
    v_lshrrev_b32 v14, 1, v2
    v_lshlrev_b32 v14, 3, v14
    v_add_u32 v14, v14, v4
    v_lshlrev_b32 v14, 7, v14
    v_and_b32 v2, 1, v2
    v_lshlrev_b32 v2, 1, v2
    v_lshrrev_b32 v3, 1, v5
    v_add_u32 v2, v2, v3
    s_lshl_b32 s43, s41, 2
    v_add_u32 v2, s43, v2
    v_lshrrev_b32 v4, 1, v4
    v_and_b32 v4, 1, v4
    v_lshlrev_b32 v4, 2, v4
    v_xor_b32 v2, v2, v4
    v_lshlrev_b32 v2, 4, v2
    v_add_u32 v14, v14, v2
    v_and_b32 v5, 1, v5
    v_lshlrev_b32 v5, 3, v5
    v_add_u32 v14, v14, v5
    v_add_u32 v15, 0x10000, v14
    v_lshrrev_b32 v2, 4, v1
    v_and_b32 v3, 15, v1
    v_lshrrev_b32 v4, 2, v3
    v_and_b32 v5, 3, v3
    v_lshrrev_b32 v16, 1, v2
    v_lshlrev_b32 v16, 3, v16
    v_add_u32 v16, v16, v4
    v_lshlrev_b32 v16, 7, v16
    v_and_b32 v2, 1, v2
    v_lshlrev_b32 v2, 1, v2
    v_lshrrev_b32 v3, 1, v5
    v_add_u32 v2, v2, v3
    s_lshl_b32 s43, s42, 2
    v_add_u32 v2, s43, v2
    v_lshrrev_b32 v4, 1, v4
    v_and_b32 v4, 1, v4
    v_lshlrev_b32 v4, 2, v4
    v_xor_b32 v2, v2, v4
    v_lshlrev_b32 v2, 4, v2
    v_add_u32 v16, v16, v2
    v_and_b32 v5, 1, v5
    v_lshlrev_b32 v5, 3, v5
    v_add_u32 v16, v16, v5
    v_add_u32 v17, 0x10000, v16
    s_lshl_b32 s44, s40, 11
    v_and_b32 v2, 31, v1
    s_lshl_b32 s43, s42, 5
    v_add_u32 v2, s43, v2
    s_lshl_b32 s43, s34, 6
    v_add_u32 v21, s43, v2
    v_lshlrev_b32 v2, 1, v21
    buffer_load_ushort v20, v2, s[16:19], 0 offen
    v_mov_b32 v32, 0
    v_mov_b32 v33, 0
    v_mov_b32 v34, 0
    v_mov_b32 v35, 0
    v_mov_b32 v36, 0
    v_mov_b32 v37, 0
    v_mov_b32 v38, 0
    v_mov_b32 v39, 0
    v_mov_b32 v40, 0
    v_mov_b32 v41, 0
    v_mov_b32 v42, 0
    v_mov_b32 v43, 0
    v_mov_b32 v44, 0
    v_mov_b32 v45, 0
    v_mov_b32 v46, 0
    v_mov_b32 v47, 0
    s_mov_b32 s20, 0
    s_mov_b32 s21, 0
    s_add_u32 m0, s44, 0
    s_nop 0
    buffer_load_dwordx4 v10, s[4:7], s20 offen lds
    s_add_u32 m0, s44, 1024
    s_nop 0
    buffer_load_dwordx4 v11, s[4:7], s20 offen lds
    s_add_u32 m0, s44, 8192
    s_nop 0
    buffer_load_dwordx4 v12, s[8:11], s21 offen lds
    s_add_u32 m0, s44, 9216
    s_nop 0
    buffer_load_dwordx4 v13, s[8:11], s21 offen lds
    s_mov_b32 s20, 65536
    s_mov_b32 s21, 229376
    s_add_u32 m0, s44, 16384
    s_nop 0
    buffer_load_dwordx4 v10, s[4:7], s20 offen lds
    s_add_u32 m0, s44, 17408
    s_nop 0
    buffer_load_dwordx4 v11, s[4:7], s20 offen lds
    s_add_u32 m0, s44, 24576
    s_nop 0
    buffer_load_dwordx4 v12, s[8:11], s21 offen lds
    s_add_u32 m0, s44, 25600
    s_nop 0
    buffer_load_dwordx4 v13, s[8:11], s21 offen lds
    s_mov_b32 s20, 131072
    s_mov_b32 s21, 458752
    s_add_u32 m0, s44, 32768
    s_nop 0
    buffer_load_dwordx4 v10, s[4:7], s20 offen lds
    s_add_u32 m0, s44, 33792
    s_nop 0
    buffer_load_dwordx4 v11, s[4:7], s20 offen lds
    s_add_u32 m0, s44, 40960
    s_nop 0
    buffer_load_dwordx4 v12, s[8:11], s21 offen lds
    s_add_u32 m0, s44, 41984
    s_nop 0
    buffer_load_dwordx4 v13, s[8:11], s21 offen lds
    s_mov_b32 s20, 196608
    s_mov_b32 s21, 688128
    s_add_u32 m0, s44, 49152
    s_nop 0
    buffer_load_dwordx4 v10, s[4:7], s20 offen lds
    s_add_u32 m0, s44, 50176
    s_nop 0
    buffer_load_dwordx4 v11, s[4:7], s20 offen lds
    s_add_u32 m0, s44, 57344
    s_nop 0
    buffer_load_dwordx4 v12, s[8:11], s21 offen lds
    s_add_u32 m0, s44, 58368
    s_nop 0
    buffer_load_dwordx4 v13, s[8:11], s21 offen lds
    s_mov_b32 s20, 262144
    s_mov_b32 s21, 917504
    s_add_u32 m0, s44, 65536
    s_nop 0
    buffer_load_dwordx4 v10, s[4:7], s20 offen lds
    s_add_u32 m0, s44, 66560
    s_nop 0
    buffer_load_dwordx4 v11, s[4:7], s20 offen lds
    s_add_u32 m0, s44, 73728
    s_nop 0
    buffer_load_dwordx4 v12, s[8:11], s21 offen lds
    s_add_u32 m0, s44, 74752
    s_nop 0
    buffer_load_dwordx4 v13, s[8:11], s21 offen lds
    s_mov_b32 s20, 327680
    s_mov_b32 s21, 1146880
    s_add_u32 m0, s44, 81920
    s_nop 0
    buffer_load_dwordx4 v10, s[4:7], s20 offen lds
    s_add_u32 m0, s44, 82944
    s_nop 0
    buffer_load_dwordx4 v11, s[4:7], s20 offen lds
    s_add_u32 m0, s44, 90112
    s_nop 0
    buffer_load_dwordx4 v12, s[8:11], s21 offen lds
    s_add_u32 m0, s44, 91136
    s_nop 0
    buffer_load_dwordx4 v13, s[8:11], s21 offen lds
    s_mov_b32 s20, 393216
    s_mov_b32 s21, 1376256
    s_add_u32 m0, s44, 98304
    s_nop 0
    buffer_load_dwordx4 v10, s[4:7], s20 offen lds
    s_add_u32 m0, s44, 99328
    s_nop 0
    buffer_load_dwordx4 v11, s[4:7], s20 offen lds
    s_add_u32 m0, s44, 106496
    s_nop 0
    buffer_load_dwordx4 v12, s[8:11], s21 offen lds
    s_add_u32 m0, s44, 107520
    s_nop 0
    buffer_load_dwordx4 v13, s[8:11], s21 offen lds
    s_mov_b32 s20, 458752
    s_mov_b32 s21, 1605632
    s_add_u32 m0, s44, 114688
    s_nop 0
    buffer_load_dwordx4 v10, s[4:7], s20 offen lds
    s_add_u32 m0, s44, 115712
    s_nop 0
    buffer_load_dwordx4 v11, s[4:7], s20 offen lds
    s_add_u32 m0, s44, 122880
    s_nop 0
    buffer_load_dwordx4 v12, s[8:11], s21 offen lds
    s_add_u32 m0, s44, 123904
    s_nop 0
    buffer_load_dwordx4 v13, s[8:11], s21 offen lds
    s_waitcnt vmcnt(28)
    s_barrier
    ds_read_b64_tr_b16 v[64:65], v14 offset:0
    ds_read_b64_tr_b16 v[80:81], v16 offset:8192
    ds_read_b64_tr_b16 v[66:67], v14 offset:512
    ds_read_b64_tr_b16 v[82:83], v16 offset:8704
    ds_read_b64_tr_b16 v[68:69], v14 offset:2048
    ds_read_b64_tr_b16 v[84:85], v16 offset:10240
    ds_read_b64_tr_b16 v[70:71], v14 offset:2560
    ds_read_b64_tr_b16 v[86:87], v16 offset:10752
    ds_read_b64_tr_b16 v[72:73], v14 offset:4096
    ds_read_b64_tr_b16 v[88:89], v16 offset:12288
    ds_read_b64_tr_b16 v[74:75], v14 offset:4608
    ds_read_b64_tr_b16 v[90:91], v16 offset:12800
    ds_read_b64_tr_b16 v[76:77], v14 offset:6144
    ds_read_b64_tr_b16 v[92:93], v16 offset:14336
    ds_read_b64_tr_b16 v[78:79], v14 offset:6656
    ds_read_b64_tr_b16 v[94:95], v16 offset:14848
    s_waitcnt vmcnt(24)
    s_waitcnt lgkmcnt(0)
    s_barrier
    s_mov_b32 s20, 524288
    s_mov_b32 s21, 1835008
    s_add_u32 m0, s44, 0
    s_nop 0
    buffer_load_dwordx4 v10, s[4:7], s20 offen lds
    s_add_u32 m0, s44, 1024
    s_nop 0
    buffer_load_dwordx4 v11, s[4:7], s20 offen lds
    s_add_u32 m0, s44, 8192
    s_nop 0
    buffer_load_dwordx4 v12, s[8:11], s21 offen lds
    s_add_u32 m0, s44, 9216
    s_nop 0
    buffer_load_dwordx4 v13, s[8:11], s21 offen lds
    ds_read_b64_tr_b16 v[96:97], v14 offset:16384
    ds_read_b64_tr_b16 v[112:113], v16 offset:24576
    ds_read_b64_tr_b16 v[98:99], v14 offset:16896
    ds_read_b64_tr_b16 v[114:115], v16 offset:25088
    ds_read_b64_tr_b16 v[100:101], v14 offset:18432
    ds_read_b64_tr_b16 v[116:117], v16 offset:26624
    ds_read_b64_tr_b16 v[102:103], v14 offset:18944
    ds_read_b64_tr_b16 v[118:119], v16 offset:27136
    ds_read_b64_tr_b16 v[104:105], v14 offset:20480
    ds_read_b64_tr_b16 v[120:121], v16 offset:28672
    ds_read_b64_tr_b16 v[106:107], v14 offset:20992
    ds_read_b64_tr_b16 v[122:123], v16 offset:29184
    ds_read_b64_tr_b16 v[108:109], v14 offset:22528
    ds_read_b64_tr_b16 v[124:125], v16 offset:30720
    ds_read_b64_tr_b16 v[110:111], v14 offset:23040
    ds_read_b64_tr_b16 v[126:127], v16 offset:31232
    v_mfma_f32_32x32x16_bf16 v[32:47], v[64:67], v[80:83], v[32:47]
    v_mfma_f32_32x32x16_bf16 v[32:47], v[68:71], v[84:87], v[32:47]
    v_mfma_f32_32x32x16_bf16 v[32:47], v[72:75], v[88:91], v[32:47]
    v_mfma_f32_32x32x16_bf16 v[32:47], v[76:79], v[92:95], v[32:47]
    s_waitcnt vmcnt(24)
    s_waitcnt lgkmcnt(0)
    s_barrier
    s_mov_b32 s20, 589824
    s_mov_b32 s21, 2064384
    s_add_u32 m0, s44, 16384
    s_nop 0
    buffer_load_dwordx4 v10, s[4:7], s20 offen lds
    s_add_u32 m0, s44, 17408
    s_nop 0
    buffer_load_dwordx4 v11, s[4:7], s20 offen lds
    s_add_u32 m0, s44, 24576
    s_nop 0
    buffer_load_dwordx4 v12, s[8:11], s21 offen lds
    s_add_u32 m0, s44, 25600
    s_nop 0
    buffer_load_dwordx4 v13, s[8:11], s21 offen lds
    ds_read_b64_tr_b16 v[64:65], v14 offset:32768
    ds_read_b64_tr_b16 v[80:81], v16 offset:40960
    ds_read_b64_tr_b16 v[66:67], v14 offset:33280
    ds_read_b64_tr_b16 v[82:83], v16 offset:41472
    ds_read_b64_tr_b16 v[68:69], v14 offset:34816
    ds_read_b64_tr_b16 v[84:85], v16 offset:43008
    ds_read_b64_tr_b16 v[70:71], v14 offset:35328
    ds_read_b64_tr_b16 v[86:87], v16 offset:43520
    ds_read_b64_tr_b16 v[72:73], v14 offset:36864
    ds_read_b64_tr_b16 v[88:89], v16 offset:45056
    ds_read_b64_tr_b16 v[74:75], v14 offset:37376
    ds_read_b64_tr_b16 v[90:91], v16 offset:45568
    ds_read_b64_tr_b16 v[76:77], v14 offset:38912
    ds_read_b64_tr_b16 v[92:93], v16 offset:47104
    ds_read_b64_tr_b16 v[78:79], v14 offset:39424
    ds_read_b64_tr_b16 v[94:95], v16 offset:47616
    v_mfma_f32_32x32x16_bf16 v[32:47], v[96:99], v[112:115], v[32:47]
    v_mfma_f32_32x32x16_bf16 v[32:47], v[100:103], v[116:119], v[32:47]
    v_mfma_f32_32x32x16_bf16 v[32:47], v[104:107], v[120:123], v[32:47]
    v_mfma_f32_32x32x16_bf16 v[32:47], v[108:111], v[124:127], v[32:47]
    s_waitcnt vmcnt(24)
    s_waitcnt lgkmcnt(0)
    s_barrier
    s_mov_b32 s20, 655360
    s_mov_b32 s21, 2293760
    s_add_u32 m0, s44, 32768
    s_nop 0
    buffer_load_dwordx4 v10, s[4:7], s20 offen lds
    s_add_u32 m0, s44, 33792
    s_nop 0
    buffer_load_dwordx4 v11, s[4:7], s20 offen lds
    s_add_u32 m0, s44, 40960
    s_nop 0
    buffer_load_dwordx4 v12, s[8:11], s21 offen lds
    s_add_u32 m0, s44, 41984
    s_nop 0
    buffer_load_dwordx4 v13, s[8:11], s21 offen lds
    ds_read_b64_tr_b16 v[96:97], v14 offset:49152
    ds_read_b64_tr_b16 v[112:113], v16 offset:57344
    ds_read_b64_tr_b16 v[98:99], v14 offset:49664
    ds_read_b64_tr_b16 v[114:115], v16 offset:57856
    ds_read_b64_tr_b16 v[100:101], v14 offset:51200
    ds_read_b64_tr_b16 v[116:117], v16 offset:59392
    ds_read_b64_tr_b16 v[102:103], v14 offset:51712
    ds_read_b64_tr_b16 v[118:119], v16 offset:59904
    ds_read_b64_tr_b16 v[104:105], v14 offset:53248
    ds_read_b64_tr_b16 v[120:121], v16 offset:61440
    ds_read_b64_tr_b16 v[106:107], v14 offset:53760
    ds_read_b64_tr_b16 v[122:123], v16 offset:61952
    ds_read_b64_tr_b16 v[108:109], v14 offset:55296
    ds_read_b64_tr_b16 v[124:125], v16 offset:63488
    ds_read_b64_tr_b16 v[110:111], v14 offset:55808
    ds_read_b64_tr_b16 v[126:127], v16 offset:64000
    v_mfma_f32_32x32x16_bf16 v[32:47], v[64:67], v[80:83], v[32:47]
    v_mfma_f32_32x32x16_bf16 v[32:47], v[68:71], v[84:87], v[32:47]
    v_mfma_f32_32x32x16_bf16 v[32:47], v[72:75], v[88:91], v[32:47]
    v_mfma_f32_32x32x16_bf16 v[32:47], v[76:79], v[92:95], v[32:47]
    s_waitcnt vmcnt(24)
    s_waitcnt lgkmcnt(0)
    s_barrier
    s_mov_b32 s20, 720896
    s_mov_b32 s21, 2523136
    s_add_u32 m0, s44, 49152
    s_nop 0
    buffer_load_dwordx4 v10, s[4:7], s20 offen lds
    s_add_u32 m0, s44, 50176
    s_nop 0
    buffer_load_dwordx4 v11, s[4:7], s20 offen lds
    s_add_u32 m0, s44, 57344
    s_nop 0
    buffer_load_dwordx4 v12, s[8:11], s21 offen lds
    s_add_u32 m0, s44, 58368
    s_nop 0
    buffer_load_dwordx4 v13, s[8:11], s21 offen lds
    ds_read_b64_tr_b16 v[64:65], v15 offset:0
    ds_read_b64_tr_b16 v[80:81], v17 offset:8192
    ds_read_b64_tr_b16 v[66:67], v15 offset:512
    ds_read_b64_tr_b16 v[82:83], v17 offset:8704
    ds_read_b64_tr_b16 v[68:69], v15 offset:2048
    ds_read_b64_tr_b16 v[84:85], v17 offset:10240
    ds_read_b64_tr_b16 v[70:71], v15 offset:2560
    ds_read_b64_tr_b16 v[86:87], v17 offset:10752
    ds_read_b64_tr_b16 v[72:73], v15 offset:4096
    ds_read_b64_tr_b16 v[88:89], v17 offset:12288
    ds_read_b64_tr_b16 v[74:75], v15 offset:4608
    ds_read_b64_tr_b16 v[90:91], v17 offset:12800
    ds_read_b64_tr_b16 v[76:77], v15 offset:6144
    ds_read_b64_tr_b16 v[92:93], v17 offset:14336
    ds_read_b64_tr_b16 v[78:79], v15 offset:6656
    ds_read_b64_tr_b16 v[94:95], v17 offset:14848
    v_mfma_f32_32x32x16_bf16 v[32:47], v[96:99], v[112:115], v[32:47]
    v_mfma_f32_32x32x16_bf16 v[32:47], v[100:103], v[116:119], v[32:47]
    v_mfma_f32_32x32x16_bf16 v[32:47], v[104:107], v[120:123], v[32:47]
    v_mfma_f32_32x32x16_bf16 v[32:47], v[108:111], v[124:127], v[32:47]
    s_waitcnt vmcnt(24)
    s_waitcnt lgkmcnt(0)
    s_barrier
    s_mov_b32 s20, 786432
    s_mov_b32 s21, 2752512
    s_add_u32 m0, s44, 65536
    s_nop 0
    buffer_load_dwordx4 v10, s[4:7], s20 offen lds
    s_add_u32 m0, s44, 66560
    s_nop 0
    buffer_load_dwordx4 v11, s[4:7], s20 offen lds
    s_add_u32 m0, s44, 73728
    s_nop 0
    buffer_load_dwordx4 v12, s[8:11], s21 offen lds
    s_add_u32 m0, s44, 74752
    s_nop 0
    buffer_load_dwordx4 v13, s[8:11], s21 offen lds
    ds_read_b64_tr_b16 v[96:97], v15 offset:16384
    ds_read_b64_tr_b16 v[112:113], v17 offset:24576
    ds_read_b64_tr_b16 v[98:99], v15 offset:16896
    ds_read_b64_tr_b16 v[114:115], v17 offset:25088
    ds_read_b64_tr_b16 v[100:101], v15 offset:18432
    ds_read_b64_tr_b16 v[116:117], v17 offset:26624
    ds_read_b64_tr_b16 v[102:103], v15 offset:18944
    ds_read_b64_tr_b16 v[118:119], v17 offset:27136
    ds_read_b64_tr_b16 v[104:105], v15 offset:20480
    ds_read_b64_tr_b16 v[120:121], v17 offset:28672
    ds_read_b64_tr_b16 v[106:107], v15 offset:20992
    ds_read_b64_tr_b16 v[122:123], v17 offset:29184
    ds_read_b64_tr_b16 v[108:109], v15 offset:22528
    ds_read_b64_tr_b16 v[124:125], v17 offset:30720
    ds_read_b64_tr_b16 v[110:111], v15 offset:23040
    ds_read_b64_tr_b16 v[126:127], v17 offset:31232
    v_mfma_f32_32x32x16_bf16 v[32:47], v[64:67], v[80:83], v[32:47]
    v_mfma_f32_32x32x16_bf16 v[32:47], v[68:71], v[84:87], v[32:47]
    v_mfma_f32_32x32x16_bf16 v[32:47], v[72:75], v[88:91], v[32:47]
    v_mfma_f32_32x32x16_bf16 v[32:47], v[76:79], v[92:95], v[32:47]
    s_waitcnt vmcnt(24)
    s_waitcnt lgkmcnt(0)
    s_barrier
    s_mov_b32 s20, 851968
    s_mov_b32 s21, 2981888
    s_add_u32 m0, s44, 81920
    s_nop 0
    buffer_load_dwordx4 v10, s[4:7], s20 offen lds
    s_add_u32 m0, s44, 82944
    s_nop 0
    buffer_load_dwordx4 v11, s[4:7], s20 offen lds
    s_add_u32 m0, s44, 90112
    s_nop 0
    buffer_load_dwordx4 v12, s[8:11], s21 offen lds
    s_add_u32 m0, s44, 91136
    s_nop 0
    buffer_load_dwordx4 v13, s[8:11], s21 offen lds
    ds_read_b64_tr_b16 v[64:65], v15 offset:32768
    ds_read_b64_tr_b16 v[80:81], v17 offset:40960
    ds_read_b64_tr_b16 v[66:67], v15 offset:33280
    ds_read_b64_tr_b16 v[82:83], v17 offset:41472
    ds_read_b64_tr_b16 v[68:69], v15 offset:34816
    ds_read_b64_tr_b16 v[84:85], v17 offset:43008
    ds_read_b64_tr_b16 v[70:71], v15 offset:35328
    ds_read_b64_tr_b16 v[86:87], v17 offset:43520
    ds_read_b64_tr_b16 v[72:73], v15 offset:36864
    ds_read_b64_tr_b16 v[88:89], v17 offset:45056
    ds_read_b64_tr_b16 v[74:75], v15 offset:37376
    ds_read_b64_tr_b16 v[90:91], v17 offset:45568
    ds_read_b64_tr_b16 v[76:77], v15 offset:38912
    ds_read_b64_tr_b16 v[92:93], v17 offset:47104
    ds_read_b64_tr_b16 v[78:79], v15 offset:39424
    ds_read_b64_tr_b16 v[94:95], v17 offset:47616
    v_mfma_f32_32x32x16_bf16 v[32:47], v[96:99], v[112:115], v[32:47]
    v_mfma_f32_32x32x16_bf16 v[32:47], v[100:103], v[116:119], v[32:47]
    v_mfma_f32_32x32x16_bf16 v[32:47], v[104:107], v[120:123], v[32:47]
    v_mfma_f32_32x32x16_bf16 v[32:47], v[108:111], v[124:127], v[32:47]
    s_waitcnt vmcnt(24)
    s_waitcnt lgkmcnt(0)
    s_barrier
    s_mov_b32 s20, 917504
    s_mov_b32 s21, 3211264
    s_add_u32 m0, s44, 98304
    s_nop 0
    buffer_load_dwordx4 v10, s[4:7], s20 offen lds
    s_add_u32 m0, s44, 99328
    s_nop 0
    buffer_load_dwordx4 v11, s[4:7], s20 offen lds
    s_add_u32 m0, s44, 106496
    s_nop 0
    buffer_load_dwordx4 v12, s[8:11], s21 offen lds
    s_add_u32 m0, s44, 107520
    s_nop 0
    buffer_load_dwordx4 v13, s[8:11], s21 offen lds
    ds_read_b64_tr_b16 v[96:97], v15 offset:49152
    ds_read_b64_tr_b16 v[112:113], v17 offset:57344
    ds_read_b64_tr_b16 v[98:99], v15 offset:49664
    ds_read_b64_tr_b16 v[114:115], v17 offset:57856
    ds_read_b64_tr_b16 v[100:101], v15 offset:51200
    ds_read_b64_tr_b16 v[116:117], v17 offset:59392
    ds_read_b64_tr_b16 v[102:103], v15 offset:51712
    ds_read_b64_tr_b16 v[118:119], v17 offset:59904
    ds_read_b64_tr_b16 v[104:105], v15 offset:53248
    ds_read_b64_tr_b16 v[120:121], v17 offset:61440
    ds_read_b64_tr_b16 v[106:107], v15 offset:53760
    ds_read_b64_tr_b16 v[122:123], v17 offset:61952
    ds_read_b64_tr_b16 v[108:109], v15 offset:55296
    ds_read_b64_tr_b16 v[124:125], v17 offset:63488
    ds_read_b64_tr_b16 v[110:111], v15 offset:55808
    ds_read_b64_tr_b16 v[126:127], v17 offset:64000
    v_mfma_f32_32x32x16_bf16 v[32:47], v[64:67], v[80:83], v[32:47]
    v_mfma_f32_32x32x16_bf16 v[32:47], v[68:71], v[84:87], v[32:47]
    v_mfma_f32_32x32x16_bf16 v[32:47], v[72:75], v[88:91], v[32:47]
    v_mfma_f32_32x32x16_bf16 v[32:47], v[76:79], v[92:95], v[32:47]
    s_waitcnt vmcnt(24)
    s_waitcnt lgkmcnt(0)
    s_barrier
    s_mov_b32 s20, 983040
    s_mov_b32 s21, 3440640
    s_add_u32 m0, s44, 114688
    s_nop 0
    buffer_load_dwordx4 v10, s[4:7], s20 offen lds
    s_add_u32 m0, s44, 115712
    s_nop 0
    buffer_load_dwordx4 v11, s[4:7], s20 offen lds
    s_add_u32 m0, s44, 122880
    s_nop 0
    buffer_load_dwordx4 v12, s[8:11], s21 offen lds
    s_add_u32 m0, s44, 123904
    s_nop 0
    buffer_load_dwordx4 v13, s[8:11], s21 offen lds
    ds_read_b64_tr_b16 v[64:65], v14 offset:0
    ds_read_b64_tr_b16 v[80:81], v16 offset:8192
    ds_read_b64_tr_b16 v[66:67], v14 offset:512
    ds_read_b64_tr_b16 v[82:83], v16 offset:8704
    ds_read_b64_tr_b16 v[68:69], v14 offset:2048
    ds_read_b64_tr_b16 v[84:85], v16 offset:10240
    ds_read_b64_tr_b16 v[70:71], v14 offset:2560
    ds_read_b64_tr_b16 v[86:87], v16 offset:10752
    ds_read_b64_tr_b16 v[72:73], v14 offset:4096
    ds_read_b64_tr_b16 v[88:89], v16 offset:12288
    ds_read_b64_tr_b16 v[74:75], v14 offset:4608
    ds_read_b64_tr_b16 v[90:91], v16 offset:12800
    ds_read_b64_tr_b16 v[76:77], v14 offset:6144
    ds_read_b64_tr_b16 v[92:93], v16 offset:14336
    ds_read_b64_tr_b16 v[78:79], v14 offset:6656
    ds_read_b64_tr_b16 v[94:95], v16 offset:14848
    v_mfma_f32_32x32x16_bf16 v[32:47], v[96:99], v[112:115], v[32:47]
    v_mfma_f32_32x32x16_bf16 v[32:47], v[100:103], v[116:119], v[32:47]
    v_mfma_f32_32x32x16_bf16 v[32:47], v[104:107], v[120:123], v[32:47]
    v_mfma_f32_32x32x16_bf16 v[32:47], v[108:111], v[124:127], v[32:47]
    s_waitcnt vmcnt(24)
    s_waitcnt lgkmcnt(0)
    s_barrier
    s_mov_b32 s20, 1048576
    s_mov_b32 s21, 3670016
    s_add_u32 m0, s44, 0
    s_nop 0
    buffer_load_dwordx4 v10, s[4:7], s20 offen lds
    s_add_u32 m0, s44, 1024
    s_nop 0
    buffer_load_dwordx4 v11, s[4:7], s20 offen lds
    s_add_u32 m0, s44, 8192
    s_nop 0
    buffer_load_dwordx4 v12, s[8:11], s21 offen lds
    s_add_u32 m0, s44, 9216
    s_nop 0
    buffer_load_dwordx4 v13, s[8:11], s21 offen lds
    ds_read_b64_tr_b16 v[96:97], v14 offset:16384
    ds_read_b64_tr_b16 v[112:113], v16 offset:24576
    ds_read_b64_tr_b16 v[98:99], v14 offset:16896
    ds_read_b64_tr_b16 v[114:115], v16 offset:25088
    ds_read_b64_tr_b16 v[100:101], v14 offset:18432
    ds_read_b64_tr_b16 v[116:117], v16 offset:26624
    ds_read_b64_tr_b16 v[102:103], v14 offset:18944
    ds_read_b64_tr_b16 v[118:119], v16 offset:27136
    ds_read_b64_tr_b16 v[104:105], v14 offset:20480
    ds_read_b64_tr_b16 v[120:121], v16 offset:28672
    ds_read_b64_tr_b16 v[106:107], v14 offset:20992
    ds_read_b64_tr_b16 v[122:123], v16 offset:29184
    ds_read_b64_tr_b16 v[108:109], v14 offset:22528
    ds_read_b64_tr_b16 v[124:125], v16 offset:30720
    ds_read_b64_tr_b16 v[110:111], v14 offset:23040
    ds_read_b64_tr_b16 v[126:127], v16 offset:31232
    v_mfma_f32_32x32x16_bf16 v[32:47], v[64:67], v[80:83], v[32:47]
    v_mfma_f32_32x32x16_bf16 v[32:47], v[68:71], v[84:87], v[32:47]
    v_mfma_f32_32x32x16_bf16 v[32:47], v[72:75], v[88:91], v[32:47]
    v_mfma_f32_32x32x16_bf16 v[32:47], v[76:79], v[92:95], v[32:47]
    s_waitcnt vmcnt(24)
    s_waitcnt lgkmcnt(0)
    s_barrier
    s_mov_b32 s20, 1114112
    s_mov_b32 s21, 3899392
    s_add_u32 m0, s44, 16384
    s_nop 0
    buffer_load_dwordx4 v10, s[4:7], s20 offen lds
    s_add_u32 m0, s44, 17408
    s_nop 0
    buffer_load_dwordx4 v11, s[4:7], s20 offen lds
    s_add_u32 m0, s44, 24576
    s_nop 0
    buffer_load_dwordx4 v12, s[8:11], s21 offen lds
    s_add_u32 m0, s44, 25600
    s_nop 0
    buffer_load_dwordx4 v13, s[8:11], s21 offen lds
    ds_read_b64_tr_b16 v[64:65], v14 offset:32768
    ds_read_b64_tr_b16 v[80:81], v16 offset:40960
    ds_read_b64_tr_b16 v[66:67], v14 offset:33280
    ds_read_b64_tr_b16 v[82:83], v16 offset:41472
    ds_read_b64_tr_b16 v[68:69], v14 offset:34816
    ds_read_b64_tr_b16 v[84:85], v16 offset:43008
    ds_read_b64_tr_b16 v[70:71], v14 offset:35328
    ds_read_b64_tr_b16 v[86:87], v16 offset:43520
    ds_read_b64_tr_b16 v[72:73], v14 offset:36864
    ds_read_b64_tr_b16 v[88:89], v16 offset:45056
    ds_read_b64_tr_b16 v[74:75], v14 offset:37376
    ds_read_b64_tr_b16 v[90:91], v16 offset:45568
    ds_read_b64_tr_b16 v[76:77], v14 offset:38912
    ds_read_b64_tr_b16 v[92:93], v16 offset:47104
    ds_read_b64_tr_b16 v[78:79], v14 offset:39424
    ds_read_b64_tr_b16 v[94:95], v16 offset:47616
    v_mfma_f32_32x32x16_bf16 v[32:47], v[96:99], v[112:115], v[32:47]
    v_mfma_f32_32x32x16_bf16 v[32:47], v[100:103], v[116:119], v[32:47]
    v_mfma_f32_32x32x16_bf16 v[32:47], v[104:107], v[120:123], v[32:47]
    v_mfma_f32_32x32x16_bf16 v[32:47], v[108:111], v[124:127], v[32:47]
    s_waitcnt vmcnt(24)
    s_waitcnt lgkmcnt(0)
    s_barrier
    s_mov_b32 s20, 1179648
    s_mov_b32 s21, 4128768
    s_add_u32 m0, s44, 32768
    s_nop 0
    buffer_load_dwordx4 v10, s[4:7], s20 offen lds
    s_add_u32 m0, s44, 33792
    s_nop 0
    buffer_load_dwordx4 v11, s[4:7], s20 offen lds
    s_add_u32 m0, s44, 40960
    s_nop 0
    buffer_load_dwordx4 v12, s[8:11], s21 offen lds
    s_add_u32 m0, s44, 41984
    s_nop 0
    buffer_load_dwordx4 v13, s[8:11], s21 offen lds
    ds_read_b64_tr_b16 v[96:97], v14 offset:49152
    ds_read_b64_tr_b16 v[112:113], v16 offset:57344
    ds_read_b64_tr_b16 v[98:99], v14 offset:49664
    ds_read_b64_tr_b16 v[114:115], v16 offset:57856
    ds_read_b64_tr_b16 v[100:101], v14 offset:51200
    ds_read_b64_tr_b16 v[116:117], v16 offset:59392
    ds_read_b64_tr_b16 v[102:103], v14 offset:51712
    ds_read_b64_tr_b16 v[118:119], v16 offset:59904
    ds_read_b64_tr_b16 v[104:105], v14 offset:53248
    ds_read_b64_tr_b16 v[120:121], v16 offset:61440
    ds_read_b64_tr_b16 v[106:107], v14 offset:53760
    ds_read_b64_tr_b16 v[122:123], v16 offset:61952
    ds_read_b64_tr_b16 v[108:109], v14 offset:55296
    ds_read_b64_tr_b16 v[124:125], v16 offset:63488
    ds_read_b64_tr_b16 v[110:111], v14 offset:55808
    ds_read_b64_tr_b16 v[126:127], v16 offset:64000
    v_mfma_f32_32x32x16_bf16 v[32:47], v[64:67], v[80:83], v[32:47]
    v_mfma_f32_32x32x16_bf16 v[32:47], v[68:71], v[84:87], v[32:47]
    v_mfma_f32_32x32x16_bf16 v[32:47], v[72:75], v[88:91], v[32:47]
    v_mfma_f32_32x32x16_bf16 v[32:47], v[76:79], v[92:95], v[32:47]
    s_waitcnt vmcnt(24)
    s_waitcnt lgkmcnt(0)
    s_barrier
    s_mov_b32 s20, 1245184
    s_mov_b32 s21, 4358144
    s_add_u32 m0, s44, 49152
    s_nop 0
    buffer_load_dwordx4 v10, s[4:7], s20 offen lds
    s_add_u32 m0, s44, 50176
    s_nop 0
    buffer_load_dwordx4 v11, s[4:7], s20 offen lds
    s_add_u32 m0, s44, 57344
    s_nop 0
    buffer_load_dwordx4 v12, s[8:11], s21 offen lds
    s_add_u32 m0, s44, 58368
    s_nop 0
    buffer_load_dwordx4 v13, s[8:11], s21 offen lds
    ds_read_b64_tr_b16 v[64:65], v15 offset:0
    ds_read_b64_tr_b16 v[80:81], v17 offset:8192
    ds_read_b64_tr_b16 v[66:67], v15 offset:512
    ds_read_b64_tr_b16 v[82:83], v17 offset:8704
    ds_read_b64_tr_b16 v[68:69], v15 offset:2048
    ds_read_b64_tr_b16 v[84:85], v17 offset:10240
    ds_read_b64_tr_b16 v[70:71], v15 offset:2560
    ds_read_b64_tr_b16 v[86:87], v17 offset:10752
    ds_read_b64_tr_b16 v[72:73], v15 offset:4096
    ds_read_b64_tr_b16 v[88:89], v17 offset:12288
    ds_read_b64_tr_b16 v[74:75], v15 offset:4608
    ds_read_b64_tr_b16 v[90:91], v17 offset:12800
    ds_read_b64_tr_b16 v[76:77], v15 offset:6144
    ds_read_b64_tr_b16 v[92:93], v17 offset:14336
    ds_read_b64_tr_b16 v[78:79], v15 offset:6656
    ds_read_b64_tr_b16 v[94:95], v17 offset:14848
    v_mfma_f32_32x32x16_bf16 v[32:47], v[96:99], v[112:115], v[32:47]
    v_mfma_f32_32x32x16_bf16 v[32:47], v[100:103], v[116:119], v[32:47]
    v_mfma_f32_32x32x16_bf16 v[32:47], v[104:107], v[120:123], v[32:47]
    v_mfma_f32_32x32x16_bf16 v[32:47], v[108:111], v[124:127], v[32:47]
    s_waitcnt vmcnt(24)
    s_waitcnt lgkmcnt(0)
    s_barrier
    s_mov_b32 s20, 1310720
    s_mov_b32 s21, 4587520
    s_add_u32 m0, s44, 65536
    s_nop 0
    buffer_load_dwordx4 v10, s[4:7], s20 offen lds
    s_add_u32 m0, s44, 66560
    s_nop 0
    buffer_load_dwordx4 v11, s[4:7], s20 offen lds
    s_add_u32 m0, s44, 73728
    s_nop 0
    buffer_load_dwordx4 v12, s[8:11], s21 offen lds
    s_add_u32 m0, s44, 74752
    s_nop 0
    buffer_load_dwordx4 v13, s[8:11], s21 offen lds
    ds_read_b64_tr_b16 v[96:97], v15 offset:16384
    ds_read_b64_tr_b16 v[112:113], v17 offset:24576
    ds_read_b64_tr_b16 v[98:99], v15 offset:16896
    ds_read_b64_tr_b16 v[114:115], v17 offset:25088
    ds_read_b64_tr_b16 v[100:101], v15 offset:18432
    ds_read_b64_tr_b16 v[116:117], v17 offset:26624
    ds_read_b64_tr_b16 v[102:103], v15 offset:18944
    ds_read_b64_tr_b16 v[118:119], v17 offset:27136
    ds_read_b64_tr_b16 v[104:105], v15 offset:20480
    ds_read_b64_tr_b16 v[120:121], v17 offset:28672
    ds_read_b64_tr_b16 v[106:107], v15 offset:20992
    ds_read_b64_tr_b16 v[122:123], v17 offset:29184
    ds_read_b64_tr_b16 v[108:109], v15 offset:22528
    ds_read_b64_tr_b16 v[124:125], v17 offset:30720
    ds_read_b64_tr_b16 v[110:111], v15 offset:23040
    ds_read_b64_tr_b16 v[126:127], v17 offset:31232
    v_mfma_f32_32x32x16_bf16 v[32:47], v[64:67], v[80:83], v[32:47]
    v_mfma_f32_32x32x16_bf16 v[32:47], v[68:71], v[84:87], v[32:47]
    v_mfma_f32_32x32x16_bf16 v[32:47], v[72:75], v[88:91], v[32:47]
    v_mfma_f32_32x32x16_bf16 v[32:47], v[76:79], v[92:95], v[32:47]
    s_waitcnt vmcnt(24)
    s_waitcnt lgkmcnt(0)
    s_barrier
    s_mov_b32 s20, 1376256
    s_mov_b32 s21, 4816896
    s_add_u32 m0, s44, 81920
    s_nop 0
    buffer_load_dwordx4 v10, s[4:7], s20 offen lds
    s_add_u32 m0, s44, 82944
    s_nop 0
    buffer_load_dwordx4 v11, s[4:7], s20 offen lds
    s_add_u32 m0, s44, 90112
    s_nop 0
    buffer_load_dwordx4 v12, s[8:11], s21 offen lds
    s_add_u32 m0, s44, 91136
    s_nop 0
    buffer_load_dwordx4 v13, s[8:11], s21 offen lds
    ds_read_b64_tr_b16 v[64:65], v15 offset:32768
    ds_read_b64_tr_b16 v[80:81], v17 offset:40960
    ds_read_b64_tr_b16 v[66:67], v15 offset:33280
    ds_read_b64_tr_b16 v[82:83], v17 offset:41472
    ds_read_b64_tr_b16 v[68:69], v15 offset:34816
    ds_read_b64_tr_b16 v[84:85], v17 offset:43008
    ds_read_b64_tr_b16 v[70:71], v15 offset:35328
    ds_read_b64_tr_b16 v[86:87], v17 offset:43520
    ds_read_b64_tr_b16 v[72:73], v15 offset:36864
    ds_read_b64_tr_b16 v[88:89], v17 offset:45056
    ds_read_b64_tr_b16 v[74:75], v15 offset:37376
    ds_read_b64_tr_b16 v[90:91], v17 offset:45568
    ds_read_b64_tr_b16 v[76:77], v15 offset:38912
    ds_read_b64_tr_b16 v[92:93], v17 offset:47104
    ds_read_b64_tr_b16 v[78:79], v15 offset:39424
    ds_read_b64_tr_b16 v[94:95], v17 offset:47616
    v_mfma_f32_32x32x16_bf16 v[32:47], v[96:99], v[112:115], v[32:47]
    v_mfma_f32_32x32x16_bf16 v[32:47], v[100:103], v[116:119], v[32:47]
    v_mfma_f32_32x32x16_bf16 v[32:47], v[104:107], v[120:123], v[32:47]
    v_mfma_f32_32x32x16_bf16 v[32:47], v[108:111], v[124:127], v[32:47]
    s_waitcnt vmcnt(24)
    s_waitcnt lgkmcnt(0)
    s_barrier
    s_mov_b32 s20, 1441792
    s_mov_b32 s21, 5046272
    s_add_u32 m0, s44, 98304
    s_nop 0
    buffer_load_dwordx4 v10, s[4:7], s20 offen lds
    s_add_u32 m0, s44, 99328
    s_nop 0
    buffer_load_dwordx4 v11, s[4:7], s20 offen lds
    s_add_u32 m0, s44, 106496
    s_nop 0
    buffer_load_dwordx4 v12, s[8:11], s21 offen lds
    s_add_u32 m0, s44, 107520
    s_nop 0
    buffer_load_dwordx4 v13, s[8:11], s21 offen lds
    ds_read_b64_tr_b16 v[96:97], v15 offset:49152
    ds_read_b64_tr_b16 v[112:113], v17 offset:57344
    ds_read_b64_tr_b16 v[98:99], v15 offset:49664
    ds_read_b64_tr_b16 v[114:115], v17 offset:57856
    ds_read_b64_tr_b16 v[100:101], v15 offset:51200
    ds_read_b64_tr_b16 v[116:117], v17 offset:59392
    ds_read_b64_tr_b16 v[102:103], v15 offset:51712
    ds_read_b64_tr_b16 v[118:119], v17 offset:59904
    ds_read_b64_tr_b16 v[104:105], v15 offset:53248
    ds_read_b64_tr_b16 v[120:121], v17 offset:61440
    ds_read_b64_tr_b16 v[106:107], v15 offset:53760
    ds_read_b64_tr_b16 v[122:123], v17 offset:61952
    ds_read_b64_tr_b16 v[108:109], v15 offset:55296
    ds_read_b64_tr_b16 v[124:125], v17 offset:63488
    ds_read_b64_tr_b16 v[110:111], v15 offset:55808
    ds_read_b64_tr_b16 v[126:127], v17 offset:64000
    v_mfma_f32_32x32x16_bf16 v[32:47], v[64:67], v[80:83], v[32:47]
    v_mfma_f32_32x32x16_bf16 v[32:47], v[68:71], v[84:87], v[32:47]
    v_mfma_f32_32x32x16_bf16 v[32:47], v[72:75], v[88:91], v[32:47]
    v_mfma_f32_32x32x16_bf16 v[32:47], v[76:79], v[92:95], v[32:47]
    s_waitcnt vmcnt(24)
    s_waitcnt lgkmcnt(0)
    s_barrier
    s_mov_b32 s20, 1507328
    s_mov_b32 s21, 5275648
    s_add_u32 m0, s44, 114688
    s_nop 0
    buffer_load_dwordx4 v10, s[4:7], s20 offen lds
    s_add_u32 m0, s44, 115712
    s_nop 0
    buffer_load_dwordx4 v11, s[4:7], s20 offen lds
    s_add_u32 m0, s44, 122880
    s_nop 0
    buffer_load_dwordx4 v12, s[8:11], s21 offen lds
    s_add_u32 m0, s44, 123904
    s_nop 0
    buffer_load_dwordx4 v13, s[8:11], s21 offen lds
    ds_read_b64_tr_b16 v[64:65], v14 offset:0
    ds_read_b64_tr_b16 v[80:81], v16 offset:8192
    ds_read_b64_tr_b16 v[66:67], v14 offset:512
    ds_read_b64_tr_b16 v[82:83], v16 offset:8704
    ds_read_b64_tr_b16 v[68:69], v14 offset:2048
    ds_read_b64_tr_b16 v[84:85], v16 offset:10240
    ds_read_b64_tr_b16 v[70:71], v14 offset:2560
    ds_read_b64_tr_b16 v[86:87], v16 offset:10752
    ds_read_b64_tr_b16 v[72:73], v14 offset:4096
    ds_read_b64_tr_b16 v[88:89], v16 offset:12288
    ds_read_b64_tr_b16 v[74:75], v14 offset:4608
    ds_read_b64_tr_b16 v[90:91], v16 offset:12800
    ds_read_b64_tr_b16 v[76:77], v14 offset:6144
    ds_read_b64_tr_b16 v[92:93], v16 offset:14336
    ds_read_b64_tr_b16 v[78:79], v14 offset:6656
    ds_read_b64_tr_b16 v[94:95], v16 offset:14848
    v_mfma_f32_32x32x16_bf16 v[32:47], v[96:99], v[112:115], v[32:47]
    v_mfma_f32_32x32x16_bf16 v[32:47], v[100:103], v[116:119], v[32:47]
    v_mfma_f32_32x32x16_bf16 v[32:47], v[104:107], v[120:123], v[32:47]
    v_mfma_f32_32x32x16_bf16 v[32:47], v[108:111], v[124:127], v[32:47]
    s_waitcnt vmcnt(24)
    s_waitcnt lgkmcnt(0)
    s_barrier
    s_mov_b32 s20, 1572864
    s_mov_b32 s21, 5505024
    s_add_u32 m0, s44, 0
    s_nop 0
    buffer_load_dwordx4 v10, s[4:7], s20 offen lds
    s_add_u32 m0, s44, 1024
    s_nop 0
    buffer_load_dwordx4 v11, s[4:7], s20 offen lds
    s_add_u32 m0, s44, 8192
    s_nop 0
    buffer_load_dwordx4 v12, s[8:11], s21 offen lds
    s_add_u32 m0, s44, 9216
    s_nop 0
    buffer_load_dwordx4 v13, s[8:11], s21 offen lds
    ds_read_b64_tr_b16 v[96:97], v14 offset:16384
    ds_read_b64_tr_b16 v[112:113], v16 offset:24576
    ds_read_b64_tr_b16 v[98:99], v14 offset:16896
    ds_read_b64_tr_b16 v[114:115], v16 offset:25088
    ds_read_b64_tr_b16 v[100:101], v14 offset:18432
    ds_read_b64_tr_b16 v[116:117], v16 offset:26624
    ds_read_b64_tr_b16 v[102:103], v14 offset:18944
    ds_read_b64_tr_b16 v[118:119], v16 offset:27136
    ds_read_b64_tr_b16 v[104:105], v14 offset:20480
    ds_read_b64_tr_b16 v[120:121], v16 offset:28672
    ds_read_b64_tr_b16 v[106:107], v14 offset:20992
    ds_read_b64_tr_b16 v[122:123], v16 offset:29184
    ds_read_b64_tr_b16 v[108:109], v14 offset:22528
    ds_read_b64_tr_b16 v[124:125], v16 offset:30720
    ds_read_b64_tr_b16 v[110:111], v14 offset:23040
    ds_read_b64_tr_b16 v[126:127], v16 offset:31232
    v_mfma_f32_32x32x16_bf16 v[32:47], v[64:67], v[80:83], v[32:47]
    v_mfma_f32_32x32x16_bf16 v[32:47], v[68:71], v[84:87], v[32:47]
    v_mfma_f32_32x32x16_bf16 v[32:47], v[72:75], v[88:91], v[32:47]
    v_mfma_f32_32x32x16_bf16 v[32:47], v[76:79], v[92:95], v[32:47]
    s_waitcnt vmcnt(24)
    s_waitcnt lgkmcnt(0)
    s_barrier
    s_mov_b32 s20, 1638400
    s_mov_b32 s21, 5734400
    s_add_u32 m0, s44, 16384
    s_nop 0
    buffer_load_dwordx4 v10, s[4:7], s20 offen lds
    s_add_u32 m0, s44, 17408
    s_nop 0
    buffer_load_dwordx4 v11, s[4:7], s20 offen lds
    s_add_u32 m0, s44, 24576
    s_nop 0
    buffer_load_dwordx4 v12, s[8:11], s21 offen lds
    s_add_u32 m0, s44, 25600
    s_nop 0
    buffer_load_dwordx4 v13, s[8:11], s21 offen lds
    ds_read_b64_tr_b16 v[64:65], v14 offset:32768
    ds_read_b64_tr_b16 v[80:81], v16 offset:40960
    ds_read_b64_tr_b16 v[66:67], v14 offset:33280
    ds_read_b64_tr_b16 v[82:83], v16 offset:41472
    ds_read_b64_tr_b16 v[68:69], v14 offset:34816
    ds_read_b64_tr_b16 v[84:85], v16 offset:43008
    ds_read_b64_tr_b16 v[70:71], v14 offset:35328
    ds_read_b64_tr_b16 v[86:87], v16 offset:43520
    ds_read_b64_tr_b16 v[72:73], v14 offset:36864
    ds_read_b64_tr_b16 v[88:89], v16 offset:45056
    ds_read_b64_tr_b16 v[74:75], v14 offset:37376
    ds_read_b64_tr_b16 v[90:91], v16 offset:45568
    ds_read_b64_tr_b16 v[76:77], v14 offset:38912
    ds_read_b64_tr_b16 v[92:93], v16 offset:47104
    ds_read_b64_tr_b16 v[78:79], v14 offset:39424
    ds_read_b64_tr_b16 v[94:95], v16 offset:47616
    v_mfma_f32_32x32x16_bf16 v[32:47], v[96:99], v[112:115], v[32:47]
    v_mfma_f32_32x32x16_bf16 v[32:47], v[100:103], v[116:119], v[32:47]
    v_mfma_f32_32x32x16_bf16 v[32:47], v[104:107], v[120:123], v[32:47]
    v_mfma_f32_32x32x16_bf16 v[32:47], v[108:111], v[124:127], v[32:47]
    s_waitcnt vmcnt(24)
    s_waitcnt lgkmcnt(0)
    s_barrier
    s_mov_b32 s20, 1703936
    s_mov_b32 s21, 5963776
    s_add_u32 m0, s44, 32768
    s_nop 0
    buffer_load_dwordx4 v10, s[4:7], s20 offen lds
    s_add_u32 m0, s44, 33792
    s_nop 0
    buffer_load_dwordx4 v11, s[4:7], s20 offen lds
    s_add_u32 m0, s44, 40960
    s_nop 0
    buffer_load_dwordx4 v12, s[8:11], s21 offen lds
    s_add_u32 m0, s44, 41984
    s_nop 0
    buffer_load_dwordx4 v13, s[8:11], s21 offen lds
    ds_read_b64_tr_b16 v[96:97], v14 offset:49152
    ds_read_b64_tr_b16 v[112:113], v16 offset:57344
    ds_read_b64_tr_b16 v[98:99], v14 offset:49664
    ds_read_b64_tr_b16 v[114:115], v16 offset:57856
    ds_read_b64_tr_b16 v[100:101], v14 offset:51200
    ds_read_b64_tr_b16 v[116:117], v16 offset:59392
    ds_read_b64_tr_b16 v[102:103], v14 offset:51712
    ds_read_b64_tr_b16 v[118:119], v16 offset:59904
    ds_read_b64_tr_b16 v[104:105], v14 offset:53248
    ds_read_b64_tr_b16 v[120:121], v16 offset:61440
    ds_read_b64_tr_b16 v[106:107], v14 offset:53760
    ds_read_b64_tr_b16 v[122:123], v16 offset:61952
    ds_read_b64_tr_b16 v[108:109], v14 offset:55296
    ds_read_b64_tr_b16 v[124:125], v16 offset:63488
    ds_read_b64_tr_b16 v[110:111], v14 offset:55808
    ds_read_b64_tr_b16 v[126:127], v16 offset:64000
    v_mfma_f32_32x32x16_bf16 v[32:47], v[64:67], v[80:83], v[32:47]
    v_mfma_f32_32x32x16_bf16 v[32:47], v[68:71], v[84:87], v[32:47]
    v_mfma_f32_32x32x16_bf16 v[32:47], v[72:75], v[88:91], v[32:47]
    v_mfma_f32_32x32x16_bf16 v[32:47], v[76:79], v[92:95], v[32:47]
    s_waitcnt vmcnt(24)
    s_waitcnt lgkmcnt(0)
    s_barrier
    s_mov_b32 s20, 1769472
    s_mov_b32 s21, 6193152
    s_add_u32 m0, s44, 49152
    s_nop 0
    buffer_load_dwordx4 v10, s[4:7], s20 offen lds
    s_add_u32 m0, s44, 50176
    s_nop 0
    buffer_load_dwordx4 v11, s[4:7], s20 offen lds
    s_add_u32 m0, s44, 57344
    s_nop 0
    buffer_load_dwordx4 v12, s[8:11], s21 offen lds
    s_add_u32 m0, s44, 58368
    s_nop 0
    buffer_load_dwordx4 v13, s[8:11], s21 offen lds
    ds_read_b64_tr_b16 v[64:65], v15 offset:0
    ds_read_b64_tr_b16 v[80:81], v17 offset:8192
    ds_read_b64_tr_b16 v[66:67], v15 offset:512
    ds_read_b64_tr_b16 v[82:83], v17 offset:8704
    ds_read_b64_tr_b16 v[68:69], v15 offset:2048
    ds_read_b64_tr_b16 v[84:85], v17 offset:10240
    ds_read_b64_tr_b16 v[70:71], v15 offset:2560
    ds_read_b64_tr_b16 v[86:87], v17 offset:10752
    ds_read_b64_tr_b16 v[72:73], v15 offset:4096
    ds_read_b64_tr_b16 v[88:89], v17 offset:12288
    ds_read_b64_tr_b16 v[74:75], v15 offset:4608
    ds_read_b64_tr_b16 v[90:91], v17 offset:12800
    ds_read_b64_tr_b16 v[76:77], v15 offset:6144
    ds_read_b64_tr_b16 v[92:93], v17 offset:14336
    ds_read_b64_tr_b16 v[78:79], v15 offset:6656
    ds_read_b64_tr_b16 v[94:95], v17 offset:14848
    v_mfma_f32_32x32x16_bf16 v[32:47], v[96:99], v[112:115], v[32:47]
    v_mfma_f32_32x32x16_bf16 v[32:47], v[100:103], v[116:119], v[32:47]
    v_mfma_f32_32x32x16_bf16 v[32:47], v[104:107], v[120:123], v[32:47]
    v_mfma_f32_32x32x16_bf16 v[32:47], v[108:111], v[124:127], v[32:47]
    s_waitcnt vmcnt(24)
    s_waitcnt lgkmcnt(0)
    s_barrier
    s_mov_b32 s20, 1835008
    s_mov_b32 s21, 6422528
    s_add_u32 m0, s44, 65536
    s_nop 0
    buffer_load_dwordx4 v10, s[4:7], s20 offen lds
    s_add_u32 m0, s44, 66560
    s_nop 0
    buffer_load_dwordx4 v11, s[4:7], s20 offen lds
    s_add_u32 m0, s44, 73728
    s_nop 0
    buffer_load_dwordx4 v12, s[8:11], s21 offen lds
    s_add_u32 m0, s44, 74752
    s_nop 0
    buffer_load_dwordx4 v13, s[8:11], s21 offen lds
    ds_read_b64_tr_b16 v[96:97], v15 offset:16384
    ds_read_b64_tr_b16 v[112:113], v17 offset:24576
    ds_read_b64_tr_b16 v[98:99], v15 offset:16896
    ds_read_b64_tr_b16 v[114:115], v17 offset:25088
    ds_read_b64_tr_b16 v[100:101], v15 offset:18432
    ds_read_b64_tr_b16 v[116:117], v17 offset:26624
    ds_read_b64_tr_b16 v[102:103], v15 offset:18944
    ds_read_b64_tr_b16 v[118:119], v17 offset:27136
    ds_read_b64_tr_b16 v[104:105], v15 offset:20480
    ds_read_b64_tr_b16 v[120:121], v17 offset:28672
    ds_read_b64_tr_b16 v[106:107], v15 offset:20992
    ds_read_b64_tr_b16 v[122:123], v17 offset:29184
    ds_read_b64_tr_b16 v[108:109], v15 offset:22528
    ds_read_b64_tr_b16 v[124:125], v17 offset:30720
    ds_read_b64_tr_b16 v[110:111], v15 offset:23040
    ds_read_b64_tr_b16 v[126:127], v17 offset:31232
    v_mfma_f32_32x32x16_bf16 v[32:47], v[64:67], v[80:83], v[32:47]
    v_mfma_f32_32x32x16_bf16 v[32:47], v[68:71], v[84:87], v[32:47]
    v_mfma_f32_32x32x16_bf16 v[32:47], v[72:75], v[88:91], v[32:47]
    v_mfma_f32_32x32x16_bf16 v[32:47], v[76:79], v[92:95], v[32:47]
    s_waitcnt vmcnt(24)
    s_waitcnt lgkmcnt(0)
    s_barrier
    s_mov_b32 s20, 1900544
    s_mov_b32 s21, 6651904
    s_add_u32 m0, s44, 81920
    s_nop 0
    buffer_load_dwordx4 v10, s[4:7], s20 offen lds
    s_add_u32 m0, s44, 82944
    s_nop 0
    buffer_load_dwordx4 v11, s[4:7], s20 offen lds
    s_add_u32 m0, s44, 90112
    s_nop 0
    buffer_load_dwordx4 v12, s[8:11], s21 offen lds
    s_add_u32 m0, s44, 91136
    s_nop 0
    buffer_load_dwordx4 v13, s[8:11], s21 offen lds
    ds_read_b64_tr_b16 v[64:65], v15 offset:32768
    ds_read_b64_tr_b16 v[80:81], v17 offset:40960
    ds_read_b64_tr_b16 v[66:67], v15 offset:33280
    ds_read_b64_tr_b16 v[82:83], v17 offset:41472
    ds_read_b64_tr_b16 v[68:69], v15 offset:34816
    ds_read_b64_tr_b16 v[84:85], v17 offset:43008
    ds_read_b64_tr_b16 v[70:71], v15 offset:35328
    ds_read_b64_tr_b16 v[86:87], v17 offset:43520
    ds_read_b64_tr_b16 v[72:73], v15 offset:36864
    ds_read_b64_tr_b16 v[88:89], v17 offset:45056
    ds_read_b64_tr_b16 v[74:75], v15 offset:37376
    ds_read_b64_tr_b16 v[90:91], v17 offset:45568
    ds_read_b64_tr_b16 v[76:77], v15 offset:38912
    ds_read_b64_tr_b16 v[92:93], v17 offset:47104
    ds_read_b64_tr_b16 v[78:79], v15 offset:39424
    ds_read_b64_tr_b16 v[94:95], v17 offset:47616
    v_mfma_f32_32x32x16_bf16 v[32:47], v[96:99], v[112:115], v[32:47]
    v_mfma_f32_32x32x16_bf16 v[32:47], v[100:103], v[116:119], v[32:47]
    v_mfma_f32_32x32x16_bf16 v[32:47], v[104:107], v[120:123], v[32:47]
    v_mfma_f32_32x32x16_bf16 v[32:47], v[108:111], v[124:127], v[32:47]
    s_waitcnt vmcnt(24)
    s_waitcnt lgkmcnt(0)
    s_barrier
    s_mov_b32 s20, 1966080
    s_mov_b32 s21, 6881280
    s_add_u32 m0, s44, 98304
    s_nop 0
    buffer_load_dwordx4 v10, s[4:7], s20 offen lds
    s_add_u32 m0, s44, 99328
    s_nop 0
    buffer_load_dwordx4 v11, s[4:7], s20 offen lds
    s_add_u32 m0, s44, 106496
    s_nop 0
    buffer_load_dwordx4 v12, s[8:11], s21 offen lds
    s_add_u32 m0, s44, 107520
    s_nop 0
    buffer_load_dwordx4 v13, s[8:11], s21 offen lds
    ds_read_b64_tr_b16 v[96:97], v15 offset:49152
    ds_read_b64_tr_b16 v[112:113], v17 offset:57344
    ds_read_b64_tr_b16 v[98:99], v15 offset:49664
    ds_read_b64_tr_b16 v[114:115], v17 offset:57856
    ds_read_b64_tr_b16 v[100:101], v15 offset:51200
    ds_read_b64_tr_b16 v[116:117], v17 offset:59392
    ds_read_b64_tr_b16 v[102:103], v15 offset:51712
    ds_read_b64_tr_b16 v[118:119], v17 offset:59904
    ds_read_b64_tr_b16 v[104:105], v15 offset:53248
    ds_read_b64_tr_b16 v[120:121], v17 offset:61440
    ds_read_b64_tr_b16 v[106:107], v15 offset:53760
    ds_read_b64_tr_b16 v[122:123], v17 offset:61952
    ds_read_b64_tr_b16 v[108:109], v15 offset:55296
    ds_read_b64_tr_b16 v[124:125], v17 offset:63488
    ds_read_b64_tr_b16 v[110:111], v15 offset:55808
    ds_read_b64_tr_b16 v[126:127], v17 offset:64000
    v_mfma_f32_32x32x16_bf16 v[32:47], v[64:67], v[80:83], v[32:47]
    v_mfma_f32_32x32x16_bf16 v[32:47], v[68:71], v[84:87], v[32:47]
    v_mfma_f32_32x32x16_bf16 v[32:47], v[72:75], v[88:91], v[32:47]
    v_mfma_f32_32x32x16_bf16 v[32:47], v[76:79], v[92:95], v[32:47]
    s_waitcnt vmcnt(24)
    s_waitcnt lgkmcnt(0)
    s_barrier
    s_mov_b32 s20, 2031616
    s_mov_b32 s21, 7110656
    s_add_u32 m0, s44, 114688
    s_nop 0
    buffer_load_dwordx4 v10, s[4:7], s20 offen lds
    s_add_u32 m0, s44, 115712
    s_nop 0
    buffer_load_dwordx4 v11, s[4:7], s20 offen lds
    s_add_u32 m0, s44, 122880
    s_nop 0
    buffer_load_dwordx4 v12, s[8:11], s21 offen lds
    s_add_u32 m0, s44, 123904
    s_nop 0
    buffer_load_dwordx4 v13, s[8:11], s21 offen lds
    ds_read_b64_tr_b16 v[64:65], v14 offset:0
    ds_read_b64_tr_b16 v[80:81], v16 offset:8192
    ds_read_b64_tr_b16 v[66:67], v14 offset:512
    ds_read_b64_tr_b16 v[82:83], v16 offset:8704
    ds_read_b64_tr_b16 v[68:69], v14 offset:2048
    ds_read_b64_tr_b16 v[84:85], v16 offset:10240
    ds_read_b64_tr_b16 v[70:71], v14 offset:2560
    ds_read_b64_tr_b16 v[86:87], v16 offset:10752
    ds_read_b64_tr_b16 v[72:73], v14 offset:4096
    ds_read_b64_tr_b16 v[88:89], v16 offset:12288
    ds_read_b64_tr_b16 v[74:75], v14 offset:4608
    ds_read_b64_tr_b16 v[90:91], v16 offset:12800
    ds_read_b64_tr_b16 v[76:77], v14 offset:6144
    ds_read_b64_tr_b16 v[92:93], v16 offset:14336
    ds_read_b64_tr_b16 v[78:79], v14 offset:6656
    ds_read_b64_tr_b16 v[94:95], v16 offset:14848
    v_mfma_f32_32x32x16_bf16 v[32:47], v[96:99], v[112:115], v[32:47]
    v_mfma_f32_32x32x16_bf16 v[32:47], v[100:103], v[116:119], v[32:47]
    v_mfma_f32_32x32x16_bf16 v[32:47], v[104:107], v[120:123], v[32:47]
    v_mfma_f32_32x32x16_bf16 v[32:47], v[108:111], v[124:127], v[32:47]
    s_waitcnt vmcnt(24)
    s_waitcnt lgkmcnt(0)
    s_barrier
    ds_read_b64_tr_b16 v[96:97], v14 offset:16384
    ds_read_b64_tr_b16 v[112:113], v16 offset:24576
    ds_read_b64_tr_b16 v[98:99], v14 offset:16896
    ds_read_b64_tr_b16 v[114:115], v16 offset:25088
    ds_read_b64_tr_b16 v[100:101], v14 offset:18432
    ds_read_b64_tr_b16 v[116:117], v16 offset:26624
    ds_read_b64_tr_b16 v[102:103], v14 offset:18944
    ds_read_b64_tr_b16 v[118:119], v16 offset:27136
    ds_read_b64_tr_b16 v[104:105], v14 offset:20480
    ds_read_b64_tr_b16 v[120:121], v16 offset:28672
    ds_read_b64_tr_b16 v[106:107], v14 offset:20992
    ds_read_b64_tr_b16 v[122:123], v16 offset:29184
    ds_read_b64_tr_b16 v[108:109], v14 offset:22528
    ds_read_b64_tr_b16 v[124:125], v16 offset:30720
    ds_read_b64_tr_b16 v[110:111], v14 offset:23040
    ds_read_b64_tr_b16 v[126:127], v16 offset:31232
    v_mfma_f32_32x32x16_bf16 v[32:47], v[64:67], v[80:83], v[32:47]
    v_mfma_f32_32x32x16_bf16 v[32:47], v[68:71], v[84:87], v[32:47]
    v_mfma_f32_32x32x16_bf16 v[32:47], v[72:75], v[88:91], v[32:47]
    v_mfma_f32_32x32x16_bf16 v[32:47], v[76:79], v[92:95], v[32:47]
    s_waitcnt vmcnt(20)
    s_waitcnt lgkmcnt(0)
    s_barrier
    ds_read_b64_tr_b16 v[64:65], v14 offset:32768
    ds_read_b64_tr_b16 v[80:81], v16 offset:40960
    ds_read_b64_tr_b16 v[66:67], v14 offset:33280
    ds_read_b64_tr_b16 v[82:83], v16 offset:41472
    ds_read_b64_tr_b16 v[68:69], v14 offset:34816
    ds_read_b64_tr_b16 v[84:85], v16 offset:43008
    ds_read_b64_tr_b16 v[70:71], v14 offset:35328
    ds_read_b64_tr_b16 v[86:87], v16 offset:43520
    ds_read_b64_tr_b16 v[72:73], v14 offset:36864
    ds_read_b64_tr_b16 v[88:89], v16 offset:45056
    ds_read_b64_tr_b16 v[74:75], v14 offset:37376
    ds_read_b64_tr_b16 v[90:91], v16 offset:45568
    ds_read_b64_tr_b16 v[76:77], v14 offset:38912
    ds_read_b64_tr_b16 v[92:93], v16 offset:47104
    ds_read_b64_tr_b16 v[78:79], v14 offset:39424
    ds_read_b64_tr_b16 v[94:95], v16 offset:47616
    v_mfma_f32_32x32x16_bf16 v[32:47], v[96:99], v[112:115], v[32:47]
    v_mfma_f32_32x32x16_bf16 v[32:47], v[100:103], v[116:119], v[32:47]
    v_mfma_f32_32x32x16_bf16 v[32:47], v[104:107], v[120:123], v[32:47]
    v_mfma_f32_32x32x16_bf16 v[32:47], v[108:111], v[124:127], v[32:47]
    s_waitcnt vmcnt(16)
    s_waitcnt lgkmcnt(0)
    s_barrier
    ds_read_b64_tr_b16 v[96:97], v14 offset:49152
    ds_read_b64_tr_b16 v[112:113], v16 offset:57344
    ds_read_b64_tr_b16 v[98:99], v14 offset:49664
    ds_read_b64_tr_b16 v[114:115], v16 offset:57856
    ds_read_b64_tr_b16 v[100:101], v14 offset:51200
    ds_read_b64_tr_b16 v[116:117], v16 offset:59392
    ds_read_b64_tr_b16 v[102:103], v14 offset:51712
    ds_read_b64_tr_b16 v[118:119], v16 offset:59904
    ds_read_b64_tr_b16 v[104:105], v14 offset:53248
    ds_read_b64_tr_b16 v[120:121], v16 offset:61440
    ds_read_b64_tr_b16 v[106:107], v14 offset:53760
    ds_read_b64_tr_b16 v[122:123], v16 offset:61952
    ds_read_b64_tr_b16 v[108:109], v14 offset:55296
    ds_read_b64_tr_b16 v[124:125], v16 offset:63488
    ds_read_b64_tr_b16 v[110:111], v14 offset:55808
    ds_read_b64_tr_b16 v[126:127], v16 offset:64000
    v_mfma_f32_32x32x16_bf16 v[32:47], v[64:67], v[80:83], v[32:47]
    v_mfma_f32_32x32x16_bf16 v[32:47], v[68:71], v[84:87], v[32:47]
    v_mfma_f32_32x32x16_bf16 v[32:47], v[72:75], v[88:91], v[32:47]
    v_mfma_f32_32x32x16_bf16 v[32:47], v[76:79], v[92:95], v[32:47]
    s_waitcnt vmcnt(12)
    s_waitcnt lgkmcnt(0)
    s_barrier
    ds_read_b64_tr_b16 v[64:65], v15 offset:0
    ds_read_b64_tr_b16 v[80:81], v17 offset:8192
    ds_read_b64_tr_b16 v[66:67], v15 offset:512
    ds_read_b64_tr_b16 v[82:83], v17 offset:8704
    ds_read_b64_tr_b16 v[68:69], v15 offset:2048
    ds_read_b64_tr_b16 v[84:85], v17 offset:10240
    ds_read_b64_tr_b16 v[70:71], v15 offset:2560
    ds_read_b64_tr_b16 v[86:87], v17 offset:10752
    ds_read_b64_tr_b16 v[72:73], v15 offset:4096
    ds_read_b64_tr_b16 v[88:89], v17 offset:12288
    ds_read_b64_tr_b16 v[74:75], v15 offset:4608
    ds_read_b64_tr_b16 v[90:91], v17 offset:12800
    ds_read_b64_tr_b16 v[76:77], v15 offset:6144
    ds_read_b64_tr_b16 v[92:93], v17 offset:14336
    ds_read_b64_tr_b16 v[78:79], v15 offset:6656
    ds_read_b64_tr_b16 v[94:95], v17 offset:14848
    v_mfma_f32_32x32x16_bf16 v[32:47], v[96:99], v[112:115], v[32:47]
    v_mfma_f32_32x32x16_bf16 v[32:47], v[100:103], v[116:119], v[32:47]
    v_mfma_f32_32x32x16_bf16 v[32:47], v[104:107], v[120:123], v[32:47]
    v_mfma_f32_32x32x16_bf16 v[32:47], v[108:111], v[124:127], v[32:47]
    s_waitcnt vmcnt(8)
    s_waitcnt lgkmcnt(0)
    s_barrier
    ds_read_b64_tr_b16 v[96:97], v15 offset:16384
    ds_read_b64_tr_b16 v[112:113], v17 offset:24576
    ds_read_b64_tr_b16 v[98:99], v15 offset:16896
    ds_read_b64_tr_b16 v[114:115], v17 offset:25088
    ds_read_b64_tr_b16 v[100:101], v15 offset:18432
    ds_read_b64_tr_b16 v[116:117], v17 offset:26624
    ds_read_b64_tr_b16 v[102:103], v15 offset:18944
    ds_read_b64_tr_b16 v[118:119], v17 offset:27136
    ds_read_b64_tr_b16 v[104:105], v15 offset:20480
    ds_read_b64_tr_b16 v[120:121], v17 offset:28672
    ds_read_b64_tr_b16 v[106:107], v15 offset:20992
    ds_read_b64_tr_b16 v[122:123], v17 offset:29184
    ds_read_b64_tr_b16 v[108:109], v15 offset:22528
    ds_read_b64_tr_b16 v[124:125], v17 offset:30720
    ds_read_b64_tr_b16 v[110:111], v15 offset:23040
    ds_read_b64_tr_b16 v[126:127], v17 offset:31232
    v_mfma_f32_32x32x16_bf16 v[32:47], v[64:67], v[80:83], v[32:47]
    v_mfma_f32_32x32x16_bf16 v[32:47], v[68:71], v[84:87], v[32:47]
    v_mfma_f32_32x32x16_bf16 v[32:47], v[72:75], v[88:91], v[32:47]
    v_mfma_f32_32x32x16_bf16 v[32:47], v[76:79], v[92:95], v[32:47]
    s_waitcnt vmcnt(4)
    s_waitcnt lgkmcnt(0)
    s_barrier
    ds_read_b64_tr_b16 v[64:65], v15 offset:32768
    ds_read_b64_tr_b16 v[80:81], v17 offset:40960
    ds_read_b64_tr_b16 v[66:67], v15 offset:33280
    ds_read_b64_tr_b16 v[82:83], v17 offset:41472
    ds_read_b64_tr_b16 v[68:69], v15 offset:34816
    ds_read_b64_tr_b16 v[84:85], v17 offset:43008
    ds_read_b64_tr_b16 v[70:71], v15 offset:35328
    ds_read_b64_tr_b16 v[86:87], v17 offset:43520
    ds_read_b64_tr_b16 v[72:73], v15 offset:36864
    ds_read_b64_tr_b16 v[88:89], v17 offset:45056
    ds_read_b64_tr_b16 v[74:75], v15 offset:37376
    ds_read_b64_tr_b16 v[90:91], v17 offset:45568
    ds_read_b64_tr_b16 v[76:77], v15 offset:38912
    ds_read_b64_tr_b16 v[92:93], v17 offset:47104
    ds_read_b64_tr_b16 v[78:79], v15 offset:39424
    ds_read_b64_tr_b16 v[94:95], v17 offset:47616
    v_mfma_f32_32x32x16_bf16 v[32:47], v[96:99], v[112:115], v[32:47]
    v_mfma_f32_32x32x16_bf16 v[32:47], v[100:103], v[116:119], v[32:47]
    v_mfma_f32_32x32x16_bf16 v[32:47], v[104:107], v[120:123], v[32:47]
    v_mfma_f32_32x32x16_bf16 v[32:47], v[108:111], v[124:127], v[32:47]
    s_waitcnt vmcnt(0)
    s_waitcnt lgkmcnt(0)
    s_barrier
    ds_read_b64_tr_b16 v[96:97], v15 offset:49152
    ds_read_b64_tr_b16 v[112:113], v17 offset:57344
    ds_read_b64_tr_b16 v[98:99], v15 offset:49664
    ds_read_b64_tr_b16 v[114:115], v17 offset:57856
    ds_read_b64_tr_b16 v[100:101], v15 offset:51200
    ds_read_b64_tr_b16 v[116:117], v17 offset:59392
    ds_read_b64_tr_b16 v[102:103], v15 offset:51712
    ds_read_b64_tr_b16 v[118:119], v17 offset:59904
    ds_read_b64_tr_b16 v[104:105], v15 offset:53248
    ds_read_b64_tr_b16 v[120:121], v17 offset:61440
    ds_read_b64_tr_b16 v[106:107], v15 offset:53760
    ds_read_b64_tr_b16 v[122:123], v17 offset:61952
    ds_read_b64_tr_b16 v[108:109], v15 offset:55296
    ds_read_b64_tr_b16 v[124:125], v17 offset:63488
    ds_read_b64_tr_b16 v[110:111], v15 offset:55808
    ds_read_b64_tr_b16 v[126:127], v17 offset:64000
    v_mfma_f32_32x32x16_bf16 v[32:47], v[64:67], v[80:83], v[32:47]
    v_mfma_f32_32x32x16_bf16 v[32:47], v[68:71], v[84:87], v[32:47]
    v_mfma_f32_32x32x16_bf16 v[32:47], v[72:75], v[88:91], v[32:47]
    v_mfma_f32_32x32x16_bf16 v[32:47], v[76:79], v[92:95], v[32:47]
    s_waitcnt lgkmcnt(0)
    s_barrier
    v_mfma_f32_32x32x16_bf16 v[32:47], v[96:99], v[112:115], v[32:47]
    v_mfma_f32_32x32x16_bf16 v[32:47], v[100:103], v[116:119], v[32:47]
    v_mfma_f32_32x32x16_bf16 v[32:47], v[104:107], v[120:123], v[32:47]
    v_mfma_f32_32x32x16_bf16 v[32:47], v[108:111], v[124:127], v[32:47]
    s_waitcnt vmcnt(0)
    v_lshlrev_b32 v20, 16, v20
    v_lshrrev_b32 v2, 5, v1
    v_lshlrev_b32 v2, 2, v2
    s_lshl_b32 s43, s41, 5
    v_add_u32 v2, s43, v2
    s_lshl_b32 s43, s33, 6
    v_add_u32 v2, s43, v2
    s_mov_b32 s43, 3584
    v_mul_lo_u32 v2, v2, s43
    v_lshlrev_b32 v3, 1, v21
    v_add_u32 v22, v2, v3
    s_nop 11
    s_mov_b32 s47, 1024598649
    s_mov_b32 s54, 1061962282
    s_mov_b32 s55, 3224939067
    v_cvt_pk_bf16_f32 v4, v32, v32
    v_lshlrev_b32 v4, 16, v4
    v_add_f32 v4, v4, v20
    v_cvt_pk_bf16_f32 v4, v4, v4
    v_lshlrev_b32 v4, 16, v4
    v_mul_f32 v5, v4, v4
    v_mov_b32 v6, s54
    v_fma_f32 v5, v5, s47, v6
    v_mul_f32 v5, v5, v4
    v_mul_f32 v5, s55, v5
    v_exp_f32 v5, v5
    s_nop 0
    v_add_f32 v5, 1.0, v5
    v_rcp_f32 v5, v5
    s_nop 0
    v_mul_f32 v5, v5, v4
    v_cvt_pk_bf16_f32 v5, v5, v5
    buffer_store_short v5, v22, s[12:15], 0 offen
    v_cvt_pk_bf16_f32 v4, v33, v33
    v_lshlrev_b32 v4, 16, v4
    v_add_f32 v4, v4, v20
    v_cvt_pk_bf16_f32 v4, v4, v4
    v_lshlrev_b32 v4, 16, v4
    v_mul_f32 v5, v4, v4
    v_mov_b32 v6, s54
    v_fma_f32 v5, v5, s47, v6
    v_mul_f32 v5, v5, v4
    v_mul_f32 v5, s55, v5
    v_exp_f32 v5, v5
    s_nop 0
    v_add_f32 v5, 1.0, v5
    v_rcp_f32 v5, v5
    s_nop 0
    v_mul_f32 v5, v5, v4
    v_cvt_pk_bf16_f32 v5, v5, v5
    v_add_u32 v6, 3584, v22
    buffer_store_short v5, v6, s[12:15], 0 offen
    v_cvt_pk_bf16_f32 v4, v34, v34
    v_lshlrev_b32 v4, 16, v4
    v_add_f32 v4, v4, v20
    v_cvt_pk_bf16_f32 v4, v4, v4
    v_lshlrev_b32 v4, 16, v4
    v_mul_f32 v5, v4, v4
    v_mov_b32 v6, s54
    v_fma_f32 v5, v5, s47, v6
    v_mul_f32 v5, v5, v4
    v_mul_f32 v5, s55, v5
    v_exp_f32 v5, v5
    s_nop 0
    v_add_f32 v5, 1.0, v5
    v_rcp_f32 v5, v5
    s_nop 0
    v_mul_f32 v5, v5, v4
    v_cvt_pk_bf16_f32 v5, v5, v5
    v_add_u32 v6, 7168, v22
    buffer_store_short v5, v6, s[12:15], 0 offen
    v_cvt_pk_bf16_f32 v4, v35, v35
    v_lshlrev_b32 v4, 16, v4
    v_add_f32 v4, v4, v20
    v_cvt_pk_bf16_f32 v4, v4, v4
    v_lshlrev_b32 v4, 16, v4
    v_mul_f32 v5, v4, v4
    v_mov_b32 v6, s54
    v_fma_f32 v5, v5, s47, v6
    v_mul_f32 v5, v5, v4
    v_mul_f32 v5, s55, v5
    v_exp_f32 v5, v5
    s_nop 0
    v_add_f32 v5, 1.0, v5
    v_rcp_f32 v5, v5
    s_nop 0
    v_mul_f32 v5, v5, v4
    v_cvt_pk_bf16_f32 v5, v5, v5
    v_add_u32 v6, 10752, v22
    buffer_store_short v5, v6, s[12:15], 0 offen
    v_cvt_pk_bf16_f32 v4, v36, v36
    v_lshlrev_b32 v4, 16, v4
    v_add_f32 v4, v4, v20
    v_cvt_pk_bf16_f32 v4, v4, v4
    v_lshlrev_b32 v4, 16, v4
    v_mul_f32 v5, v4, v4
    v_mov_b32 v6, s54
    v_fma_f32 v5, v5, s47, v6
    v_mul_f32 v5, v5, v4
    v_mul_f32 v5, s55, v5
    v_exp_f32 v5, v5
    s_nop 0
    v_add_f32 v5, 1.0, v5
    v_rcp_f32 v5, v5
    s_nop 0
    v_mul_f32 v5, v5, v4
    v_cvt_pk_bf16_f32 v5, v5, v5
    v_add_u32 v6, 28672, v22
    buffer_store_short v5, v6, s[12:15], 0 offen
    v_cvt_pk_bf16_f32 v4, v37, v37
    v_lshlrev_b32 v4, 16, v4
    v_add_f32 v4, v4, v20
    v_cvt_pk_bf16_f32 v4, v4, v4
    v_lshlrev_b32 v4, 16, v4
    v_mul_f32 v5, v4, v4
    v_mov_b32 v6, s54
    v_fma_f32 v5, v5, s47, v6
    v_mul_f32 v5, v5, v4
    v_mul_f32 v5, s55, v5
    v_exp_f32 v5, v5
    s_nop 0
    v_add_f32 v5, 1.0, v5
    v_rcp_f32 v5, v5
    s_nop 0
    v_mul_f32 v5, v5, v4
    v_cvt_pk_bf16_f32 v5, v5, v5
    v_add_u32 v6, 32256, v22
    buffer_store_short v5, v6, s[12:15], 0 offen
    v_cvt_pk_bf16_f32 v4, v38, v38
    v_lshlrev_b32 v4, 16, v4
    v_add_f32 v4, v4, v20
    v_cvt_pk_bf16_f32 v4, v4, v4
    v_lshlrev_b32 v4, 16, v4
    v_mul_f32 v5, v4, v4
    v_mov_b32 v6, s54
    v_fma_f32 v5, v5, s47, v6
    v_mul_f32 v5, v5, v4
    v_mul_f32 v5, s55, v5
    v_exp_f32 v5, v5
    s_nop 0
    v_add_f32 v5, 1.0, v5
    v_rcp_f32 v5, v5
    s_nop 0
    v_mul_f32 v5, v5, v4
    v_cvt_pk_bf16_f32 v5, v5, v5
    v_add_u32 v6, 35840, v22
    buffer_store_short v5, v6, s[12:15], 0 offen
    v_cvt_pk_bf16_f32 v4, v39, v39
    v_lshlrev_b32 v4, 16, v4
    v_add_f32 v4, v4, v20
    v_cvt_pk_bf16_f32 v4, v4, v4
    v_lshlrev_b32 v4, 16, v4
    v_mul_f32 v5, v4, v4
    v_mov_b32 v6, s54
    v_fma_f32 v5, v5, s47, v6
    v_mul_f32 v5, v5, v4
    v_mul_f32 v5, s55, v5
    v_exp_f32 v5, v5
    s_nop 0
    v_add_f32 v5, 1.0, v5
    v_rcp_f32 v5, v5
    s_nop 0
    v_mul_f32 v5, v5, v4
    v_cvt_pk_bf16_f32 v5, v5, v5
    v_add_u32 v6, 39424, v22
    buffer_store_short v5, v6, s[12:15], 0 offen
    v_cvt_pk_bf16_f32 v4, v40, v40
    v_lshlrev_b32 v4, 16, v4
    v_add_f32 v4, v4, v20
    v_cvt_pk_bf16_f32 v4, v4, v4
    v_lshlrev_b32 v4, 16, v4
    v_mul_f32 v5, v4, v4
    v_mov_b32 v6, s54
    v_fma_f32 v5, v5, s47, v6
    v_mul_f32 v5, v5, v4
    v_mul_f32 v5, s55, v5
    v_exp_f32 v5, v5
    s_nop 0
    v_add_f32 v5, 1.0, v5
    v_rcp_f32 v5, v5
    s_nop 0
    v_mul_f32 v5, v5, v4
    v_cvt_pk_bf16_f32 v5, v5, v5
    v_add_u32 v6, 57344, v22
    buffer_store_short v5, v6, s[12:15], 0 offen
    v_cvt_pk_bf16_f32 v4, v41, v41
    v_lshlrev_b32 v4, 16, v4
    v_add_f32 v4, v4, v20
    v_cvt_pk_bf16_f32 v4, v4, v4
    v_lshlrev_b32 v4, 16, v4
    v_mul_f32 v5, v4, v4
    v_mov_b32 v6, s54
    v_fma_f32 v5, v5, s47, v6
    v_mul_f32 v5, v5, v4
    v_mul_f32 v5, s55, v5
    v_exp_f32 v5, v5
    s_nop 0
    v_add_f32 v5, 1.0, v5
    v_rcp_f32 v5, v5
    s_nop 0
    v_mul_f32 v5, v5, v4
    v_cvt_pk_bf16_f32 v5, v5, v5
    v_add_u32 v6, 60928, v22
    buffer_store_short v5, v6, s[12:15], 0 offen
    v_cvt_pk_bf16_f32 v4, v42, v42
    v_lshlrev_b32 v4, 16, v4
    v_add_f32 v4, v4, v20
    v_cvt_pk_bf16_f32 v4, v4, v4
    v_lshlrev_b32 v4, 16, v4
    v_mul_f32 v5, v4, v4
    v_mov_b32 v6, s54
    v_fma_f32 v5, v5, s47, v6
    v_mul_f32 v5, v5, v4
    v_mul_f32 v5, s55, v5
    v_exp_f32 v5, v5
    s_nop 0
    v_add_f32 v5, 1.0, v5
    v_rcp_f32 v5, v5
    s_nop 0
    v_mul_f32 v5, v5, v4
    v_cvt_pk_bf16_f32 v5, v5, v5
    v_add_u32 v6, 64512, v22
    buffer_store_short v5, v6, s[12:15], 0 offen
    v_cvt_pk_bf16_f32 v4, v43, v43
    v_lshlrev_b32 v4, 16, v4
    v_add_f32 v4, v4, v20
    v_cvt_pk_bf16_f32 v4, v4, v4
    v_lshlrev_b32 v4, 16, v4
    v_mul_f32 v5, v4, v4
    v_mov_b32 v6, s54
    v_fma_f32 v5, v5, s47, v6
    v_mul_f32 v5, v5, v4
    v_mul_f32 v5, s55, v5
    v_exp_f32 v5, v5
    s_nop 0
    v_add_f32 v5, 1.0, v5
    v_rcp_f32 v5, v5
    s_nop 0
    v_mul_f32 v5, v5, v4
    v_cvt_pk_bf16_f32 v5, v5, v5
    v_add_u32 v6, 68096, v22
    buffer_store_short v5, v6, s[12:15], 0 offen
    v_cvt_pk_bf16_f32 v4, v44, v44
    v_lshlrev_b32 v4, 16, v4
    v_add_f32 v4, v4, v20
    v_cvt_pk_bf16_f32 v4, v4, v4
    v_lshlrev_b32 v4, 16, v4
    v_mul_f32 v5, v4, v4
    v_mov_b32 v6, s54
    v_fma_f32 v5, v5, s47, v6
    v_mul_f32 v5, v5, v4
    v_mul_f32 v5, s55, v5
    v_exp_f32 v5, v5
    s_nop 0
    v_add_f32 v5, 1.0, v5
    v_rcp_f32 v5, v5
    s_nop 0
    v_mul_f32 v5, v5, v4
    v_cvt_pk_bf16_f32 v5, v5, v5
    v_add_u32 v6, 86016, v22
    buffer_store_short v5, v6, s[12:15], 0 offen
    v_cvt_pk_bf16_f32 v4, v45, v45
    v_lshlrev_b32 v4, 16, v4
    v_add_f32 v4, v4, v20
    v_cvt_pk_bf16_f32 v4, v4, v4
    v_lshlrev_b32 v4, 16, v4
    v_mul_f32 v5, v4, v4
    v_mov_b32 v6, s54
    v_fma_f32 v5, v5, s47, v6
    v_mul_f32 v5, v5, v4
    v_mul_f32 v5, s55, v5
    v_exp_f32 v5, v5
    s_nop 0
    v_add_f32 v5, 1.0, v5
    v_rcp_f32 v5, v5
    s_nop 0
    v_mul_f32 v5, v5, v4
    v_cvt_pk_bf16_f32 v5, v5, v5
    v_add_u32 v6, 89600, v22
    buffer_store_short v5, v6, s[12:15], 0 offen
    v_cvt_pk_bf16_f32 v4, v46, v46
    v_lshlrev_b32 v4, 16, v4
    v_add_f32 v4, v4, v20
    v_cvt_pk_bf16_f32 v4, v4, v4
    v_lshlrev_b32 v4, 16, v4
    v_mul_f32 v5, v4, v4
    v_mov_b32 v6, s54
    v_fma_f32 v5, v5, s47, v6
    v_mul_f32 v5, v5, v4
    v_mul_f32 v5, s55, v5
    v_exp_f32 v5, v5
    s_nop 0
    v_add_f32 v5, 1.0, v5
    v_rcp_f32 v5, v5
    s_nop 0
    v_mul_f32 v5, v5, v4
    v_cvt_pk_bf16_f32 v5, v5, v5
    v_add_u32 v6, 93184, v22
    buffer_store_short v5, v6, s[12:15], 0 offen
    v_cvt_pk_bf16_f32 v4, v47, v47
    v_lshlrev_b32 v4, 16, v4
    v_add_f32 v4, v4, v20
    v_cvt_pk_bf16_f32 v4, v4, v4
    v_lshlrev_b32 v4, 16, v4
    v_mul_f32 v5, v4, v4
    v_mov_b32 v6, s54
    v_fma_f32 v5, v5, s47, v6
    v_mul_f32 v5, v5, v4
    v_mul_f32 v5, s55, v5
    v_exp_f32 v5, v5
    s_nop 0
    v_add_f32 v5, 1.0, v5
    v_rcp_f32 v5, v5
    s_nop 0
    v_mul_f32 v5, v5, v4
    v_cvt_pk_bf16_f32 v5, v5, v5
    v_add_u32 v6, 96768, v22
    buffer_store_short v5, v6, s[12:15], 0 offen
    s_branch k2_end
k2_fixup:
    s_sub_u32 s56, s30, 4
    s_lshl_b32 s56, s56, 3
    s_add_u32 s56, s56, s31
    s_sub_u32 s56, s56, 24
    s_add_u32 s4, s28, 4194304
    s_addc_u32 s5, s29, 0
    s_and_b32 s5, s5, 0xffff
    s_mov_b32 s6, 8388608
    s_mov_b32 s7, 0x00020000
    s_add_u32 s8, s28, 12582912
    s_addc_u32 s9, s29, 0
    s_and_b32 s9, s9, 0xffff
    s_mov_b32 s10, 131072
    s_mov_b32 s11, 0x00020000
    s_add_u32 s12, s28, 13631488
    s_addc_u32 s13, s29, 0
    s_and_b32 s13, s13, 0xffff
    s_mov_b32 s14, 4194304
    s_mov_b32 s15, 0x00020000
    s_mov_b32 s16, s48
    s_mov_b32 s17, s49
    s_and_b32 s17, s17, 0xffff
    s_mov_b32 s18, 1024
    s_mov_b32 s19, 0x00020000
    s_mov_b32 s60, s50
    s_mov_b32 s61, s51
    s_and_b32 s61, s61, 0xffff
    s_mov_b32 s62, 1024
    s_mov_b32 s63, 0x00020000
    s_mov_b32 s64, s52
    s_mov_b32 s65, s53
    s_and_b32 s65, s65, 0xffff
    s_mov_b32 s66, 1024
    s_mov_b32 s67, 0x00020000
    v_lshlrev_b32 v2, 2, v0
    buffer_load_dword v3, v2, s[16:19], 0 offen
    buffer_load_dword v4, v2, s[60:63], 0 offen
    buffer_load_dword v5, v2, s[64:67], 0 offen
    v_lshlrev_b32 v6, 3, v0
    s_mov_b32 s43, 0
    buffer_load_dwordx2 v[128:129], v6, s[8:11], s43 offen
    buffer_load_dwordx2 v[130:131], v6, s[8:11], s43 offen offset:2048
    s_mov_b32 s43, 4096
    buffer_load_dwordx2 v[132:133], v6, s[8:11], s43 offen
    buffer_load_dwordx2 v[134:135], v6, s[8:11], s43 offen offset:2048
    s_mov_b32 s43, 8192
    buffer_load_dwordx2 v[136:137], v6, s[8:11], s43 offen
    buffer_load_dwordx2 v[138:139], v6, s[8:11], s43 offen offset:2048
    s_mov_b32 s43, 12288
    buffer_load_dwordx2 v[140:141], v6, s[8:11], s43 offen
    buffer_load_dwordx2 v[142:143], v6, s[8:11], s43 offen offset:2048
    s_mov_b32 s43, 16384
    buffer_load_dwordx2 v[144:145], v6, s[8:11], s43 offen
    buffer_load_dwordx2 v[146:147], v6, s[8:11], s43 offen offset:2048
    s_mov_b32 s43, 20480
    buffer_load_dwordx2 v[148:149], v6, s[8:11], s43 offen
    buffer_load_dwordx2 v[150:151], v6, s[8:11], s43 offen offset:2048
    s_mov_b32 s43, 24576
    buffer_load_dwordx2 v[152:153], v6, s[8:11], s43 offen
    buffer_load_dwordx2 v[154:155], v6, s[8:11], s43 offen offset:2048
    s_mov_b32 s43, 28672
    buffer_load_dwordx2 v[156:157], v6, s[8:11], s43 offen
    buffer_load_dwordx2 v[158:159], v6, s[8:11], s43 offen offset:2048
    s_mov_b32 s43, 32768
    buffer_load_dwordx2 v[160:161], v6, s[8:11], s43 offen
    buffer_load_dwordx2 v[162:163], v6, s[8:11], s43 offen offset:2048
    s_mov_b32 s43, 36864
    buffer_load_dwordx2 v[164:165], v6, s[8:11], s43 offen
    buffer_load_dwordx2 v[166:167], v6, s[8:11], s43 offen offset:2048
    s_mov_b32 s43, 40960
    buffer_load_dwordx2 v[168:169], v6, s[8:11], s43 offen
    buffer_load_dwordx2 v[170:171], v6, s[8:11], s43 offen offset:2048
    s_mov_b32 s43, 45056
    buffer_load_dwordx2 v[172:173], v6, s[8:11], s43 offen
    buffer_load_dwordx2 v[174:175], v6, s[8:11], s43 offen offset:2048
    s_mov_b32 s43, 49152
    buffer_load_dwordx2 v[176:177], v6, s[8:11], s43 offen
    buffer_load_dwordx2 v[178:179], v6, s[8:11], s43 offen offset:2048
    s_mov_b32 s43, 53248
    buffer_load_dwordx2 v[180:181], v6, s[8:11], s43 offen
    buffer_load_dwordx2 v[182:183], v6, s[8:11], s43 offen offset:2048
    s_mov_b32 s43, 57344
    buffer_load_dwordx2 v[184:185], v6, s[8:11], s43 offen
    buffer_load_dwordx2 v[186:187], v6, s[8:11], s43 offen offset:2048
    s_mov_b32 s43, 61440
    buffer_load_dwordx2 v[188:189], v6, s[8:11], s43 offen
    buffer_load_dwordx2 v[190:191], v6, s[8:11], s43 offen offset:2048
    s_mov_b32 s43, 65536
    buffer_load_dwordx2 v[192:193], v6, s[8:11], s43 offen
    buffer_load_dwordx2 v[194:195], v6, s[8:11], s43 offen offset:2048
    s_mov_b32 s43, 69632
    buffer_load_dwordx2 v[196:197], v6, s[8:11], s43 offen
    buffer_load_dwordx2 v[198:199], v6, s[8:11], s43 offen offset:2048
    s_mov_b32 s43, 73728
    buffer_load_dwordx2 v[200:201], v6, s[8:11], s43 offen
    buffer_load_dwordx2 v[202:203], v6, s[8:11], s43 offen offset:2048
    s_mov_b32 s43, 77824
    buffer_load_dwordx2 v[204:205], v6, s[8:11], s43 offen
    buffer_load_dwordx2 v[206:207], v6, s[8:11], s43 offen offset:2048
    s_mov_b32 s43, 81920
    buffer_load_dwordx2 v[208:209], v6, s[8:11], s43 offen
    buffer_load_dwordx2 v[210:211], v6, s[8:11], s43 offen offset:2048
    s_mov_b32 s43, 86016
    buffer_load_dwordx2 v[212:213], v6, s[8:11], s43 offen
    buffer_load_dwordx2 v[214:215], v6, s[8:11], s43 offen offset:2048
    s_mov_b32 s43, 90112
    buffer_load_dwordx2 v[216:217], v6, s[8:11], s43 offen
    buffer_load_dwordx2 v[218:219], v6, s[8:11], s43 offen offset:2048
    s_mov_b32 s43, 94208
    buffer_load_dwordx2 v[220:221], v6, s[8:11], s43 offen
    buffer_load_dwordx2 v[222:223], v6, s[8:11], s43 offen offset:2048
    s_mov_b32 s43, 98304
    buffer_load_dwordx2 v[224:225], v6, s[8:11], s43 offen
    buffer_load_dwordx2 v[226:227], v6, s[8:11], s43 offen offset:2048
    s_mov_b32 s43, 102400
    buffer_load_dwordx2 v[228:229], v6, s[8:11], s43 offen
    buffer_load_dwordx2 v[230:231], v6, s[8:11], s43 offen offset:2048
    s_mov_b32 s43, 106496
    buffer_load_dwordx2 v[232:233], v6, s[8:11], s43 offen
    buffer_load_dwordx2 v[234:235], v6, s[8:11], s43 offen offset:2048
    s_mov_b32 s43, 110592
    buffer_load_dwordx2 v[236:237], v6, s[8:11], s43 offen
    buffer_load_dwordx2 v[238:239], v6, s[8:11], s43 offen offset:2048
    s_mov_b32 s43, 114688
    buffer_load_dwordx2 v[240:241], v6, s[8:11], s43 offen
    buffer_load_dwordx2 v[242:243], v6, s[8:11], s43 offen offset:2048
    s_mov_b32 s43, 118784
    buffer_load_dwordx2 v[244:245], v6, s[8:11], s43 offen
    buffer_load_dwordx2 v[246:247], v6, s[8:11], s43 offen offset:2048
    s_mov_b32 s43, 122880
    buffer_load_dwordx2 v[248:249], v6, s[8:11], s43 offen
    buffer_load_dwordx2 v[250:251], v6, s[8:11], s43 offen offset:2048
    s_waitcnt vmcnt(62)
    v_lshlrev_b32 v8, 16, v3
    v_and_b32 v9, 0xffff0000, v3
    v_lshlrev_b32 v10, 16, v4
    v_and_b32 v11, 0xffff0000, v4
    v_lshlrev_b32 v12, 16, v5
    v_and_b32 v13, 0xffff0000, v5
    s_mov_b32 s43, 1069066811
    v_mul_f32 v20, s43, v12
    v_exp_f32 v20, v20
    s_nop 0
    v_cvt_pk_bf16_f32 v20, v20, v20
    v_lshlrev_b32 v20, 16, v20
    v_mul_f32 v21, v20, v8
    v_mul_f32 v22, v20, v10
    v_mul_f32 v21, s43, v21
    v_exp_f32 v21, v21
    v_mul_f32 v22, 0.15915494, v22
    v_fract_f32 v23, v22
    v_cos_f32 v14, v23
    v_sin_f32 v15, v23
    s_nop 0
    v_mul_f32 v14, v14, v21
    v_mul_f32 v15, v15, v21
    s_mov_b32 s43, 1069066811
    v_mul_f32 v20, s43, v13
    v_exp_f32 v20, v20
    s_nop 0
    v_cvt_pk_bf16_f32 v20, v20, v20
    v_lshlrev_b32 v20, 16, v20
    v_mul_f32 v21, v20, v9
    v_mul_f32 v22, v20, v11
    v_mul_f32 v21, s43, v21
    v_exp_f32 v21, v21
    v_mul_f32 v22, 0.15915494, v22
    v_fract_f32 v23, v22
    v_cos_f32 v16, v23
    v_sin_f32 v17, v23
    s_nop 0
    v_mul_f32 v16, v16, v21
    v_mul_f32 v17, v17, v21
    v_mov_b32 v24, v14
    v_mov_b32 v25, v15
    v_mul_f32 v20, v25, v25
    v_mul_f32 v21, v24, v25
    v_fma_f32 v24, v24, v24, -v20
    v_add_f32 v25, v21, v21
    v_mul_f32 v20, v25, v25
    v_mul_f32 v21, v24, v25
    v_fma_f32 v24, v24, v24, -v20
    v_add_f32 v25, v21, v21
    v_mul_f32 v20, v25, v25
    v_mul_f32 v21, v24, v25
    v_fma_f32 v24, v24, v24, -v20
    v_add_f32 v25, v21, v21
    v_mul_f32 v20, v25, v25
    v_mul_f32 v21, v24, v25
    v_fma_f32 v24, v24, v24, -v20
    v_add_f32 v25, v21, v21
    v_mul_f32 v20, v25, v25
    v_mul_f32 v21, v24, v25
    v_fma_f32 v24, v24, v24, -v20
    v_add_f32 v25, v21, v21
    v_mul_f32 v20, v25, v25
    v_mul_f32 v21, v24, v25
    v_fma_f32 v24, v24, v24, -v20
    v_add_f32 v25, v21, v21
    v_mov_b32 v26, v16
    v_mov_b32 v27, v17
    v_mul_f32 v20, v27, v27
    v_mul_f32 v21, v26, v27
    v_fma_f32 v26, v26, v26, -v20
    v_add_f32 v27, v21, v21
    v_mul_f32 v20, v27, v27
    v_mul_f32 v21, v26, v27
    v_fma_f32 v26, v26, v26, -v20
    v_add_f32 v27, v21, v21
    v_mul_f32 v20, v27, v27
    v_mul_f32 v21, v26, v27
    v_fma_f32 v26, v26, v26, -v20
    v_add_f32 v27, v21, v21
    v_mul_f32 v20, v27, v27
    v_mul_f32 v21, v26, v27
    v_fma_f32 v26, v26, v26, -v20
    v_add_f32 v27, v21, v21
    v_mul_f32 v20, v27, v27
    v_mul_f32 v21, v26, v27
    v_fma_f32 v26, v26, v26, -v20
    v_add_f32 v27, v21, v21
    v_mul_f32 v20, v27, v27
    v_mul_f32 v21, v26, v27
    v_fma_f32 v26, v26, v26, -v20
    v_add_f32 v27, v21, v21
    v_mov_b32 v28, 0
    v_mov_b32 v29, 0
    v_mov_b32 v30, 0
    v_mov_b32 v31, 0
    s_waitcnt vmcnt(0)
    s_cmp_le_u32 s56, 0
    s_cbranch_scc1 k2_carry_done
    v_fma_f32 v20, v24, v28, v128
    v_fma_f32 v21, v24, v29, v130
    v_fma_f32 v20, -v25, v29, v20
    v_fma_f32 v21, v25, v28, v21
    v_mov_b32 v28, v20
    v_mov_b32 v29, v21
    v_fma_f32 v20, v26, v30, v129
    v_fma_f32 v21, v26, v31, v131
    v_fma_f32 v20, -v27, v31, v20
    v_fma_f32 v21, v27, v30, v21
    v_mov_b32 v30, v20
    v_mov_b32 v31, v21
    s_cmp_le_u32 s56, 1
    s_cbranch_scc1 k2_carry_done
    v_fma_f32 v20, v24, v28, v132
    v_fma_f32 v21, v24, v29, v134
    v_fma_f32 v20, -v25, v29, v20
    v_fma_f32 v21, v25, v28, v21
    v_mov_b32 v28, v20
    v_mov_b32 v29, v21
    v_fma_f32 v20, v26, v30, v133
    v_fma_f32 v21, v26, v31, v135
    v_fma_f32 v20, -v27, v31, v20
    v_fma_f32 v21, v27, v30, v21
    v_mov_b32 v30, v20
    v_mov_b32 v31, v21
    s_cmp_le_u32 s56, 2
    s_cbranch_scc1 k2_carry_done
    v_fma_f32 v20, v24, v28, v136
    v_fma_f32 v21, v24, v29, v138
    v_fma_f32 v20, -v25, v29, v20
    v_fma_f32 v21, v25, v28, v21
    v_mov_b32 v28, v20
    v_mov_b32 v29, v21
    v_fma_f32 v20, v26, v30, v137
    v_fma_f32 v21, v26, v31, v139
    v_fma_f32 v20, -v27, v31, v20
    v_fma_f32 v21, v27, v30, v21
    v_mov_b32 v30, v20
    v_mov_b32 v31, v21
    s_cmp_le_u32 s56, 3
    s_cbranch_scc1 k2_carry_done
    v_fma_f32 v20, v24, v28, v140
    v_fma_f32 v21, v24, v29, v142
    v_fma_f32 v20, -v25, v29, v20
    v_fma_f32 v21, v25, v28, v21
    v_mov_b32 v28, v20
    v_mov_b32 v29, v21
    v_fma_f32 v20, v26, v30, v141
    v_fma_f32 v21, v26, v31, v143
    v_fma_f32 v20, -v27, v31, v20
    v_fma_f32 v21, v27, v30, v21
    v_mov_b32 v30, v20
    v_mov_b32 v31, v21
    s_cmp_le_u32 s56, 4
    s_cbranch_scc1 k2_carry_done
    v_fma_f32 v20, v24, v28, v144
    v_fma_f32 v21, v24, v29, v146
    v_fma_f32 v20, -v25, v29, v20
    v_fma_f32 v21, v25, v28, v21
    v_mov_b32 v28, v20
    v_mov_b32 v29, v21
    v_fma_f32 v20, v26, v30, v145
    v_fma_f32 v21, v26, v31, v147
    v_fma_f32 v20, -v27, v31, v20
    v_fma_f32 v21, v27, v30, v21
    v_mov_b32 v30, v20
    v_mov_b32 v31, v21
    s_cmp_le_u32 s56, 5
    s_cbranch_scc1 k2_carry_done
    v_fma_f32 v20, v24, v28, v148
    v_fma_f32 v21, v24, v29, v150
    v_fma_f32 v20, -v25, v29, v20
    v_fma_f32 v21, v25, v28, v21
    v_mov_b32 v28, v20
    v_mov_b32 v29, v21
    v_fma_f32 v20, v26, v30, v149
    v_fma_f32 v21, v26, v31, v151
    v_fma_f32 v20, -v27, v31, v20
    v_fma_f32 v21, v27, v30, v21
    v_mov_b32 v30, v20
    v_mov_b32 v31, v21
    s_cmp_le_u32 s56, 6
    s_cbranch_scc1 k2_carry_done
    v_fma_f32 v20, v24, v28, v152
    v_fma_f32 v21, v24, v29, v154
    v_fma_f32 v20, -v25, v29, v20
    v_fma_f32 v21, v25, v28, v21
    v_mov_b32 v28, v20
    v_mov_b32 v29, v21
    v_fma_f32 v20, v26, v30, v153
    v_fma_f32 v21, v26, v31, v155
    v_fma_f32 v20, -v27, v31, v20
    v_fma_f32 v21, v27, v30, v21
    v_mov_b32 v30, v20
    v_mov_b32 v31, v21
    s_cmp_le_u32 s56, 7
    s_cbranch_scc1 k2_carry_done
    v_fma_f32 v20, v24, v28, v156
    v_fma_f32 v21, v24, v29, v158
    v_fma_f32 v20, -v25, v29, v20
    v_fma_f32 v21, v25, v28, v21
    v_mov_b32 v28, v20
    v_mov_b32 v29, v21
    v_fma_f32 v20, v26, v30, v157
    v_fma_f32 v21, v26, v31, v159
    v_fma_f32 v20, -v27, v31, v20
    v_fma_f32 v21, v27, v30, v21
    v_mov_b32 v30, v20
    v_mov_b32 v31, v21
    s_cmp_le_u32 s56, 8
    s_cbranch_scc1 k2_carry_done
    v_fma_f32 v20, v24, v28, v160
    v_fma_f32 v21, v24, v29, v162
    v_fma_f32 v20, -v25, v29, v20
    v_fma_f32 v21, v25, v28, v21
    v_mov_b32 v28, v20
    v_mov_b32 v29, v21
    v_fma_f32 v20, v26, v30, v161
    v_fma_f32 v21, v26, v31, v163
    v_fma_f32 v20, -v27, v31, v20
    v_fma_f32 v21, v27, v30, v21
    v_mov_b32 v30, v20
    v_mov_b32 v31, v21
    s_cmp_le_u32 s56, 9
    s_cbranch_scc1 k2_carry_done
    v_fma_f32 v20, v24, v28, v164
    v_fma_f32 v21, v24, v29, v166
    v_fma_f32 v20, -v25, v29, v20
    v_fma_f32 v21, v25, v28, v21
    v_mov_b32 v28, v20
    v_mov_b32 v29, v21
    v_fma_f32 v20, v26, v30, v165
    v_fma_f32 v21, v26, v31, v167
    v_fma_f32 v20, -v27, v31, v20
    v_fma_f32 v21, v27, v30, v21
    v_mov_b32 v30, v20
    v_mov_b32 v31, v21
    s_cmp_le_u32 s56, 10
    s_cbranch_scc1 k2_carry_done
    v_fma_f32 v20, v24, v28, v168
    v_fma_f32 v21, v24, v29, v170
    v_fma_f32 v20, -v25, v29, v20
    v_fma_f32 v21, v25, v28, v21
    v_mov_b32 v28, v20
    v_mov_b32 v29, v21
    v_fma_f32 v20, v26, v30, v169
    v_fma_f32 v21, v26, v31, v171
    v_fma_f32 v20, -v27, v31, v20
    v_fma_f32 v21, v27, v30, v21
    v_mov_b32 v30, v20
    v_mov_b32 v31, v21
    s_cmp_le_u32 s56, 11
    s_cbranch_scc1 k2_carry_done
    v_fma_f32 v20, v24, v28, v172
    v_fma_f32 v21, v24, v29, v174
    v_fma_f32 v20, -v25, v29, v20
    v_fma_f32 v21, v25, v28, v21
    v_mov_b32 v28, v20
    v_mov_b32 v29, v21
    v_fma_f32 v20, v26, v30, v173
    v_fma_f32 v21, v26, v31, v175
    v_fma_f32 v20, -v27, v31, v20
    v_fma_f32 v21, v27, v30, v21
    v_mov_b32 v30, v20
    v_mov_b32 v31, v21
    s_cmp_le_u32 s56, 12
    s_cbranch_scc1 k2_carry_done
    v_fma_f32 v20, v24, v28, v176
    v_fma_f32 v21, v24, v29, v178
    v_fma_f32 v20, -v25, v29, v20
    v_fma_f32 v21, v25, v28, v21
    v_mov_b32 v28, v20
    v_mov_b32 v29, v21
    v_fma_f32 v20, v26, v30, v177
    v_fma_f32 v21, v26, v31, v179
    v_fma_f32 v20, -v27, v31, v20
    v_fma_f32 v21, v27, v30, v21
    v_mov_b32 v30, v20
    v_mov_b32 v31, v21
    s_cmp_le_u32 s56, 13
    s_cbranch_scc1 k2_carry_done
    v_fma_f32 v20, v24, v28, v180
    v_fma_f32 v21, v24, v29, v182
    v_fma_f32 v20, -v25, v29, v20
    v_fma_f32 v21, v25, v28, v21
    v_mov_b32 v28, v20
    v_mov_b32 v29, v21
    v_fma_f32 v20, v26, v30, v181
    v_fma_f32 v21, v26, v31, v183
    v_fma_f32 v20, -v27, v31, v20
    v_fma_f32 v21, v27, v30, v21
    v_mov_b32 v30, v20
    v_mov_b32 v31, v21
    s_cmp_le_u32 s56, 14
    s_cbranch_scc1 k2_carry_done
    v_fma_f32 v20, v24, v28, v184
    v_fma_f32 v21, v24, v29, v186
    v_fma_f32 v20, -v25, v29, v20
    v_fma_f32 v21, v25, v28, v21
    v_mov_b32 v28, v20
    v_mov_b32 v29, v21
    v_fma_f32 v20, v26, v30, v185
    v_fma_f32 v21, v26, v31, v187
    v_fma_f32 v20, -v27, v31, v20
    v_fma_f32 v21, v27, v30, v21
    v_mov_b32 v30, v20
    v_mov_b32 v31, v21
    s_cmp_le_u32 s56, 15
    s_cbranch_scc1 k2_carry_done
    v_fma_f32 v20, v24, v28, v188
    v_fma_f32 v21, v24, v29, v190
    v_fma_f32 v20, -v25, v29, v20
    v_fma_f32 v21, v25, v28, v21
    v_mov_b32 v28, v20
    v_mov_b32 v29, v21
    v_fma_f32 v20, v26, v30, v189
    v_fma_f32 v21, v26, v31, v191
    v_fma_f32 v20, -v27, v31, v20
    v_fma_f32 v21, v27, v30, v21
    v_mov_b32 v30, v20
    v_mov_b32 v31, v21
    s_cmp_le_u32 s56, 16
    s_cbranch_scc1 k2_carry_done
    v_fma_f32 v20, v24, v28, v192
    v_fma_f32 v21, v24, v29, v194
    v_fma_f32 v20, -v25, v29, v20
    v_fma_f32 v21, v25, v28, v21
    v_mov_b32 v28, v20
    v_mov_b32 v29, v21
    v_fma_f32 v20, v26, v30, v193
    v_fma_f32 v21, v26, v31, v195
    v_fma_f32 v20, -v27, v31, v20
    v_fma_f32 v21, v27, v30, v21
    v_mov_b32 v30, v20
    v_mov_b32 v31, v21
    s_cmp_le_u32 s56, 17
    s_cbranch_scc1 k2_carry_done
    v_fma_f32 v20, v24, v28, v196
    v_fma_f32 v21, v24, v29, v198
    v_fma_f32 v20, -v25, v29, v20
    v_fma_f32 v21, v25, v28, v21
    v_mov_b32 v28, v20
    v_mov_b32 v29, v21
    v_fma_f32 v20, v26, v30, v197
    v_fma_f32 v21, v26, v31, v199
    v_fma_f32 v20, -v27, v31, v20
    v_fma_f32 v21, v27, v30, v21
    v_mov_b32 v30, v20
    v_mov_b32 v31, v21
    s_cmp_le_u32 s56, 18
    s_cbranch_scc1 k2_carry_done
    v_fma_f32 v20, v24, v28, v200
    v_fma_f32 v21, v24, v29, v202
    v_fma_f32 v20, -v25, v29, v20
    v_fma_f32 v21, v25, v28, v21
    v_mov_b32 v28, v20
    v_mov_b32 v29, v21
    v_fma_f32 v20, v26, v30, v201
    v_fma_f32 v21, v26, v31, v203
    v_fma_f32 v20, -v27, v31, v20
    v_fma_f32 v21, v27, v30, v21
    v_mov_b32 v30, v20
    v_mov_b32 v31, v21
    s_cmp_le_u32 s56, 19
    s_cbranch_scc1 k2_carry_done
    v_fma_f32 v20, v24, v28, v204
    v_fma_f32 v21, v24, v29, v206
    v_fma_f32 v20, -v25, v29, v20
    v_fma_f32 v21, v25, v28, v21
    v_mov_b32 v28, v20
    v_mov_b32 v29, v21
    v_fma_f32 v20, v26, v30, v205
    v_fma_f32 v21, v26, v31, v207
    v_fma_f32 v20, -v27, v31, v20
    v_fma_f32 v21, v27, v30, v21
    v_mov_b32 v30, v20
    v_mov_b32 v31, v21
    s_cmp_le_u32 s56, 20
    s_cbranch_scc1 k2_carry_done
    v_fma_f32 v20, v24, v28, v208
    v_fma_f32 v21, v24, v29, v210
    v_fma_f32 v20, -v25, v29, v20
    v_fma_f32 v21, v25, v28, v21
    v_mov_b32 v28, v20
    v_mov_b32 v29, v21
    v_fma_f32 v20, v26, v30, v209
    v_fma_f32 v21, v26, v31, v211
    v_fma_f32 v20, -v27, v31, v20
    v_fma_f32 v21, v27, v30, v21
    v_mov_b32 v30, v20
    v_mov_b32 v31, v21
    s_cmp_le_u32 s56, 21
    s_cbranch_scc1 k2_carry_done
    v_fma_f32 v20, v24, v28, v212
    v_fma_f32 v21, v24, v29, v214
    v_fma_f32 v20, -v25, v29, v20
    v_fma_f32 v21, v25, v28, v21
    v_mov_b32 v28, v20
    v_mov_b32 v29, v21
    v_fma_f32 v20, v26, v30, v213
    v_fma_f32 v21, v26, v31, v215
    v_fma_f32 v20, -v27, v31, v20
    v_fma_f32 v21, v27, v30, v21
    v_mov_b32 v30, v20
    v_mov_b32 v31, v21
    s_cmp_le_u32 s56, 22
    s_cbranch_scc1 k2_carry_done
    v_fma_f32 v20, v24, v28, v216
    v_fma_f32 v21, v24, v29, v218
    v_fma_f32 v20, -v25, v29, v20
    v_fma_f32 v21, v25, v28, v21
    v_mov_b32 v28, v20
    v_mov_b32 v29, v21
    v_fma_f32 v20, v26, v30, v217
    v_fma_f32 v21, v26, v31, v219
    v_fma_f32 v20, -v27, v31, v20
    v_fma_f32 v21, v27, v30, v21
    v_mov_b32 v30, v20
    v_mov_b32 v31, v21
    s_cmp_le_u32 s56, 23
    s_cbranch_scc1 k2_carry_done
    v_fma_f32 v20, v24, v28, v220
    v_fma_f32 v21, v24, v29, v222
    v_fma_f32 v20, -v25, v29, v20
    v_fma_f32 v21, v25, v28, v21
    v_mov_b32 v28, v20
    v_mov_b32 v29, v21
    v_fma_f32 v20, v26, v30, v221
    v_fma_f32 v21, v26, v31, v223
    v_fma_f32 v20, -v27, v31, v20
    v_fma_f32 v21, v27, v30, v21
    v_mov_b32 v30, v20
    v_mov_b32 v31, v21
    s_cmp_le_u32 s56, 24
    s_cbranch_scc1 k2_carry_done
    v_fma_f32 v20, v24, v28, v224
    v_fma_f32 v21, v24, v29, v226
    v_fma_f32 v20, -v25, v29, v20
    v_fma_f32 v21, v25, v28, v21
    v_mov_b32 v28, v20
    v_mov_b32 v29, v21
    v_fma_f32 v20, v26, v30, v225
    v_fma_f32 v21, v26, v31, v227
    v_fma_f32 v20, -v27, v31, v20
    v_fma_f32 v21, v27, v30, v21
    v_mov_b32 v30, v20
    v_mov_b32 v31, v21
    s_cmp_le_u32 s56, 25
    s_cbranch_scc1 k2_carry_done
    v_fma_f32 v20, v24, v28, v228
    v_fma_f32 v21, v24, v29, v230
    v_fma_f32 v20, -v25, v29, v20
    v_fma_f32 v21, v25, v28, v21
    v_mov_b32 v28, v20
    v_mov_b32 v29, v21
    v_fma_f32 v20, v26, v30, v229
    v_fma_f32 v21, v26, v31, v231
    v_fma_f32 v20, -v27, v31, v20
    v_fma_f32 v21, v27, v30, v21
    v_mov_b32 v30, v20
    v_mov_b32 v31, v21
    s_cmp_le_u32 s56, 26
    s_cbranch_scc1 k2_carry_done
    v_fma_f32 v20, v24, v28, v232
    v_fma_f32 v21, v24, v29, v234
    v_fma_f32 v20, -v25, v29, v20
    v_fma_f32 v21, v25, v28, v21
    v_mov_b32 v28, v20
    v_mov_b32 v29, v21
    v_fma_f32 v20, v26, v30, v233
    v_fma_f32 v21, v26, v31, v235
    v_fma_f32 v20, -v27, v31, v20
    v_fma_f32 v21, v27, v30, v21
    v_mov_b32 v30, v20
    v_mov_b32 v31, v21
    s_cmp_le_u32 s56, 27
    s_cbranch_scc1 k2_carry_done
    v_fma_f32 v20, v24, v28, v236
    v_fma_f32 v21, v24, v29, v238
    v_fma_f32 v20, -v25, v29, v20
    v_fma_f32 v21, v25, v28, v21
    v_mov_b32 v28, v20
    v_mov_b32 v29, v21
    v_fma_f32 v20, v26, v30, v237
    v_fma_f32 v21, v26, v31, v239
    v_fma_f32 v20, -v27, v31, v20
    v_fma_f32 v21, v27, v30, v21
    v_mov_b32 v30, v20
    v_mov_b32 v31, v21
    s_cmp_le_u32 s56, 28
    s_cbranch_scc1 k2_carry_done
    v_fma_f32 v20, v24, v28, v240
    v_fma_f32 v21, v24, v29, v242
    v_fma_f32 v20, -v25, v29, v20
    v_fma_f32 v21, v25, v28, v21
    v_mov_b32 v28, v20
    v_mov_b32 v29, v21
    v_fma_f32 v20, v26, v30, v241
    v_fma_f32 v21, v26, v31, v243
    v_fma_f32 v20, -v27, v31, v20
    v_fma_f32 v21, v27, v30, v21
    v_mov_b32 v30, v20
    v_mov_b32 v31, v21
    s_cmp_le_u32 s56, 29
    s_cbranch_scc1 k2_carry_done
    v_fma_f32 v20, v24, v28, v244
    v_fma_f32 v21, v24, v29, v246
    v_fma_f32 v20, -v25, v29, v20
    v_fma_f32 v21, v25, v28, v21
    v_mov_b32 v28, v20
    v_mov_b32 v29, v21
    v_fma_f32 v20, v26, v30, v245
    v_fma_f32 v21, v26, v31, v247
    v_fma_f32 v20, -v27, v31, v20
    v_fma_f32 v21, v27, v30, v21
    v_mov_b32 v30, v20
    v_mov_b32 v31, v21
    s_cmp_le_u32 s56, 30
    s_cbranch_scc1 k2_carry_done
    v_fma_f32 v20, v24, v28, v248
    v_fma_f32 v21, v24, v29, v250
    v_fma_f32 v20, -v25, v29, v20
    v_fma_f32 v21, v25, v28, v21
    v_mov_b32 v28, v20
    v_mov_b32 v29, v21
    v_fma_f32 v20, v26, v30, v249
    v_fma_f32 v21, v26, v31, v251
    v_fma_f32 v20, -v27, v31, v20
    v_fma_f32 v21, v27, v30, v21
    v_mov_b32 v30, v20
    v_mov_b32 v31, v21
k2_carry_done:
    s_lshl_b32 s57, s56, 18
    v_lshlrev_b32 v6, 3, v0
    v_mov_b32 v7, s57
    v_add_u32 v6, v7, v6
    s_lshl_b32 s57, s56, 17
    v_lshlrev_b32 v7, 2, v0
    v_mov_b32 v2, s57
    v_add_u32 v7, v2, v7
    s_mov_b32 s43, 0
    buffer_load_dwordx2 v[64:65], v6, s[4:7], s43 offen
    buffer_load_dwordx2 v[66:67], v6, s[4:7], s43 offen offset:2048
    s_mov_b32 s43, 4096
    buffer_load_dwordx2 v[68:69], v6, s[4:7], s43 offen
    buffer_load_dwordx2 v[70:71], v6, s[4:7], s43 offen offset:2048
    s_mov_b32 s43, 8192
    buffer_load_dwordx2 v[72:73], v6, s[4:7], s43 offen
    buffer_load_dwordx2 v[74:75], v6, s[4:7], s43 offen offset:2048
    s_mov_b32 s43, 12288
    buffer_load_dwordx2 v[76:77], v6, s[4:7], s43 offen
    buffer_load_dwordx2 v[78:79], v6, s[4:7], s43 offen offset:2048
    s_mov_b32 s43, 16384
    buffer_load_dwordx2 v[80:81], v6, s[4:7], s43 offen
    buffer_load_dwordx2 v[82:83], v6, s[4:7], s43 offen offset:2048
    s_mov_b32 s43, 20480
    buffer_load_dwordx2 v[84:85], v6, s[4:7], s43 offen
    buffer_load_dwordx2 v[86:87], v6, s[4:7], s43 offen offset:2048
    s_mov_b32 s43, 24576
    buffer_load_dwordx2 v[88:89], v6, s[4:7], s43 offen
    buffer_load_dwordx2 v[90:91], v6, s[4:7], s43 offen offset:2048
    s_mov_b32 s43, 28672
    buffer_load_dwordx2 v[92:93], v6, s[4:7], s43 offen
    buffer_load_dwordx2 v[94:95], v6, s[4:7], s43 offen offset:2048
    s_mov_b32 s43, 32768
    buffer_load_dwordx2 v[96:97], v6, s[4:7], s43 offen
    buffer_load_dwordx2 v[98:99], v6, s[4:7], s43 offen offset:2048
    s_mov_b32 s43, 36864
    buffer_load_dwordx2 v[100:101], v6, s[4:7], s43 offen
    buffer_load_dwordx2 v[102:103], v6, s[4:7], s43 offen offset:2048
    s_mov_b32 s43, 40960
    buffer_load_dwordx2 v[104:105], v6, s[4:7], s43 offen
    buffer_load_dwordx2 v[106:107], v6, s[4:7], s43 offen offset:2048
    s_mov_b32 s43, 45056
    buffer_load_dwordx2 v[108:109], v6, s[4:7], s43 offen
    buffer_load_dwordx2 v[110:111], v6, s[4:7], s43 offen offset:2048
    s_mov_b32 s43, 49152
    buffer_load_dwordx2 v[112:113], v6, s[4:7], s43 offen
    buffer_load_dwordx2 v[114:115], v6, s[4:7], s43 offen offset:2048
    s_mov_b32 s43, 53248
    buffer_load_dwordx2 v[116:117], v6, s[4:7], s43 offen
    buffer_load_dwordx2 v[118:119], v6, s[4:7], s43 offen offset:2048
    s_mov_b32 s43, 57344
    buffer_load_dwordx2 v[120:121], v6, s[4:7], s43 offen
    buffer_load_dwordx2 v[122:123], v6, s[4:7], s43 offen offset:2048
    s_mov_b32 s43, 61440
    buffer_load_dwordx2 v[124:125], v6, s[4:7], s43 offen
    buffer_load_dwordx2 v[126:127], v6, s[4:7], s43 offen offset:2048
    s_waitcnt vmcnt(30)
    v_mul_f32 v20, v15, v29
    v_mul_f32 v21, v15, v28
    v_fma_f32 v28, v14, v28, -v20
    v_fma_f32 v29, v14, v29, v21
    v_mul_f32 v20, v17, v31
    v_mul_f32 v21, v17, v30
    v_fma_f32 v30, v16, v30, -v20
    v_fma_f32 v31, v16, v31, v21
    v_add_f32 v64, v64, v28
    v_add_f32 v65, v65, v30
    v_add_f32 v66, v66, v29
    v_add_f32 v67, v67, v31
    v_cvt_pk_bf16_f32 v32, v64, v65
    v_cvt_pk_bf16_f32 v33, -v66, -v67
    s_mov_b32 s43, 0
    buffer_store_dword v32, v7, s[12:15], s43 offen
    buffer_store_dword v33, v7, s[12:15], s43 offen offset:1024
    s_waitcnt vmcnt(30)
    v_mul_f32 v20, v15, v29
    v_mul_f32 v21, v15, v28
    v_fma_f32 v28, v14, v28, -v20
    v_fma_f32 v29, v14, v29, v21
    v_mul_f32 v20, v17, v31
    v_mul_f32 v21, v17, v30
    v_fma_f32 v30, v16, v30, -v20
    v_fma_f32 v31, v16, v31, v21
    v_add_f32 v68, v68, v28
    v_add_f32 v69, v69, v30
    v_add_f32 v70, v70, v29
    v_add_f32 v71, v71, v31
    v_cvt_pk_bf16_f32 v34, v68, v69
    v_cvt_pk_bf16_f32 v35, -v70, -v71
    s_mov_b32 s43, 2048
    buffer_store_dword v34, v7, s[12:15], s43 offen
    buffer_store_dword v35, v7, s[12:15], s43 offen offset:1024
    s_waitcnt vmcnt(30)
    v_mul_f32 v20, v15, v29
    v_mul_f32 v21, v15, v28
    v_fma_f32 v28, v14, v28, -v20
    v_fma_f32 v29, v14, v29, v21
    v_mul_f32 v20, v17, v31
    v_mul_f32 v21, v17, v30
    v_fma_f32 v30, v16, v30, -v20
    v_fma_f32 v31, v16, v31, v21
    v_add_f32 v72, v72, v28
    v_add_f32 v73, v73, v30
    v_add_f32 v74, v74, v29
    v_add_f32 v75, v75, v31
    v_cvt_pk_bf16_f32 v36, v72, v73
    v_cvt_pk_bf16_f32 v37, -v74, -v75
    s_mov_b32 s43, 4096
    buffer_store_dword v36, v7, s[12:15], s43 offen
    buffer_store_dword v37, v7, s[12:15], s43 offen offset:1024
    s_waitcnt vmcnt(30)
    v_mul_f32 v20, v15, v29
    v_mul_f32 v21, v15, v28
    v_fma_f32 v28, v14, v28, -v20
    v_fma_f32 v29, v14, v29, v21
    v_mul_f32 v20, v17, v31
    v_mul_f32 v21, v17, v30
    v_fma_f32 v30, v16, v30, -v20
    v_fma_f32 v31, v16, v31, v21
    v_add_f32 v76, v76, v28
    v_add_f32 v77, v77, v30
    v_add_f32 v78, v78, v29
    v_add_f32 v79, v79, v31
    v_cvt_pk_bf16_f32 v38, v76, v77
    v_cvt_pk_bf16_f32 v39, -v78, -v79
    s_mov_b32 s43, 6144
    buffer_store_dword v38, v7, s[12:15], s43 offen
    buffer_store_dword v39, v7, s[12:15], s43 offen offset:1024
    s_waitcnt vmcnt(30)
    v_mul_f32 v20, v15, v29
    v_mul_f32 v21, v15, v28
    v_fma_f32 v28, v14, v28, -v20
    v_fma_f32 v29, v14, v29, v21
    v_mul_f32 v20, v17, v31
    v_mul_f32 v21, v17, v30
    v_fma_f32 v30, v16, v30, -v20
    v_fma_f32 v31, v16, v31, v21
    v_add_f32 v80, v80, v28
    v_add_f32 v81, v81, v30
    v_add_f32 v82, v82, v29
    v_add_f32 v83, v83, v31
    v_cvt_pk_bf16_f32 v40, v80, v81
    v_cvt_pk_bf16_f32 v41, -v82, -v83
    s_mov_b32 s43, 8192
    buffer_store_dword v40, v7, s[12:15], s43 offen
    buffer_store_dword v41, v7, s[12:15], s43 offen offset:1024
    s_waitcnt vmcnt(30)
    v_mul_f32 v20, v15, v29
    v_mul_f32 v21, v15, v28
    v_fma_f32 v28, v14, v28, -v20
    v_fma_f32 v29, v14, v29, v21
    v_mul_f32 v20, v17, v31
    v_mul_f32 v21, v17, v30
    v_fma_f32 v30, v16, v30, -v20
    v_fma_f32 v31, v16, v31, v21
    v_add_f32 v84, v84, v28
    v_add_f32 v85, v85, v30
    v_add_f32 v86, v86, v29
    v_add_f32 v87, v87, v31
    v_cvt_pk_bf16_f32 v42, v84, v85
    v_cvt_pk_bf16_f32 v43, -v86, -v87
    s_mov_b32 s43, 10240
    buffer_store_dword v42, v7, s[12:15], s43 offen
    buffer_store_dword v43, v7, s[12:15], s43 offen offset:1024
    s_waitcnt vmcnt(30)
    v_mul_f32 v20, v15, v29
    v_mul_f32 v21, v15, v28
    v_fma_f32 v28, v14, v28, -v20
    v_fma_f32 v29, v14, v29, v21
    v_mul_f32 v20, v17, v31
    v_mul_f32 v21, v17, v30
    v_fma_f32 v30, v16, v30, -v20
    v_fma_f32 v31, v16, v31, v21
    v_add_f32 v88, v88, v28
    v_add_f32 v89, v89, v30
    v_add_f32 v90, v90, v29
    v_add_f32 v91, v91, v31
    v_cvt_pk_bf16_f32 v44, v88, v89
    v_cvt_pk_bf16_f32 v45, -v90, -v91
    s_mov_b32 s43, 12288
    buffer_store_dword v44, v7, s[12:15], s43 offen
    buffer_store_dword v45, v7, s[12:15], s43 offen offset:1024
    s_waitcnt vmcnt(30)
    v_mul_f32 v20, v15, v29
    v_mul_f32 v21, v15, v28
    v_fma_f32 v28, v14, v28, -v20
    v_fma_f32 v29, v14, v29, v21
    v_mul_f32 v20, v17, v31
    v_mul_f32 v21, v17, v30
    v_fma_f32 v30, v16, v30, -v20
    v_fma_f32 v31, v16, v31, v21
    v_add_f32 v92, v92, v28
    v_add_f32 v93, v93, v30
    v_add_f32 v94, v94, v29
    v_add_f32 v95, v95, v31
    v_cvt_pk_bf16_f32 v46, v92, v93
    v_cvt_pk_bf16_f32 v47, -v94, -v95
    s_mov_b32 s43, 14336
    buffer_store_dword v46, v7, s[12:15], s43 offen
    buffer_store_dword v47, v7, s[12:15], s43 offen offset:1024
    s_waitcnt vmcnt(30)
    v_mul_f32 v20, v15, v29
    v_mul_f32 v21, v15, v28
    v_fma_f32 v28, v14, v28, -v20
    v_fma_f32 v29, v14, v29, v21
    v_mul_f32 v20, v17, v31
    v_mul_f32 v21, v17, v30
    v_fma_f32 v30, v16, v30, -v20
    v_fma_f32 v31, v16, v31, v21
    v_add_f32 v96, v96, v28
    v_add_f32 v97, v97, v30
    v_add_f32 v98, v98, v29
    v_add_f32 v99, v99, v31
    v_cvt_pk_bf16_f32 v32, v96, v97
    v_cvt_pk_bf16_f32 v33, -v98, -v99
    s_mov_b32 s43, 16384
    buffer_store_dword v32, v7, s[12:15], s43 offen
    buffer_store_dword v33, v7, s[12:15], s43 offen offset:1024
    s_waitcnt vmcnt(30)
    v_mul_f32 v20, v15, v29
    v_mul_f32 v21, v15, v28
    v_fma_f32 v28, v14, v28, -v20
    v_fma_f32 v29, v14, v29, v21
    v_mul_f32 v20, v17, v31
    v_mul_f32 v21, v17, v30
    v_fma_f32 v30, v16, v30, -v20
    v_fma_f32 v31, v16, v31, v21
    v_add_f32 v100, v100, v28
    v_add_f32 v101, v101, v30
    v_add_f32 v102, v102, v29
    v_add_f32 v103, v103, v31
    v_cvt_pk_bf16_f32 v34, v100, v101
    v_cvt_pk_bf16_f32 v35, -v102, -v103
    s_mov_b32 s43, 18432
    buffer_store_dword v34, v7, s[12:15], s43 offen
    buffer_store_dword v35, v7, s[12:15], s43 offen offset:1024
    s_waitcnt vmcnt(30)
    v_mul_f32 v20, v15, v29
    v_mul_f32 v21, v15, v28
    v_fma_f32 v28, v14, v28, -v20
    v_fma_f32 v29, v14, v29, v21
    v_mul_f32 v20, v17, v31
    v_mul_f32 v21, v17, v30
    v_fma_f32 v30, v16, v30, -v20
    v_fma_f32 v31, v16, v31, v21
    v_add_f32 v104, v104, v28
    v_add_f32 v105, v105, v30
    v_add_f32 v106, v106, v29
    v_add_f32 v107, v107, v31
    v_cvt_pk_bf16_f32 v36, v104, v105
    v_cvt_pk_bf16_f32 v37, -v106, -v107
    s_mov_b32 s43, 20480
    buffer_store_dword v36, v7, s[12:15], s43 offen
    buffer_store_dword v37, v7, s[12:15], s43 offen offset:1024
    s_waitcnt vmcnt(30)
    v_mul_f32 v20, v15, v29
    v_mul_f32 v21, v15, v28
    v_fma_f32 v28, v14, v28, -v20
    v_fma_f32 v29, v14, v29, v21
    v_mul_f32 v20, v17, v31
    v_mul_f32 v21, v17, v30
    v_fma_f32 v30, v16, v30, -v20
    v_fma_f32 v31, v16, v31, v21
    v_add_f32 v108, v108, v28
    v_add_f32 v109, v109, v30
    v_add_f32 v110, v110, v29
    v_add_f32 v111, v111, v31
    v_cvt_pk_bf16_f32 v38, v108, v109
    v_cvt_pk_bf16_f32 v39, -v110, -v111
    s_mov_b32 s43, 22528
    buffer_store_dword v38, v7, s[12:15], s43 offen
    buffer_store_dword v39, v7, s[12:15], s43 offen offset:1024
    s_waitcnt vmcnt(30)
    v_mul_f32 v20, v15, v29
    v_mul_f32 v21, v15, v28
    v_fma_f32 v28, v14, v28, -v20
    v_fma_f32 v29, v14, v29, v21
    v_mul_f32 v20, v17, v31
    v_mul_f32 v21, v17, v30
    v_fma_f32 v30, v16, v30, -v20
    v_fma_f32 v31, v16, v31, v21
    v_add_f32 v112, v112, v28
    v_add_f32 v113, v113, v30
    v_add_f32 v114, v114, v29
    v_add_f32 v115, v115, v31
    v_cvt_pk_bf16_f32 v40, v112, v113
    v_cvt_pk_bf16_f32 v41, -v114, -v115
    s_mov_b32 s43, 24576
    buffer_store_dword v40, v7, s[12:15], s43 offen
    buffer_store_dword v41, v7, s[12:15], s43 offen offset:1024
    s_waitcnt vmcnt(30)
    v_mul_f32 v20, v15, v29
    v_mul_f32 v21, v15, v28
    v_fma_f32 v28, v14, v28, -v20
    v_fma_f32 v29, v14, v29, v21
    v_mul_f32 v20, v17, v31
    v_mul_f32 v21, v17, v30
    v_fma_f32 v30, v16, v30, -v20
    v_fma_f32 v31, v16, v31, v21
    v_add_f32 v116, v116, v28
    v_add_f32 v117, v117, v30
    v_add_f32 v118, v118, v29
    v_add_f32 v119, v119, v31
    v_cvt_pk_bf16_f32 v42, v116, v117
    v_cvt_pk_bf16_f32 v43, -v118, -v119
    s_mov_b32 s43, 26624
    buffer_store_dword v42, v7, s[12:15], s43 offen
    buffer_store_dword v43, v7, s[12:15], s43 offen offset:1024
    s_waitcnt vmcnt(30)
    v_mul_f32 v20, v15, v29
    v_mul_f32 v21, v15, v28
    v_fma_f32 v28, v14, v28, -v20
    v_fma_f32 v29, v14, v29, v21
    v_mul_f32 v20, v17, v31
    v_mul_f32 v21, v17, v30
    v_fma_f32 v30, v16, v30, -v20
    v_fma_f32 v31, v16, v31, v21
    v_add_f32 v120, v120, v28
    v_add_f32 v121, v121, v30
    v_add_f32 v122, v122, v29
    v_add_f32 v123, v123, v31
    v_cvt_pk_bf16_f32 v44, v120, v121
    v_cvt_pk_bf16_f32 v45, -v122, -v123
    s_mov_b32 s43, 28672
    buffer_store_dword v44, v7, s[12:15], s43 offen
    buffer_store_dword v45, v7, s[12:15], s43 offen offset:1024
    s_waitcnt vmcnt(30)
    v_mul_f32 v20, v15, v29
    v_mul_f32 v21, v15, v28
    v_fma_f32 v28, v14, v28, -v20
    v_fma_f32 v29, v14, v29, v21
    v_mul_f32 v20, v17, v31
    v_mul_f32 v21, v17, v30
    v_fma_f32 v30, v16, v30, -v20
    v_fma_f32 v31, v16, v31, v21
    v_add_f32 v124, v124, v28
    v_add_f32 v125, v125, v30
    v_add_f32 v126, v126, v29
    v_add_f32 v127, v127, v31
    v_cvt_pk_bf16_f32 v46, v124, v125
    v_cvt_pk_bf16_f32 v47, -v126, -v127
    s_mov_b32 s43, 30720
    buffer_store_dword v46, v7, s[12:15], s43 offen
    buffer_store_dword v47, v7, s[12:15], s43 offen offset:1024
    s_mov_b32 s43, 65536
    buffer_load_dwordx2 v[64:65], v6, s[4:7], s43 offen
    buffer_load_dwordx2 v[66:67], v6, s[4:7], s43 offen offset:2048
    s_mov_b32 s43, 69632
    buffer_load_dwordx2 v[68:69], v6, s[4:7], s43 offen
    buffer_load_dwordx2 v[70:71], v6, s[4:7], s43 offen offset:2048
    s_mov_b32 s43, 73728
    buffer_load_dwordx2 v[72:73], v6, s[4:7], s43 offen
    buffer_load_dwordx2 v[74:75], v6, s[4:7], s43 offen offset:2048
    s_mov_b32 s43, 77824
    buffer_load_dwordx2 v[76:77], v6, s[4:7], s43 offen
    buffer_load_dwordx2 v[78:79], v6, s[4:7], s43 offen offset:2048
    s_mov_b32 s43, 81920
    buffer_load_dwordx2 v[80:81], v6, s[4:7], s43 offen
    buffer_load_dwordx2 v[82:83], v6, s[4:7], s43 offen offset:2048
    s_mov_b32 s43, 86016
    buffer_load_dwordx2 v[84:85], v6, s[4:7], s43 offen
    buffer_load_dwordx2 v[86:87], v6, s[4:7], s43 offen offset:2048
    s_mov_b32 s43, 90112
    buffer_load_dwordx2 v[88:89], v6, s[4:7], s43 offen
    buffer_load_dwordx2 v[90:91], v6, s[4:7], s43 offen offset:2048
    s_mov_b32 s43, 94208
    buffer_load_dwordx2 v[92:93], v6, s[4:7], s43 offen
    buffer_load_dwordx2 v[94:95], v6, s[4:7], s43 offen offset:2048
    s_mov_b32 s43, 98304
    buffer_load_dwordx2 v[96:97], v6, s[4:7], s43 offen
    buffer_load_dwordx2 v[98:99], v6, s[4:7], s43 offen offset:2048
    s_mov_b32 s43, 102400
    buffer_load_dwordx2 v[100:101], v6, s[4:7], s43 offen
    buffer_load_dwordx2 v[102:103], v6, s[4:7], s43 offen offset:2048
    s_mov_b32 s43, 106496
    buffer_load_dwordx2 v[104:105], v6, s[4:7], s43 offen
    buffer_load_dwordx2 v[106:107], v6, s[4:7], s43 offen offset:2048
    s_mov_b32 s43, 110592
    buffer_load_dwordx2 v[108:109], v6, s[4:7], s43 offen
    buffer_load_dwordx2 v[110:111], v6, s[4:7], s43 offen offset:2048
    s_mov_b32 s43, 114688
    buffer_load_dwordx2 v[112:113], v6, s[4:7], s43 offen
    buffer_load_dwordx2 v[114:115], v6, s[4:7], s43 offen offset:2048
    s_mov_b32 s43, 118784
    buffer_load_dwordx2 v[116:117], v6, s[4:7], s43 offen
    buffer_load_dwordx2 v[118:119], v6, s[4:7], s43 offen offset:2048
    s_mov_b32 s43, 122880
    buffer_load_dwordx2 v[120:121], v6, s[4:7], s43 offen
    buffer_load_dwordx2 v[122:123], v6, s[4:7], s43 offen offset:2048
    s_mov_b32 s43, 126976
    buffer_load_dwordx2 v[124:125], v6, s[4:7], s43 offen
    buffer_load_dwordx2 v[126:127], v6, s[4:7], s43 offen offset:2048
    s_waitcnt vmcnt(30)
    v_mul_f32 v20, v15, v29
    v_mul_f32 v21, v15, v28
    v_fma_f32 v28, v14, v28, -v20
    v_fma_f32 v29, v14, v29, v21
    v_mul_f32 v20, v17, v31
    v_mul_f32 v21, v17, v30
    v_fma_f32 v30, v16, v30, -v20
    v_fma_f32 v31, v16, v31, v21
    v_add_f32 v64, v64, v28
    v_add_f32 v65, v65, v30
    v_add_f32 v66, v66, v29
    v_add_f32 v67, v67, v31
    v_cvt_pk_bf16_f32 v32, v64, v65
    v_cvt_pk_bf16_f32 v33, -v66, -v67
    s_mov_b32 s43, 32768
    buffer_store_dword v32, v7, s[12:15], s43 offen
    buffer_store_dword v33, v7, s[12:15], s43 offen offset:1024
    s_waitcnt vmcnt(30)
    v_mul_f32 v20, v15, v29
    v_mul_f32 v21, v15, v28
    v_fma_f32 v28, v14, v28, -v20
    v_fma_f32 v29, v14, v29, v21
    v_mul_f32 v20, v17, v31
    v_mul_f32 v21, v17, v30
    v_fma_f32 v30, v16, v30, -v20
    v_fma_f32 v31, v16, v31, v21
    v_add_f32 v68, v68, v28
    v_add_f32 v69, v69, v30
    v_add_f32 v70, v70, v29
    v_add_f32 v71, v71, v31
    v_cvt_pk_bf16_f32 v34, v68, v69
    v_cvt_pk_bf16_f32 v35, -v70, -v71
    s_mov_b32 s43, 34816
    buffer_store_dword v34, v7, s[12:15], s43 offen
    buffer_store_dword v35, v7, s[12:15], s43 offen offset:1024
    s_waitcnt vmcnt(30)
    v_mul_f32 v20, v15, v29
    v_mul_f32 v21, v15, v28
    v_fma_f32 v28, v14, v28, -v20
    v_fma_f32 v29, v14, v29, v21
    v_mul_f32 v20, v17, v31
    v_mul_f32 v21, v17, v30
    v_fma_f32 v30, v16, v30, -v20
    v_fma_f32 v31, v16, v31, v21
    v_add_f32 v72, v72, v28
    v_add_f32 v73, v73, v30
    v_add_f32 v74, v74, v29
    v_add_f32 v75, v75, v31
    v_cvt_pk_bf16_f32 v36, v72, v73
    v_cvt_pk_bf16_f32 v37, -v74, -v75
    s_mov_b32 s43, 36864
    buffer_store_dword v36, v7, s[12:15], s43 offen
    buffer_store_dword v37, v7, s[12:15], s43 offen offset:1024
    s_waitcnt vmcnt(30)
    v_mul_f32 v20, v15, v29
    v_mul_f32 v21, v15, v28
    v_fma_f32 v28, v14, v28, -v20
    v_fma_f32 v29, v14, v29, v21
    v_mul_f32 v20, v17, v31
    v_mul_f32 v21, v17, v30
    v_fma_f32 v30, v16, v30, -v20
    v_fma_f32 v31, v16, v31, v21
    v_add_f32 v76, v76, v28
    v_add_f32 v77, v77, v30
    v_add_f32 v78, v78, v29
    v_add_f32 v79, v79, v31
    v_cvt_pk_bf16_f32 v38, v76, v77
    v_cvt_pk_bf16_f32 v39, -v78, -v79
    s_mov_b32 s43, 38912
    buffer_store_dword v38, v7, s[12:15], s43 offen
    buffer_store_dword v39, v7, s[12:15], s43 offen offset:1024
    s_waitcnt vmcnt(30)
    v_mul_f32 v20, v15, v29
    v_mul_f32 v21, v15, v28
    v_fma_f32 v28, v14, v28, -v20
    v_fma_f32 v29, v14, v29, v21
    v_mul_f32 v20, v17, v31
    v_mul_f32 v21, v17, v30
    v_fma_f32 v30, v16, v30, -v20
    v_fma_f32 v31, v16, v31, v21
    v_add_f32 v80, v80, v28
    v_add_f32 v81, v81, v30
    v_add_f32 v82, v82, v29
    v_add_f32 v83, v83, v31
    v_cvt_pk_bf16_f32 v40, v80, v81
    v_cvt_pk_bf16_f32 v41, -v82, -v83
    s_mov_b32 s43, 40960
    buffer_store_dword v40, v7, s[12:15], s43 offen
    buffer_store_dword v41, v7, s[12:15], s43 offen offset:1024
    s_waitcnt vmcnt(30)
    v_mul_f32 v20, v15, v29
    v_mul_f32 v21, v15, v28
    v_fma_f32 v28, v14, v28, -v20
    v_fma_f32 v29, v14, v29, v21
    v_mul_f32 v20, v17, v31
    v_mul_f32 v21, v17, v30
    v_fma_f32 v30, v16, v30, -v20
    v_fma_f32 v31, v16, v31, v21
    v_add_f32 v84, v84, v28
    v_add_f32 v85, v85, v30
    v_add_f32 v86, v86, v29
    v_add_f32 v87, v87, v31
    v_cvt_pk_bf16_f32 v42, v84, v85
    v_cvt_pk_bf16_f32 v43, -v86, -v87
    s_mov_b32 s43, 43008
    buffer_store_dword v42, v7, s[12:15], s43 offen
    buffer_store_dword v43, v7, s[12:15], s43 offen offset:1024
    s_waitcnt vmcnt(30)
    v_mul_f32 v20, v15, v29
    v_mul_f32 v21, v15, v28
    v_fma_f32 v28, v14, v28, -v20
    v_fma_f32 v29, v14, v29, v21
    v_mul_f32 v20, v17, v31
    v_mul_f32 v21, v17, v30
    v_fma_f32 v30, v16, v30, -v20
    v_fma_f32 v31, v16, v31, v21
    v_add_f32 v88, v88, v28
    v_add_f32 v89, v89, v30
    v_add_f32 v90, v90, v29
    v_add_f32 v91, v91, v31
    v_cvt_pk_bf16_f32 v44, v88, v89
    v_cvt_pk_bf16_f32 v45, -v90, -v91
    s_mov_b32 s43, 45056
    buffer_store_dword v44, v7, s[12:15], s43 offen
    buffer_store_dword v45, v7, s[12:15], s43 offen offset:1024
    s_waitcnt vmcnt(30)
    v_mul_f32 v20, v15, v29
    v_mul_f32 v21, v15, v28
    v_fma_f32 v28, v14, v28, -v20
    v_fma_f32 v29, v14, v29, v21
    v_mul_f32 v20, v17, v31
    v_mul_f32 v21, v17, v30
    v_fma_f32 v30, v16, v30, -v20
    v_fma_f32 v31, v16, v31, v21
    v_add_f32 v92, v92, v28
    v_add_f32 v93, v93, v30
    v_add_f32 v94, v94, v29
    v_add_f32 v95, v95, v31
    v_cvt_pk_bf16_f32 v46, v92, v93
    v_cvt_pk_bf16_f32 v47, -v94, -v95
    s_mov_b32 s43, 47104
    buffer_store_dword v46, v7, s[12:15], s43 offen
    buffer_store_dword v47, v7, s[12:15], s43 offen offset:1024
    s_waitcnt vmcnt(30)
    v_mul_f32 v20, v15, v29
    v_mul_f32 v21, v15, v28
    v_fma_f32 v28, v14, v28, -v20
    v_fma_f32 v29, v14, v29, v21
    v_mul_f32 v20, v17, v31
    v_mul_f32 v21, v17, v30
    v_fma_f32 v30, v16, v30, -v20
    v_fma_f32 v31, v16, v31, v21
    v_add_f32 v96, v96, v28
    v_add_f32 v97, v97, v30
    v_add_f32 v98, v98, v29
    v_add_f32 v99, v99, v31
    v_cvt_pk_bf16_f32 v32, v96, v97
    v_cvt_pk_bf16_f32 v33, -v98, -v99
    s_mov_b32 s43, 49152
    buffer_store_dword v32, v7, s[12:15], s43 offen
    buffer_store_dword v33, v7, s[12:15], s43 offen offset:1024
    s_waitcnt vmcnt(30)
    v_mul_f32 v20, v15, v29
    v_mul_f32 v21, v15, v28
    v_fma_f32 v28, v14, v28, -v20
    v_fma_f32 v29, v14, v29, v21
    v_mul_f32 v20, v17, v31
    v_mul_f32 v21, v17, v30
    v_fma_f32 v30, v16, v30, -v20
    v_fma_f32 v31, v16, v31, v21
    v_add_f32 v100, v100, v28
    v_add_f32 v101, v101, v30
    v_add_f32 v102, v102, v29
    v_add_f32 v103, v103, v31
    v_cvt_pk_bf16_f32 v34, v100, v101
    v_cvt_pk_bf16_f32 v35, -v102, -v103
    s_mov_b32 s43, 51200
    buffer_store_dword v34, v7, s[12:15], s43 offen
    buffer_store_dword v35, v7, s[12:15], s43 offen offset:1024
    s_waitcnt vmcnt(30)
    v_mul_f32 v20, v15, v29
    v_mul_f32 v21, v15, v28
    v_fma_f32 v28, v14, v28, -v20
    v_fma_f32 v29, v14, v29, v21
    v_mul_f32 v20, v17, v31
    v_mul_f32 v21, v17, v30
    v_fma_f32 v30, v16, v30, -v20
    v_fma_f32 v31, v16, v31, v21
    v_add_f32 v104, v104, v28
    v_add_f32 v105, v105, v30
    v_add_f32 v106, v106, v29
    v_add_f32 v107, v107, v31
    v_cvt_pk_bf16_f32 v36, v104, v105
    v_cvt_pk_bf16_f32 v37, -v106, -v107
    s_mov_b32 s43, 53248
    buffer_store_dword v36, v7, s[12:15], s43 offen
    buffer_store_dword v37, v7, s[12:15], s43 offen offset:1024
    s_waitcnt vmcnt(30)
    v_mul_f32 v20, v15, v29
    v_mul_f32 v21, v15, v28
    v_fma_f32 v28, v14, v28, -v20
    v_fma_f32 v29, v14, v29, v21
    v_mul_f32 v20, v17, v31
    v_mul_f32 v21, v17, v30
    v_fma_f32 v30, v16, v30, -v20
    v_fma_f32 v31, v16, v31, v21
    v_add_f32 v108, v108, v28
    v_add_f32 v109, v109, v30
    v_add_f32 v110, v110, v29
    v_add_f32 v111, v111, v31
    v_cvt_pk_bf16_f32 v38, v108, v109
    v_cvt_pk_bf16_f32 v39, -v110, -v111
    s_mov_b32 s43, 55296
    buffer_store_dword v38, v7, s[12:15], s43 offen
    buffer_store_dword v39, v7, s[12:15], s43 offen offset:1024
    s_waitcnt vmcnt(30)
    v_mul_f32 v20, v15, v29
    v_mul_f32 v21, v15, v28
    v_fma_f32 v28, v14, v28, -v20
    v_fma_f32 v29, v14, v29, v21
    v_mul_f32 v20, v17, v31
    v_mul_f32 v21, v17, v30
    v_fma_f32 v30, v16, v30, -v20
    v_fma_f32 v31, v16, v31, v21
    v_add_f32 v112, v112, v28
    v_add_f32 v113, v113, v30
    v_add_f32 v114, v114, v29
    v_add_f32 v115, v115, v31
    v_cvt_pk_bf16_f32 v40, v112, v113
    v_cvt_pk_bf16_f32 v41, -v114, -v115
    s_mov_b32 s43, 57344
    buffer_store_dword v40, v7, s[12:15], s43 offen
    buffer_store_dword v41, v7, s[12:15], s43 offen offset:1024
    s_waitcnt vmcnt(30)
    v_mul_f32 v20, v15, v29
    v_mul_f32 v21, v15, v28
    v_fma_f32 v28, v14, v28, -v20
    v_fma_f32 v29, v14, v29, v21
    v_mul_f32 v20, v17, v31
    v_mul_f32 v21, v17, v30
    v_fma_f32 v30, v16, v30, -v20
    v_fma_f32 v31, v16, v31, v21
    v_add_f32 v116, v116, v28
    v_add_f32 v117, v117, v30
    v_add_f32 v118, v118, v29
    v_add_f32 v119, v119, v31
    v_cvt_pk_bf16_f32 v42, v116, v117
    v_cvt_pk_bf16_f32 v43, -v118, -v119
    s_mov_b32 s43, 59392
    buffer_store_dword v42, v7, s[12:15], s43 offen
    buffer_store_dword v43, v7, s[12:15], s43 offen offset:1024
    s_waitcnt vmcnt(30)
    v_mul_f32 v20, v15, v29
    v_mul_f32 v21, v15, v28
    v_fma_f32 v28, v14, v28, -v20
    v_fma_f32 v29, v14, v29, v21
    v_mul_f32 v20, v17, v31
    v_mul_f32 v21, v17, v30
    v_fma_f32 v30, v16, v30, -v20
    v_fma_f32 v31, v16, v31, v21
    v_add_f32 v120, v120, v28
    v_add_f32 v121, v121, v30
    v_add_f32 v122, v122, v29
    v_add_f32 v123, v123, v31
    v_cvt_pk_bf16_f32 v44, v120, v121
    v_cvt_pk_bf16_f32 v45, -v122, -v123
    s_mov_b32 s43, 61440
    buffer_store_dword v44, v7, s[12:15], s43 offen
    buffer_store_dword v45, v7, s[12:15], s43 offen offset:1024
    s_waitcnt vmcnt(30)
    v_mul_f32 v20, v15, v29
    v_mul_f32 v21, v15, v28
    v_fma_f32 v28, v14, v28, -v20
    v_fma_f32 v29, v14, v29, v21
    v_mul_f32 v20, v17, v31
    v_mul_f32 v21, v17, v30
    v_fma_f32 v30, v16, v30, -v20
    v_fma_f32 v31, v16, v31, v21
    v_add_f32 v124, v124, v28
    v_add_f32 v125, v125, v30
    v_add_f32 v126, v126, v29
    v_add_f32 v127, v127, v31
    v_cvt_pk_bf16_f32 v46, v124, v125
    v_cvt_pk_bf16_f32 v47, -v126, -v127
    s_mov_b32 s43, 63488
    buffer_store_dword v46, v7, s[12:15], s43 offen
    buffer_store_dword v47, v7, s[12:15], s43 offen offset:1024
    s_mov_b32 s43, 131072
    buffer_load_dwordx2 v[64:65], v6, s[4:7], s43 offen
    buffer_load_dwordx2 v[66:67], v6, s[4:7], s43 offen offset:2048
    s_mov_b32 s43, 135168
    buffer_load_dwordx2 v[68:69], v6, s[4:7], s43 offen
    buffer_load_dwordx2 v[70:71], v6, s[4:7], s43 offen offset:2048
    s_mov_b32 s43, 139264
    buffer_load_dwordx2 v[72:73], v6, s[4:7], s43 offen
    buffer_load_dwordx2 v[74:75], v6, s[4:7], s43 offen offset:2048
    s_mov_b32 s43, 143360
    buffer_load_dwordx2 v[76:77], v6, s[4:7], s43 offen
    buffer_load_dwordx2 v[78:79], v6, s[4:7], s43 offen offset:2048
    s_mov_b32 s43, 147456
    buffer_load_dwordx2 v[80:81], v6, s[4:7], s43 offen
    buffer_load_dwordx2 v[82:83], v6, s[4:7], s43 offen offset:2048
    s_mov_b32 s43, 151552
    buffer_load_dwordx2 v[84:85], v6, s[4:7], s43 offen
    buffer_load_dwordx2 v[86:87], v6, s[4:7], s43 offen offset:2048
    s_mov_b32 s43, 155648
    buffer_load_dwordx2 v[88:89], v6, s[4:7], s43 offen
    buffer_load_dwordx2 v[90:91], v6, s[4:7], s43 offen offset:2048
    s_mov_b32 s43, 159744
    buffer_load_dwordx2 v[92:93], v6, s[4:7], s43 offen
    buffer_load_dwordx2 v[94:95], v6, s[4:7], s43 offen offset:2048
    s_mov_b32 s43, 163840
    buffer_load_dwordx2 v[96:97], v6, s[4:7], s43 offen
    buffer_load_dwordx2 v[98:99], v6, s[4:7], s43 offen offset:2048
    s_mov_b32 s43, 167936
    buffer_load_dwordx2 v[100:101], v6, s[4:7], s43 offen
    buffer_load_dwordx2 v[102:103], v6, s[4:7], s43 offen offset:2048
    s_mov_b32 s43, 172032
    buffer_load_dwordx2 v[104:105], v6, s[4:7], s43 offen
    buffer_load_dwordx2 v[106:107], v6, s[4:7], s43 offen offset:2048
    s_mov_b32 s43, 176128
    buffer_load_dwordx2 v[108:109], v6, s[4:7], s43 offen
    buffer_load_dwordx2 v[110:111], v6, s[4:7], s43 offen offset:2048
    s_mov_b32 s43, 180224
    buffer_load_dwordx2 v[112:113], v6, s[4:7], s43 offen
    buffer_load_dwordx2 v[114:115], v6, s[4:7], s43 offen offset:2048
    s_mov_b32 s43, 184320
    buffer_load_dwordx2 v[116:117], v6, s[4:7], s43 offen
    buffer_load_dwordx2 v[118:119], v6, s[4:7], s43 offen offset:2048
    s_mov_b32 s43, 188416
    buffer_load_dwordx2 v[120:121], v6, s[4:7], s43 offen
    buffer_load_dwordx2 v[122:123], v6, s[4:7], s43 offen offset:2048
    s_mov_b32 s43, 192512
    buffer_load_dwordx2 v[124:125], v6, s[4:7], s43 offen
    buffer_load_dwordx2 v[126:127], v6, s[4:7], s43 offen offset:2048
    s_waitcnt vmcnt(30)
    v_mul_f32 v20, v15, v29
    v_mul_f32 v21, v15, v28
    v_fma_f32 v28, v14, v28, -v20
    v_fma_f32 v29, v14, v29, v21
    v_mul_f32 v20, v17, v31
    v_mul_f32 v21, v17, v30
    v_fma_f32 v30, v16, v30, -v20
    v_fma_f32 v31, v16, v31, v21
    v_add_f32 v64, v64, v28
    v_add_f32 v65, v65, v30
    v_add_f32 v66, v66, v29
    v_add_f32 v67, v67, v31
    v_cvt_pk_bf16_f32 v32, v64, v65
    v_cvt_pk_bf16_f32 v33, -v66, -v67
    s_mov_b32 s43, 65536
    buffer_store_dword v32, v7, s[12:15], s43 offen
    buffer_store_dword v33, v7, s[12:15], s43 offen offset:1024
    s_waitcnt vmcnt(30)
    v_mul_f32 v20, v15, v29
    v_mul_f32 v21, v15, v28
    v_fma_f32 v28, v14, v28, -v20
    v_fma_f32 v29, v14, v29, v21
    v_mul_f32 v20, v17, v31
    v_mul_f32 v21, v17, v30
    v_fma_f32 v30, v16, v30, -v20
    v_fma_f32 v31, v16, v31, v21
    v_add_f32 v68, v68, v28
    v_add_f32 v69, v69, v30
    v_add_f32 v70, v70, v29
    v_add_f32 v71, v71, v31
    v_cvt_pk_bf16_f32 v34, v68, v69
    v_cvt_pk_bf16_f32 v35, -v70, -v71
    s_mov_b32 s43, 67584
    buffer_store_dword v34, v7, s[12:15], s43 offen
    buffer_store_dword v35, v7, s[12:15], s43 offen offset:1024
    s_waitcnt vmcnt(30)
    v_mul_f32 v20, v15, v29
    v_mul_f32 v21, v15, v28
    v_fma_f32 v28, v14, v28, -v20
    v_fma_f32 v29, v14, v29, v21
    v_mul_f32 v20, v17, v31
    v_mul_f32 v21, v17, v30
    v_fma_f32 v30, v16, v30, -v20
    v_fma_f32 v31, v16, v31, v21
    v_add_f32 v72, v72, v28
    v_add_f32 v73, v73, v30
    v_add_f32 v74, v74, v29
    v_add_f32 v75, v75, v31
    v_cvt_pk_bf16_f32 v36, v72, v73
    v_cvt_pk_bf16_f32 v37, -v74, -v75
    s_mov_b32 s43, 69632
    buffer_store_dword v36, v7, s[12:15], s43 offen
    buffer_store_dword v37, v7, s[12:15], s43 offen offset:1024
    s_waitcnt vmcnt(30)
    v_mul_f32 v20, v15, v29
    v_mul_f32 v21, v15, v28
    v_fma_f32 v28, v14, v28, -v20
    v_fma_f32 v29, v14, v29, v21
    v_mul_f32 v20, v17, v31
    v_mul_f32 v21, v17, v30
    v_fma_f32 v30, v16, v30, -v20
    v_fma_f32 v31, v16, v31, v21
    v_add_f32 v76, v76, v28
    v_add_f32 v77, v77, v30
    v_add_f32 v78, v78, v29
    v_add_f32 v79, v79, v31
    v_cvt_pk_bf16_f32 v38, v76, v77
    v_cvt_pk_bf16_f32 v39, -v78, -v79
    s_mov_b32 s43, 71680
    buffer_store_dword v38, v7, s[12:15], s43 offen
    buffer_store_dword v39, v7, s[12:15], s43 offen offset:1024
    s_waitcnt vmcnt(30)
    v_mul_f32 v20, v15, v29
    v_mul_f32 v21, v15, v28
    v_fma_f32 v28, v14, v28, -v20
    v_fma_f32 v29, v14, v29, v21
    v_mul_f32 v20, v17, v31
    v_mul_f32 v21, v17, v30
    v_fma_f32 v30, v16, v30, -v20
    v_fma_f32 v31, v16, v31, v21
    v_add_f32 v80, v80, v28
    v_add_f32 v81, v81, v30
    v_add_f32 v82, v82, v29
    v_add_f32 v83, v83, v31
    v_cvt_pk_bf16_f32 v40, v80, v81
    v_cvt_pk_bf16_f32 v41, -v82, -v83
    s_mov_b32 s43, 73728
    buffer_store_dword v40, v7, s[12:15], s43 offen
    buffer_store_dword v41, v7, s[12:15], s43 offen offset:1024
    s_waitcnt vmcnt(30)
    v_mul_f32 v20, v15, v29
    v_mul_f32 v21, v15, v28
    v_fma_f32 v28, v14, v28, -v20
    v_fma_f32 v29, v14, v29, v21
    v_mul_f32 v20, v17, v31
    v_mul_f32 v21, v17, v30
    v_fma_f32 v30, v16, v30, -v20
    v_fma_f32 v31, v16, v31, v21
    v_add_f32 v84, v84, v28
    v_add_f32 v85, v85, v30
    v_add_f32 v86, v86, v29
    v_add_f32 v87, v87, v31
    v_cvt_pk_bf16_f32 v42, v84, v85
    v_cvt_pk_bf16_f32 v43, -v86, -v87
    s_mov_b32 s43, 75776
    buffer_store_dword v42, v7, s[12:15], s43 offen
    buffer_store_dword v43, v7, s[12:15], s43 offen offset:1024
    s_waitcnt vmcnt(30)
    v_mul_f32 v20, v15, v29
    v_mul_f32 v21, v15, v28
    v_fma_f32 v28, v14, v28, -v20
    v_fma_f32 v29, v14, v29, v21
    v_mul_f32 v20, v17, v31
    v_mul_f32 v21, v17, v30
    v_fma_f32 v30, v16, v30, -v20
    v_fma_f32 v31, v16, v31, v21
    v_add_f32 v88, v88, v28
    v_add_f32 v89, v89, v30
    v_add_f32 v90, v90, v29
    v_add_f32 v91, v91, v31
    v_cvt_pk_bf16_f32 v44, v88, v89
    v_cvt_pk_bf16_f32 v45, -v90, -v91
    s_mov_b32 s43, 77824
    buffer_store_dword v44, v7, s[12:15], s43 offen
    buffer_store_dword v45, v7, s[12:15], s43 offen offset:1024
    s_waitcnt vmcnt(30)
    v_mul_f32 v20, v15, v29
    v_mul_f32 v21, v15, v28
    v_fma_f32 v28, v14, v28, -v20
    v_fma_f32 v29, v14, v29, v21
    v_mul_f32 v20, v17, v31
    v_mul_f32 v21, v17, v30
    v_fma_f32 v30, v16, v30, -v20
    v_fma_f32 v31, v16, v31, v21
    v_add_f32 v92, v92, v28
    v_add_f32 v93, v93, v30
    v_add_f32 v94, v94, v29
    v_add_f32 v95, v95, v31
    v_cvt_pk_bf16_f32 v46, v92, v93
    v_cvt_pk_bf16_f32 v47, -v94, -v95
    s_mov_b32 s43, 79872
    buffer_store_dword v46, v7, s[12:15], s43 offen
    buffer_store_dword v47, v7, s[12:15], s43 offen offset:1024
    s_waitcnt vmcnt(30)
    v_mul_f32 v20, v15, v29
    v_mul_f32 v21, v15, v28
    v_fma_f32 v28, v14, v28, -v20
    v_fma_f32 v29, v14, v29, v21
    v_mul_f32 v20, v17, v31
    v_mul_f32 v21, v17, v30
    v_fma_f32 v30, v16, v30, -v20
    v_fma_f32 v31, v16, v31, v21
    v_add_f32 v96, v96, v28
    v_add_f32 v97, v97, v30
    v_add_f32 v98, v98, v29
    v_add_f32 v99, v99, v31
    v_cvt_pk_bf16_f32 v32, v96, v97
    v_cvt_pk_bf16_f32 v33, -v98, -v99
    s_mov_b32 s43, 81920
    buffer_store_dword v32, v7, s[12:15], s43 offen
    buffer_store_dword v33, v7, s[12:15], s43 offen offset:1024
    s_waitcnt vmcnt(30)
    v_mul_f32 v20, v15, v29
    v_mul_f32 v21, v15, v28
    v_fma_f32 v28, v14, v28, -v20
    v_fma_f32 v29, v14, v29, v21
    v_mul_f32 v20, v17, v31
    v_mul_f32 v21, v17, v30
    v_fma_f32 v30, v16, v30, -v20
    v_fma_f32 v31, v16, v31, v21
    v_add_f32 v100, v100, v28
    v_add_f32 v101, v101, v30
    v_add_f32 v102, v102, v29
    v_add_f32 v103, v103, v31
    v_cvt_pk_bf16_f32 v34, v100, v101
    v_cvt_pk_bf16_f32 v35, -v102, -v103
    s_mov_b32 s43, 83968
    buffer_store_dword v34, v7, s[12:15], s43 offen
    buffer_store_dword v35, v7, s[12:15], s43 offen offset:1024
    s_waitcnt vmcnt(30)
    v_mul_f32 v20, v15, v29
    v_mul_f32 v21, v15, v28
    v_fma_f32 v28, v14, v28, -v20
    v_fma_f32 v29, v14, v29, v21
    v_mul_f32 v20, v17, v31
    v_mul_f32 v21, v17, v30
    v_fma_f32 v30, v16, v30, -v20
    v_fma_f32 v31, v16, v31, v21
    v_add_f32 v104, v104, v28
    v_add_f32 v105, v105, v30
    v_add_f32 v106, v106, v29
    v_add_f32 v107, v107, v31
    v_cvt_pk_bf16_f32 v36, v104, v105
    v_cvt_pk_bf16_f32 v37, -v106, -v107
    s_mov_b32 s43, 86016
    buffer_store_dword v36, v7, s[12:15], s43 offen
    buffer_store_dword v37, v7, s[12:15], s43 offen offset:1024
    s_waitcnt vmcnt(30)
    v_mul_f32 v20, v15, v29
    v_mul_f32 v21, v15, v28
    v_fma_f32 v28, v14, v28, -v20
    v_fma_f32 v29, v14, v29, v21
    v_mul_f32 v20, v17, v31
    v_mul_f32 v21, v17, v30
    v_fma_f32 v30, v16, v30, -v20
    v_fma_f32 v31, v16, v31, v21
    v_add_f32 v108, v108, v28
    v_add_f32 v109, v109, v30
    v_add_f32 v110, v110, v29
    v_add_f32 v111, v111, v31
    v_cvt_pk_bf16_f32 v38, v108, v109
    v_cvt_pk_bf16_f32 v39, -v110, -v111
    s_mov_b32 s43, 88064
    buffer_store_dword v38, v7, s[12:15], s43 offen
    buffer_store_dword v39, v7, s[12:15], s43 offen offset:1024
    s_waitcnt vmcnt(30)
    v_mul_f32 v20, v15, v29
    v_mul_f32 v21, v15, v28
    v_fma_f32 v28, v14, v28, -v20
    v_fma_f32 v29, v14, v29, v21
    v_mul_f32 v20, v17, v31
    v_mul_f32 v21, v17, v30
    v_fma_f32 v30, v16, v30, -v20
    v_fma_f32 v31, v16, v31, v21
    v_add_f32 v112, v112, v28
    v_add_f32 v113, v113, v30
    v_add_f32 v114, v114, v29
    v_add_f32 v115, v115, v31
    v_cvt_pk_bf16_f32 v40, v112, v113
    v_cvt_pk_bf16_f32 v41, -v114, -v115
    s_mov_b32 s43, 90112
    buffer_store_dword v40, v7, s[12:15], s43 offen
    buffer_store_dword v41, v7, s[12:15], s43 offen offset:1024
    s_waitcnt vmcnt(30)
    v_mul_f32 v20, v15, v29
    v_mul_f32 v21, v15, v28
    v_fma_f32 v28, v14, v28, -v20
    v_fma_f32 v29, v14, v29, v21
    v_mul_f32 v20, v17, v31
    v_mul_f32 v21, v17, v30
    v_fma_f32 v30, v16, v30, -v20
    v_fma_f32 v31, v16, v31, v21
    v_add_f32 v116, v116, v28
    v_add_f32 v117, v117, v30
    v_add_f32 v118, v118, v29
    v_add_f32 v119, v119, v31
    v_cvt_pk_bf16_f32 v42, v116, v117
    v_cvt_pk_bf16_f32 v43, -v118, -v119
    s_mov_b32 s43, 92160
    buffer_store_dword v42, v7, s[12:15], s43 offen
    buffer_store_dword v43, v7, s[12:15], s43 offen offset:1024
    s_waitcnt vmcnt(30)
    v_mul_f32 v20, v15, v29
    v_mul_f32 v21, v15, v28
    v_fma_f32 v28, v14, v28, -v20
    v_fma_f32 v29, v14, v29, v21
    v_mul_f32 v20, v17, v31
    v_mul_f32 v21, v17, v30
    v_fma_f32 v30, v16, v30, -v20
    v_fma_f32 v31, v16, v31, v21
    v_add_f32 v120, v120, v28
    v_add_f32 v121, v121, v30
    v_add_f32 v122, v122, v29
    v_add_f32 v123, v123, v31
    v_cvt_pk_bf16_f32 v44, v120, v121
    v_cvt_pk_bf16_f32 v45, -v122, -v123
    s_mov_b32 s43, 94208
    buffer_store_dword v44, v7, s[12:15], s43 offen
    buffer_store_dword v45, v7, s[12:15], s43 offen offset:1024
    s_waitcnt vmcnt(30)
    v_mul_f32 v20, v15, v29
    v_mul_f32 v21, v15, v28
    v_fma_f32 v28, v14, v28, -v20
    v_fma_f32 v29, v14, v29, v21
    v_mul_f32 v20, v17, v31
    v_mul_f32 v21, v17, v30
    v_fma_f32 v30, v16, v30, -v20
    v_fma_f32 v31, v16, v31, v21
    v_add_f32 v124, v124, v28
    v_add_f32 v125, v125, v30
    v_add_f32 v126, v126, v29
    v_add_f32 v127, v127, v31
    v_cvt_pk_bf16_f32 v46, v124, v125
    v_cvt_pk_bf16_f32 v47, -v126, -v127
    s_mov_b32 s43, 96256
    buffer_store_dword v46, v7, s[12:15], s43 offen
    buffer_store_dword v47, v7, s[12:15], s43 offen offset:1024
    s_mov_b32 s43, 196608
    buffer_load_dwordx2 v[64:65], v6, s[4:7], s43 offen
    buffer_load_dwordx2 v[66:67], v6, s[4:7], s43 offen offset:2048
    s_mov_b32 s43, 200704
    buffer_load_dwordx2 v[68:69], v6, s[4:7], s43 offen
    buffer_load_dwordx2 v[70:71], v6, s[4:7], s43 offen offset:2048
    s_mov_b32 s43, 204800
    buffer_load_dwordx2 v[72:73], v6, s[4:7], s43 offen
    buffer_load_dwordx2 v[74:75], v6, s[4:7], s43 offen offset:2048
    s_mov_b32 s43, 208896
    buffer_load_dwordx2 v[76:77], v6, s[4:7], s43 offen
    buffer_load_dwordx2 v[78:79], v6, s[4:7], s43 offen offset:2048
    s_mov_b32 s43, 212992
    buffer_load_dwordx2 v[80:81], v6, s[4:7], s43 offen
    buffer_load_dwordx2 v[82:83], v6, s[4:7], s43 offen offset:2048
    s_mov_b32 s43, 217088
    buffer_load_dwordx2 v[84:85], v6, s[4:7], s43 offen
    buffer_load_dwordx2 v[86:87], v6, s[4:7], s43 offen offset:2048
    s_mov_b32 s43, 221184
    buffer_load_dwordx2 v[88:89], v6, s[4:7], s43 offen
    buffer_load_dwordx2 v[90:91], v6, s[4:7], s43 offen offset:2048
    s_mov_b32 s43, 225280
    buffer_load_dwordx2 v[92:93], v6, s[4:7], s43 offen
    buffer_load_dwordx2 v[94:95], v6, s[4:7], s43 offen offset:2048
    s_mov_b32 s43, 229376
    buffer_load_dwordx2 v[96:97], v6, s[4:7], s43 offen
    buffer_load_dwordx2 v[98:99], v6, s[4:7], s43 offen offset:2048
    s_mov_b32 s43, 233472
    buffer_load_dwordx2 v[100:101], v6, s[4:7], s43 offen
    buffer_load_dwordx2 v[102:103], v6, s[4:7], s43 offen offset:2048
    s_mov_b32 s43, 237568
    buffer_load_dwordx2 v[104:105], v6, s[4:7], s43 offen
    buffer_load_dwordx2 v[106:107], v6, s[4:7], s43 offen offset:2048
    s_mov_b32 s43, 241664
    buffer_load_dwordx2 v[108:109], v6, s[4:7], s43 offen
    buffer_load_dwordx2 v[110:111], v6, s[4:7], s43 offen offset:2048
    s_mov_b32 s43, 245760
    buffer_load_dwordx2 v[112:113], v6, s[4:7], s43 offen
    buffer_load_dwordx2 v[114:115], v6, s[4:7], s43 offen offset:2048
    s_mov_b32 s43, 249856
    buffer_load_dwordx2 v[116:117], v6, s[4:7], s43 offen
    buffer_load_dwordx2 v[118:119], v6, s[4:7], s43 offen offset:2048
    s_mov_b32 s43, 253952
    buffer_load_dwordx2 v[120:121], v6, s[4:7], s43 offen
    buffer_load_dwordx2 v[122:123], v6, s[4:7], s43 offen offset:2048
    s_mov_b32 s43, 258048
    buffer_load_dwordx2 v[124:125], v6, s[4:7], s43 offen
    buffer_load_dwordx2 v[126:127], v6, s[4:7], s43 offen offset:2048
    s_waitcnt vmcnt(30)
    v_mul_f32 v20, v15, v29
    v_mul_f32 v21, v15, v28
    v_fma_f32 v28, v14, v28, -v20
    v_fma_f32 v29, v14, v29, v21
    v_mul_f32 v20, v17, v31
    v_mul_f32 v21, v17, v30
    v_fma_f32 v30, v16, v30, -v20
    v_fma_f32 v31, v16, v31, v21
    v_add_f32 v64, v64, v28
    v_add_f32 v65, v65, v30
    v_add_f32 v66, v66, v29
    v_add_f32 v67, v67, v31
    v_cvt_pk_bf16_f32 v32, v64, v65
    v_cvt_pk_bf16_f32 v33, -v66, -v67
    s_mov_b32 s43, 98304
    buffer_store_dword v32, v7, s[12:15], s43 offen
    buffer_store_dword v33, v7, s[12:15], s43 offen offset:1024
    s_waitcnt vmcnt(30)
    v_mul_f32 v20, v15, v29
    v_mul_f32 v21, v15, v28
    v_fma_f32 v28, v14, v28, -v20
    v_fma_f32 v29, v14, v29, v21
    v_mul_f32 v20, v17, v31
    v_mul_f32 v21, v17, v30
    v_fma_f32 v30, v16, v30, -v20
    v_fma_f32 v31, v16, v31, v21
    v_add_f32 v68, v68, v28
    v_add_f32 v69, v69, v30
    v_add_f32 v70, v70, v29
    v_add_f32 v71, v71, v31
    v_cvt_pk_bf16_f32 v34, v68, v69
    v_cvt_pk_bf16_f32 v35, -v70, -v71
    s_mov_b32 s43, 100352
    buffer_store_dword v34, v7, s[12:15], s43 offen
    buffer_store_dword v35, v7, s[12:15], s43 offen offset:1024
    s_waitcnt vmcnt(30)
    v_mul_f32 v20, v15, v29
    v_mul_f32 v21, v15, v28
    v_fma_f32 v28, v14, v28, -v20
    v_fma_f32 v29, v14, v29, v21
    v_mul_f32 v20, v17, v31
    v_mul_f32 v21, v17, v30
    v_fma_f32 v30, v16, v30, -v20
    v_fma_f32 v31, v16, v31, v21
    v_add_f32 v72, v72, v28
    v_add_f32 v73, v73, v30
    v_add_f32 v74, v74, v29
    v_add_f32 v75, v75, v31
    v_cvt_pk_bf16_f32 v36, v72, v73
    v_cvt_pk_bf16_f32 v37, -v74, -v75
    s_mov_b32 s43, 102400
    buffer_store_dword v36, v7, s[12:15], s43 offen
    buffer_store_dword v37, v7, s[12:15], s43 offen offset:1024
    s_waitcnt vmcnt(30)
    v_mul_f32 v20, v15, v29
    v_mul_f32 v21, v15, v28
    v_fma_f32 v28, v14, v28, -v20
    v_fma_f32 v29, v14, v29, v21
    v_mul_f32 v20, v17, v31
    v_mul_f32 v21, v17, v30
    v_fma_f32 v30, v16, v30, -v20
    v_fma_f32 v31, v16, v31, v21
    v_add_f32 v76, v76, v28
    v_add_f32 v77, v77, v30
    v_add_f32 v78, v78, v29
    v_add_f32 v79, v79, v31
    v_cvt_pk_bf16_f32 v38, v76, v77
    v_cvt_pk_bf16_f32 v39, -v78, -v79
    s_mov_b32 s43, 104448
    buffer_store_dword v38, v7, s[12:15], s43 offen
    buffer_store_dword v39, v7, s[12:15], s43 offen offset:1024
    s_waitcnt vmcnt(30)
    v_mul_f32 v20, v15, v29
    v_mul_f32 v21, v15, v28
    v_fma_f32 v28, v14, v28, -v20
    v_fma_f32 v29, v14, v29, v21
    v_mul_f32 v20, v17, v31
    v_mul_f32 v21, v17, v30
    v_fma_f32 v30, v16, v30, -v20
    v_fma_f32 v31, v16, v31, v21
    v_add_f32 v80, v80, v28
    v_add_f32 v81, v81, v30
    v_add_f32 v82, v82, v29
    v_add_f32 v83, v83, v31
    v_cvt_pk_bf16_f32 v40, v80, v81
    v_cvt_pk_bf16_f32 v41, -v82, -v83
    s_mov_b32 s43, 106496
    buffer_store_dword v40, v7, s[12:15], s43 offen
    buffer_store_dword v41, v7, s[12:15], s43 offen offset:1024
    s_waitcnt vmcnt(30)
    v_mul_f32 v20, v15, v29
    v_mul_f32 v21, v15, v28
    v_fma_f32 v28, v14, v28, -v20
    v_fma_f32 v29, v14, v29, v21
    v_mul_f32 v20, v17, v31
    v_mul_f32 v21, v17, v30
    v_fma_f32 v30, v16, v30, -v20
    v_fma_f32 v31, v16, v31, v21
    v_add_f32 v84, v84, v28
    v_add_f32 v85, v85, v30
    v_add_f32 v86, v86, v29
    v_add_f32 v87, v87, v31
    v_cvt_pk_bf16_f32 v42, v84, v85
    v_cvt_pk_bf16_f32 v43, -v86, -v87
    s_mov_b32 s43, 108544
    buffer_store_dword v42, v7, s[12:15], s43 offen
    buffer_store_dword v43, v7, s[12:15], s43 offen offset:1024
    s_waitcnt vmcnt(30)
    v_mul_f32 v20, v15, v29
    v_mul_f32 v21, v15, v28
    v_fma_f32 v28, v14, v28, -v20
    v_fma_f32 v29, v14, v29, v21
    v_mul_f32 v20, v17, v31
    v_mul_f32 v21, v17, v30
    v_fma_f32 v30, v16, v30, -v20
    v_fma_f32 v31, v16, v31, v21
    v_add_f32 v88, v88, v28
    v_add_f32 v89, v89, v30
    v_add_f32 v90, v90, v29
    v_add_f32 v91, v91, v31
    v_cvt_pk_bf16_f32 v44, v88, v89
    v_cvt_pk_bf16_f32 v45, -v90, -v91
    s_mov_b32 s43, 110592
    buffer_store_dword v44, v7, s[12:15], s43 offen
    buffer_store_dword v45, v7, s[12:15], s43 offen offset:1024
    s_waitcnt vmcnt(30)
    v_mul_f32 v20, v15, v29
    v_mul_f32 v21, v15, v28
    v_fma_f32 v28, v14, v28, -v20
    v_fma_f32 v29, v14, v29, v21
    v_mul_f32 v20, v17, v31
    v_mul_f32 v21, v17, v30
    v_fma_f32 v30, v16, v30, -v20
    v_fma_f32 v31, v16, v31, v21
    v_add_f32 v92, v92, v28
    v_add_f32 v93, v93, v30
    v_add_f32 v94, v94, v29
    v_add_f32 v95, v95, v31
    v_cvt_pk_bf16_f32 v46, v92, v93
    v_cvt_pk_bf16_f32 v47, -v94, -v95
    s_mov_b32 s43, 112640
    buffer_store_dword v46, v7, s[12:15], s43 offen
    buffer_store_dword v47, v7, s[12:15], s43 offen offset:1024
    s_waitcnt vmcnt(30)
    v_mul_f32 v20, v15, v29
    v_mul_f32 v21, v15, v28
    v_fma_f32 v28, v14, v28, -v20
    v_fma_f32 v29, v14, v29, v21
    v_mul_f32 v20, v17, v31
    v_mul_f32 v21, v17, v30
    v_fma_f32 v30, v16, v30, -v20
    v_fma_f32 v31, v16, v31, v21
    v_add_f32 v96, v96, v28
    v_add_f32 v97, v97, v30
    v_add_f32 v98, v98, v29
    v_add_f32 v99, v99, v31
    v_cvt_pk_bf16_f32 v32, v96, v97
    v_cvt_pk_bf16_f32 v33, -v98, -v99
    s_mov_b32 s43, 114688
    buffer_store_dword v32, v7, s[12:15], s43 offen
    buffer_store_dword v33, v7, s[12:15], s43 offen offset:1024
    s_waitcnt vmcnt(30)
    v_mul_f32 v20, v15, v29
    v_mul_f32 v21, v15, v28
    v_fma_f32 v28, v14, v28, -v20
    v_fma_f32 v29, v14, v29, v21
    v_mul_f32 v20, v17, v31
    v_mul_f32 v21, v17, v30
    v_fma_f32 v30, v16, v30, -v20
    v_fma_f32 v31, v16, v31, v21
    v_add_f32 v100, v100, v28
    v_add_f32 v101, v101, v30
    v_add_f32 v102, v102, v29
    v_add_f32 v103, v103, v31
    v_cvt_pk_bf16_f32 v34, v100, v101
    v_cvt_pk_bf16_f32 v35, -v102, -v103
    s_mov_b32 s43, 116736
    buffer_store_dword v34, v7, s[12:15], s43 offen
    buffer_store_dword v35, v7, s[12:15], s43 offen offset:1024
    s_waitcnt vmcnt(30)
    v_mul_f32 v20, v15, v29
    v_mul_f32 v21, v15, v28
    v_fma_f32 v28, v14, v28, -v20
    v_fma_f32 v29, v14, v29, v21
    v_mul_f32 v20, v17, v31
    v_mul_f32 v21, v17, v30
    v_fma_f32 v30, v16, v30, -v20
    v_fma_f32 v31, v16, v31, v21
    v_add_f32 v104, v104, v28
    v_add_f32 v105, v105, v30
    v_add_f32 v106, v106, v29
    v_add_f32 v107, v107, v31
    v_cvt_pk_bf16_f32 v36, v104, v105
    v_cvt_pk_bf16_f32 v37, -v106, -v107
    s_mov_b32 s43, 118784
    buffer_store_dword v36, v7, s[12:15], s43 offen
    buffer_store_dword v37, v7, s[12:15], s43 offen offset:1024
    s_waitcnt vmcnt(30)
    v_mul_f32 v20, v15, v29
    v_mul_f32 v21, v15, v28
    v_fma_f32 v28, v14, v28, -v20
    v_fma_f32 v29, v14, v29, v21
    v_mul_f32 v20, v17, v31
    v_mul_f32 v21, v17, v30
    v_fma_f32 v30, v16, v30, -v20
    v_fma_f32 v31, v16, v31, v21
    v_add_f32 v108, v108, v28
    v_add_f32 v109, v109, v30
    v_add_f32 v110, v110, v29
    v_add_f32 v111, v111, v31
    v_cvt_pk_bf16_f32 v38, v108, v109
    v_cvt_pk_bf16_f32 v39, -v110, -v111
    s_mov_b32 s43, 120832
    buffer_store_dword v38, v7, s[12:15], s43 offen
    buffer_store_dword v39, v7, s[12:15], s43 offen offset:1024
    s_waitcnt vmcnt(30)
    v_mul_f32 v20, v15, v29
    v_mul_f32 v21, v15, v28
    v_fma_f32 v28, v14, v28, -v20
    v_fma_f32 v29, v14, v29, v21
    v_mul_f32 v20, v17, v31
    v_mul_f32 v21, v17, v30
    v_fma_f32 v30, v16, v30, -v20
    v_fma_f32 v31, v16, v31, v21
    v_add_f32 v112, v112, v28
    v_add_f32 v113, v113, v30
    v_add_f32 v114, v114, v29
    v_add_f32 v115, v115, v31
    v_cvt_pk_bf16_f32 v40, v112, v113
    v_cvt_pk_bf16_f32 v41, -v114, -v115
    s_mov_b32 s43, 122880
    buffer_store_dword v40, v7, s[12:15], s43 offen
    buffer_store_dword v41, v7, s[12:15], s43 offen offset:1024
    s_waitcnt vmcnt(30)
    v_mul_f32 v20, v15, v29
    v_mul_f32 v21, v15, v28
    v_fma_f32 v28, v14, v28, -v20
    v_fma_f32 v29, v14, v29, v21
    v_mul_f32 v20, v17, v31
    v_mul_f32 v21, v17, v30
    v_fma_f32 v30, v16, v30, -v20
    v_fma_f32 v31, v16, v31, v21
    v_add_f32 v116, v116, v28
    v_add_f32 v117, v117, v30
    v_add_f32 v118, v118, v29
    v_add_f32 v119, v119, v31
    v_cvt_pk_bf16_f32 v42, v116, v117
    v_cvt_pk_bf16_f32 v43, -v118, -v119
    s_mov_b32 s43, 124928
    buffer_store_dword v42, v7, s[12:15], s43 offen
    buffer_store_dword v43, v7, s[12:15], s43 offen offset:1024
    s_waitcnt vmcnt(30)
    v_mul_f32 v20, v15, v29
    v_mul_f32 v21, v15, v28
    v_fma_f32 v28, v14, v28, -v20
    v_fma_f32 v29, v14, v29, v21
    v_mul_f32 v20, v17, v31
    v_mul_f32 v21, v17, v30
    v_fma_f32 v30, v16, v30, -v20
    v_fma_f32 v31, v16, v31, v21
    v_add_f32 v120, v120, v28
    v_add_f32 v121, v121, v30
    v_add_f32 v122, v122, v29
    v_add_f32 v123, v123, v31
    v_cvt_pk_bf16_f32 v44, v120, v121
    v_cvt_pk_bf16_f32 v45, -v122, -v123
    s_mov_b32 s43, 126976
    buffer_store_dword v44, v7, s[12:15], s43 offen
    buffer_store_dword v45, v7, s[12:15], s43 offen offset:1024
    s_waitcnt vmcnt(30)
    v_mul_f32 v20, v15, v29
    v_mul_f32 v21, v15, v28
    v_fma_f32 v28, v14, v28, -v20
    v_fma_f32 v29, v14, v29, v21
    v_mul_f32 v20, v17, v31
    v_mul_f32 v21, v17, v30
    v_fma_f32 v30, v16, v30, -v20
    v_fma_f32 v31, v16, v31, v21
    v_add_f32 v124, v124, v28
    v_add_f32 v125, v125, v30
    v_add_f32 v126, v126, v29
    v_add_f32 v127, v127, v31
    v_cvt_pk_bf16_f32 v46, v124, v125
    v_cvt_pk_bf16_f32 v47, -v126, -v127
    s_mov_b32 s43, 129024
    buffer_store_dword v46, v7, s[12:15], s43 offen
    buffer_store_dword v47, v7, s[12:15], s43 offen offset:1024
k2_end:
    s_endpgm
.section .rodata,"a"
.p2align 6
.amdhsa_kernel k2_kernel
  .amdhsa_next_free_vgpr 256
  .amdhsa_next_free_sgpr 102
  .amdhsa_accum_offset 256
  .amdhsa_group_segment_fixed_size 0
  .amdhsa_kernarg_size 136
  .amdhsa_user_sgpr_count 2
  .amdhsa_user_sgpr_kernarg_segment_ptr 1
  .amdhsa_system_sgpr_workgroup_id_x 1
.end_amdhsa_kernel
.text
.globl k3_kernel
.p2align 8
.type k3_kernel,@function
k3_kernel:
    s_cmp_ge_u32 s2, 256
    s_cbranch_scc1 k3_end
    s_load_dwordx2 s[24:25], s[0:1], 0
    s_load_dwordx4 s[68:71], s[0:1], 40
    s_load_dwordx2 s[26:27], s[0:1], 64
    s_load_dwordx4 s[72:75], s[0:1], 96
    s_load_dwordx2 s[76:77], s[0:1], 112
    s_load_dwordx2 s[28:29], s[0:1], 128
    s_and_b32 s30, s2, 7
    s_lshr_b32 s31, s2, 3
    s_lshr_b32 s32, s31, 3
    s_lshl_b32 s33, s30, 2
    s_add_u32 s33, s33, s32
    s_and_b32 s34, s31, 7
    v_and_b32 v1, 63, v0
    v_lshrrev_b32 v2, 6, v0
    s_nop 0
    v_readfirstlane_b32 s40, v2
    s_and_b32 s41, s40, 1
    s_lshr_b32 s42, s40, 1
    s_waitcnt lgkmcnt(0)
    s_mov_b32 s4, s72
    s_mov_b32 s5, s73
    s_and_b32 s5, s5, 0xffff
    s_mov_b32 s6, 7340032
    s_mov_b32 s7, 0x00020000
    s_add_u32 s8, s28, 17825792
    s_addc_u32 s9, s29, 0
    s_and_b32 s9, s9, 0xffff
    s_mov_b32 s10, 1835008
    s_mov_b32 s11, 0x00020000
    s_add_u32 s12, s28, 13631488
    s_addc_u32 s13, s29, 0
    s_and_b32 s13, s13, 0xffff
    s_mov_b32 s14, 4194304
    s_mov_b32 s15, 0x00020000
    s_mov_b32 s16, s68
    s_mov_b32 s17, s69
    s_and_b32 s17, s17, 0xffff
    s_mov_b32 s18, 524288
    s_mov_b32 s19, 0x00020000
    s_mov_b32 s20, s70
    s_mov_b32 s21, s71
    s_and_b32 s21, s21, 0xffff
    s_mov_b32 s22, 524288
    s_mov_b32 s23, 0x00020000
    s_mov_b32 s48, s24
    s_mov_b32 s49, s25
    s_and_b32 s49, s49, 0xffff
    s_mov_b32 s50, 2097152
    s_mov_b32 s51, 0x00020000
    s_mov_b32 s52, s28
    s_mov_b32 s53, s29
    s_and_b32 s53, s53, 0xffff
    s_mov_b32 s54, 2097152
    s_mov_b32 s55, 0x00020000
    s_mov_b32 s56, s76
    s_mov_b32 s57, s77
    s_and_b32 s57, s57, 0xffff
    s_mov_b32 s58, 4194304
    s_mov_b32 s59, 0x00020000
    s_mov_b32 s60, s74
    s_mov_b32 s61, s75
    s_and_b32 s61, s61, 0xffff
    s_mov_b32 s62, 4096
    s_mov_b32 s63, 0x00020000
    s_mov_b32 s64, s26
    s_mov_b32 s65, s27
    s_and_b32 s65, s65, 0xffff
    s_mov_b32 s66, 1024
    s_mov_b32 s67, 0x00020000
    s_lshl_b32 s45, s33, 7
    s_mul_i32 s46, s34, 64*3584
    s_lshl_b32 s47, s33, 17
    s_lshl_b32 s78, s34, 16
    v_lshrrev_b32 v2, 3, v1
    s_lshl_b32 s43, s40, 4
    v_add_u32 v2, s43, v2
    v_and_b32 v3, 7, v1
    v_lshrrev_b32 v4, 1, v2
    v_and_b32 v4, 1, v4
    v_lshlrev_b32 v4, 2, v4
    v_xor_b32 v3, v3, v4
    v_lshlrev_b32 v3, 4, v3
    s_mov_b32 s43, 4096
    v_mul_lo_u32 v2, v2, s43
    v_add_u32 v10, v2, v3
    v_add_u32 v10, s45, v10
    v_lshrrev_b32 v2, 3, v1
    s_lshl_b32 s43, s40, 4
    s_add_u32 s43, s43, 8
    v_add_u32 v2, s43, v2
    v_and_b32 v3, 7, v1
    v_lshrrev_b32 v4, 1, v2
    v_and_b32 v4, 1, v4
    v_lshlrev_b32 v4, 2, v4
    v_xor_b32 v3, v3, v4
    v_lshlrev_b32 v3, 4, v3
    s_mov_b32 s43, 4096
    v_mul_lo_u32 v2, v2, s43
    v_add_u32 v11, v2, v3
    v_add_u32 v11, s45, v11
    v_lshrrev_b32 v2, 3, v1
    s_lshl_b32 s43, s40, 4
    v_add_u32 v2, s43, v2
    v_and_b32 v3, 7, v1
    v_lshrrev_b32 v4, 1, v2
    v_and_b32 v4, 7, v4
    v_xor_b32 v3, v3, v4
    v_lshlrev_b32 v3, 4, v3
    s_mov_b32 s43, 3584
    v_mul_lo_u32 v2, v2, s43
    v_add_u32 v12, v2, v3
    v_add_u32 v12, s46, v12
    v_lshrrev_b32 v2, 3, v1
    s_lshl_b32 s43, s40, 4
    s_add_u32 s43, s43, 8
    v_add_u32 v2, s43, v2
    v_and_b32 v3, 7, v1
    v_lshrrev_b32 v4, 1, v2
    v_and_b32 v4, 7, v4
    v_xor_b32 v3, v3, v4
    v_lshlrev_b32 v3, 4, v3
    s_mov_b32 s43, 3584
    v_mul_lo_u32 v2, v2, s43
    v_add_u32 v13, v2, v3
    v_add_u32 v13, s46, v13
    v_lshrrev_b32 v2, 3, v1
    s_lshl_b32 s43, s40, 4
    v_add_u32 v2, s43, v2
    v_and_b32 v3, 7, v1
    v_lshrrev_b32 v4, 1, v2
    v_and_b32 v4, 7, v4
    v_xor_b32 v3, v3, v4
    v_lshlrev_b32 v3, 4, v3
    s_mov_b32 s43, 2048
    v_mul_lo_u32 v2, v2, s43
    v_add_u32 v14, v2, v3
    v_add_u32 v14, s47, v14
    v_lshrrev_b32 v2, 3, v1
    s_lshl_b32 s43, s40, 4
    s_add_u32 s43, s43, 8
    v_add_u32 v2, s43, v2
    v_and_b32 v3, 7, v1
    v_lshrrev_b32 v4, 1, v2
    v_and_b32 v4, 7, v4
    v_xor_b32 v3, v3, v4
    v_lshlrev_b32 v3, 4, v3
    s_mov_b32 s43, 2048
    v_mul_lo_u32 v2, v2, s43
    v_add_u32 v15, v2, v3
    v_add_u32 v15, s47, v15
    v_lshrrev_b32 v2, 3, v1
    s_lshl_b32 s43, s40, 4
    v_add_u32 v2, s43, v2
    v_and_b32 v3, 7, v1
    v_lshrrev_b32 v4, 1, v2
    v_and_b32 v4, 7, v4
    v_xor_b32 v3, v3, v4
    v_lshlrev_b32 v3, 4, v3
    s_mov_b32 s43, 1024
    v_mul_lo_u32 v2, v2, s43
    v_add_u32 v16, v2, v3
    v_add_u32 v16, s78, v16
    v_lshrrev_b32 v2, 3, v1
    s_lshl_b32 s43, s40, 4
    s_add_u32 s43, s43, 8
    v_add_u32 v2, s43, v2
    v_and_b32 v3, 7, v1
    v_lshrrev_b32 v4, 1, v2
    v_and_b32 v4, 7, v4
    v_xor_b32 v3, v3, v4
    v_lshlrev_b32 v3, 4, v3
    s_mov_b32 s43, 1024
    v_mul_lo_u32 v2, v2, s43
    v_add_u32 v17, v2, v3
    v_add_u32 v17, s78, v17
    v_lshrrev_b32 v2, 4, v1
    v_and_b32 v3, 15, v1
    v_lshrrev_b32 v4, 2, v3
    v_and_b32 v5, 3, v3
    v_lshrrev_b32 v18, 1, v2
    v_lshlrev_b32 v18, 3, v18
    v_add_u32 v18, v18, v4
    v_lshlrev_b32 v18, 7, v18
    v_and_b32 v2, 1, v2
    v_lshlrev_b32 v2, 1, v2
    v_lshrrev_b32 v3, 1, v5
    v_add_u32 v2, v2, v3
    s_lshl_b32 s43, s41, 2
    v_add_u32 v2, s43, v2
    v_lshrrev_b32 v4, 1, v4
    v_and_b32 v4, 1, v4
    v_lshlrev_b32 v4, 2, v4
    v_xor_b32 v2, v2, v4
    v_lshlrev_b32 v2, 4, v2
    v_add_u32 v18, v18, v2
    v_and_b32 v5, 1, v5
    v_lshlrev_b32 v5, 3, v5
    v_add_u32 v18, v18, v5
    v_add_u32 v19, 0x10000, v18
    v_and_b32 v2, 31, v1
    s_lshl_b32 s43, s42, 5
    v_add_u32 v2, s43, v2
    v_lshrrev_b32 v3, 1, v2
    v_and_b32 v3, 7, v3
    v_lshlrev_b32 v2, 7, v2
    v_lshrrev_b32 v4, 5, v1
    v_add_u32 v20, 0, v4
    v_xor_b32 v20, v20, v3
    v_lshlrev_b32 v20, 4, v20
    v_add_u32 v20, v20, v2
    v_add_u32 v24, 0x10000, v20
    v_add_u32 v21, 2, v4
    v_xor_b32 v21, v21, v3
    v_lshlrev_b32 v21, 4, v21
    v_add_u32 v21, v21, v2
    v_add_u32 v25, 0x10000, v21
    v_add_u32 v22, 4, v4
    v_xor_b32 v22, v22, v3
    v_lshlrev_b32 v22, 4, v22
    v_add_u32 v22, v22, v2
    v_add_u32 v26, 0x10000, v22
    v_add_u32 v23, 6, v4
    v_xor_b32 v23, v23, v3
    v_lshlrev_b32 v23, 4, v23
    v_add_u32 v23, v23, v2
    v_add_u32 v27, 0x10000, v23
    v_and_b32 v2, 31, v1
    s_lshl_b32 s43, s41, 5
    v_add_u32 v2, s43, v2
    v_lshrrev_b32 v3, 1, v2
    v_and_b32 v3, 7, v3
    v_lshlrev_b32 v2, 7, v2
    v_lshrrev_b32 v4, 5, v1
    v_add_u32 v28, 0, v4
    v_xor_b32 v28, v28, v3
    v_lshlrev_b32 v28, 4, v28
    v_add_u32 v28, v28, v2
    v_add_u32 v32, 0x10000, v28
    v_add_u32 v29, 2, v4
    v_xor_b32 v29, v29, v3
    v_lshlrev_b32 v29, 4, v29
    v_add_u32 v29, v29, v2
    v_add_u32 v33, 0x10000, v29
    v_add_u32 v30, 4, v4
    v_xor_b32 v30, v30, v3
    v_lshlrev_b32 v30, 4, v30
    v_add_u32 v30, v30, v2
    v_add_u32 v34, 0x10000, v30
    v_add_u32 v31, 6, v4
    v_xor_b32 v31, v31, v3
    v_lshlrev_b32 v31, 4, v31
    v_add_u32 v31, v31, v2
    v_add_u32 v35, 0x10000, v31
    s_lshl_b32 s44, s40, 11
    v_mov_b32 v40, 0
    v_mov_b32 v56, 0
    v_mov_b32 v41, 0
    v_mov_b32 v57, 0
    v_mov_b32 v42, 0
    v_mov_b32 v58, 0
    v_mov_b32 v43, 0
    v_mov_b32 v59, 0
    v_mov_b32 v44, 0
    v_mov_b32 v60, 0
    v_mov_b32 v45, 0
    v_mov_b32 v61, 0
    v_mov_b32 v46, 0
    v_mov_b32 v62, 0
    v_mov_b32 v47, 0
    v_mov_b32 v63, 0
    v_mov_b32 v48, 0
    v_mov_b32 v64, 0
    v_mov_b32 v49, 0
    v_mov_b32 v65, 0
    v_mov_b32 v50, 0
    v_mov_b32 v66, 0
    v_mov_b32 v51, 0
    v_mov_b32 v67, 0
    v_mov_b32 v52, 0
    v_mov_b32 v68, 0
    v_mov_b32 v53, 0
    v_mov_b32 v69, 0
    v_mov_b32 v54, 0
    v_mov_b32 v70, 0
    v_mov_b32 v55, 0
    v_mov_b32 v71, 0
    v_and_b32 v2, 31, v1
    s_lshl_b32 s43, s42, 5
    v_add_u32 v2, s43, v2
    s_lshl_b32 s43, s34, 6
    v_add_u32 v2, s43, v2
    v_lshrrev_b32 v3, 5, v1
    v_lshlrev_b32 v3, 2, v3
    s_lshl_b32 s43, s41, 5
    v_add_u32 v3, s43, v3
    s_lshl_b32 s43, s33, 6
    v_add_u32 v3, s43, v3
    v_lshlrev_b32 v4, 10, v3
    v_lshlrev_b32 v5, 1, v2
    v_add_u32 v4, v4, v5
    v_lshlrev_b32 v6, 1, v3
    v_lshlrev_b32 v7, 1, v2
    v_lshlrev_b32 v8, 11, v3
    v_lshlrev_b32 v9, 2, v2
    v_add_u32 v8, v8, v9
    buffer_load_ushort v120, v7, s[64:67], 0 offen
    s_mov_b32 s43, 0
    buffer_load_ushort v72, v4, s[48:51], s43 offen
    buffer_load_ushort v88, v4, s[52:55], s43 offen
    buffer_load_ushort v104, v6, s[60:63], 0 offen offset:0
    s_mov_b32 s43, 1024
    buffer_load_ushort v73, v4, s[48:51], s43 offen
    buffer_load_ushort v89, v4, s[52:55], s43 offen
    buffer_load_ushort v105, v6, s[60:63], 0 offen offset:2
    s_mov_b32 s43, 2048
    buffer_load_ushort v74, v4, s[48:51], s43 offen
    buffer_load_ushort v90, v4, s[52:55], s43 offen
    buffer_load_ushort v106, v6, s[60:63], 0 offen offset:4
    s_mov_b32 s43, 3072
    buffer_load_ushort v75, v4, s[48:51], s43 offen
    buffer_load_ushort v91, v4, s[52:55], s43 offen
    buffer_load_ushort v107, v6, s[60:63], 0 offen offset:6
    s_mov_b32 s43, 8192
    buffer_load_ushort v76, v4, s[48:51], s43 offen
    buffer_load_ushort v92, v4, s[52:55], s43 offen
    buffer_load_ushort v108, v6, s[60:63], 0 offen offset:16
    s_mov_b32 s43, 9216
    buffer_load_ushort v77, v4, s[48:51], s43 offen
    buffer_load_ushort v93, v4, s[52:55], s43 offen
    buffer_load_ushort v109, v6, s[60:63], 0 offen offset:18
    s_mov_b32 s43, 10240
    buffer_load_ushort v78, v4, s[48:51], s43 offen
    buffer_load_ushort v94, v4, s[52:55], s43 offen
    buffer_load_ushort v110, v6, s[60:63], 0 offen offset:20
    s_mov_b32 s43, 11264
    buffer_load_ushort v79, v4, s[48:51], s43 offen
    buffer_load_ushort v95, v4, s[52:55], s43 offen
    buffer_load_ushort v111, v6, s[60:63], 0 offen offset:22
    s_mov_b32 s43, 16384
    buffer_load_ushort v80, v4, s[48:51], s43 offen
    buffer_load_ushort v96, v4, s[52:55], s43 offen
    buffer_load_ushort v112, v6, s[60:63], 0 offen offset:32
    s_mov_b32 s43, 17408
    buffer_load_ushort v81, v4, s[48:51], s43 offen
    buffer_load_ushort v97, v4, s[52:55], s43 offen
    buffer_load_ushort v113, v6, s[60:63], 0 offen offset:34
    s_mov_b32 s43, 18432
    buffer_load_ushort v82, v4, s[48:51], s43 offen
    buffer_load_ushort v98, v4, s[52:55], s43 offen
    buffer_load_ushort v114, v6, s[60:63], 0 offen offset:36
    s_mov_b32 s43, 19456
    buffer_load_ushort v83, v4, s[48:51], s43 offen
    buffer_load_ushort v99, v4, s[52:55], s43 offen
    buffer_load_ushort v115, v6, s[60:63], 0 offen offset:38
    s_mov_b32 s43, 24576
    buffer_load_ushort v84, v4, s[48:51], s43 offen
    buffer_load_ushort v100, v4, s[52:55], s43 offen
    buffer_load_ushort v116, v6, s[60:63], 0 offen offset:48
    s_mov_b32 s43, 25600
    buffer_load_ushort v85, v4, s[48:51], s43 offen
    buffer_load_ushort v101, v4, s[52:55], s43 offen
    buffer_load_ushort v117, v6, s[60:63], 0 offen offset:50
    s_mov_b32 s43, 26624
    buffer_load_ushort v86, v4, s[48:51], s43 offen
    buffer_load_ushort v102, v4, s[52:55], s43 offen
    buffer_load_ushort v118, v6, s[60:63], 0 offen offset:52
    s_mov_b32 s43, 27648
    buffer_load_ushort v87, v4, s[48:51], s43 offen
    buffer_load_ushort v103, v4, s[52:55], s43 offen
    buffer_load_ushort v119, v6, s[60:63], 0 offen offset:54
    s_mov_b32 s79, 0
    s_mov_b32 s80, 0
    s_add_u32 m0, s44, 0
    s_nop 0
    buffer_load_dwordx4 v10, s[4:7], s79 offen lds
    s_add_u32 m0, s44, 1024
    s_nop 0
    buffer_load_dwordx4 v11, s[4:7], s79 offen lds
    s_add_u32 m0, s44, 8192
    s_nop 0
    buffer_load_dwordx4 v12, s[8:11], s80 offen lds
    s_add_u32 m0, s44, 9216
    s_nop 0
    buffer_load_dwordx4 v13, s[8:11], s80 offen lds
    s_mov_b32 s79, 262144
    s_mov_b32 s80, 128
    s_add_u32 m0, s44, 16384
    s_nop 0
    buffer_load_dwordx4 v10, s[4:7], s79 offen lds
    s_add_u32 m0, s44, 17408
    s_nop 0
    buffer_load_dwordx4 v11, s[4:7], s79 offen lds
    s_add_u32 m0, s44, 24576
    s_nop 0
    buffer_load_dwordx4 v12, s[8:11], s80 offen lds
    s_add_u32 m0, s44, 25600
    s_nop 0
    buffer_load_dwordx4 v13, s[8:11], s80 offen lds
    s_mov_b32 s79, 524288
    s_mov_b32 s80, 256
    s_add_u32 m0, s44, 32768
    s_nop 0
    buffer_load_dwordx4 v10, s[4:7], s79 offen lds
    s_add_u32 m0, s44, 33792
    s_nop 0
    buffer_load_dwordx4 v11, s[4:7], s79 offen lds
    s_add_u32 m0, s44, 40960
    s_nop 0
    buffer_load_dwordx4 v12, s[8:11], s80 offen lds
    s_add_u32 m0, s44, 41984
    s_nop 0
    buffer_load_dwordx4 v13, s[8:11], s80 offen lds
    s_mov_b32 s79, 786432
    s_mov_b32 s80, 384
    s_add_u32 m0, s44, 49152
    s_nop 0
    buffer_load_dwordx4 v10, s[4:7], s79 offen lds
    s_add_u32 m0, s44, 50176
    s_nop 0
    buffer_load_dwordx4 v11, s[4:7], s79 offen lds
    s_add_u32 m0, s44, 57344
    s_nop 0
    buffer_load_dwordx4 v12, s[8:11], s80 offen lds
    s_add_u32 m0, s44, 58368
    s_nop 0
    buffer_load_dwordx4 v13, s[8:11], s80 offen lds
    s_mov_b32 s79, 1048576
    s_mov_b32 s80, 512
    s_add_u32 m0, s44, 65536
    s_nop 0
    buffer_load_dwordx4 v10, s[4:7], s79 offen lds
    s_add_u32 m0, s44, 66560
    s_nop 0
    buffer_load_dwordx4 v11, s[4:7], s79 offen lds
    s_add_u32 m0, s44, 73728
    s_nop 0
    buffer_load_dwordx4 v12, s[8:11], s80 offen lds
    s_add_u32 m0, s44, 74752
    s_nop 0
    buffer_load_dwordx4 v13, s[8:11], s80 offen lds
    s_mov_b32 s79, 1310720
    s_mov_b32 s80, 640
    s_add_u32 m0, s44, 81920
    s_nop 0
    buffer_load_dwordx4 v10, s[4:7], s79 offen lds
    s_add_u32 m0, s44, 82944
    s_nop 0
    buffer_load_dwordx4 v11, s[4:7], s79 offen lds
    s_add_u32 m0, s44, 90112
    s_nop 0
    buffer_load_dwordx4 v12, s[8:11], s80 offen lds
    s_add_u32 m0, s44, 91136
    s_nop 0
    buffer_load_dwordx4 v13, s[8:11], s80 offen lds
    s_mov_b32 s79, 1572864
    s_mov_b32 s80, 768
    s_add_u32 m0, s44, 98304
    s_nop 0
    buffer_load_dwordx4 v10, s[4:7], s79 offen lds
    s_add_u32 m0, s44, 99328
    s_nop 0
    buffer_load_dwordx4 v11, s[4:7], s79 offen lds
    s_add_u32 m0, s44, 106496
    s_nop 0
    buffer_load_dwordx4 v12, s[8:11], s80 offen lds
    s_add_u32 m0, s44, 107520
    s_nop 0
    buffer_load_dwordx4 v13, s[8:11], s80 offen lds
    s_mov_b32 s79, 1835008
    s_mov_b32 s80, 896
    s_add_u32 m0, s44, 114688
    s_nop 0
    buffer_load_dwordx4 v10, s[4:7], s79 offen lds
    s_add_u32 m0, s44, 115712
    s_nop 0
    buffer_load_dwordx4 v11, s[4:7], s79 offen lds
    s_add_u32 m0, s44, 122880
    s_nop 0
    buffer_load_dwordx4 v12, s[8:11], s80 offen lds
    s_add_u32 m0, s44, 123904
    s_nop 0
    buffer_load_dwordx4 v13, s[8:11], s80 offen lds
    s_waitcnt vmcnt(28)
    s_barrier
    ds_read_b64_tr_b16 v[128:129], v18 offset:0
    ds_read_b64_tr_b16 v[130:131], v18 offset:512
    ds_read_b128 v[144:147], v20 offset:8192
    ds_read_b64_tr_b16 v[132:133], v18 offset:2048
    ds_read_b64_tr_b16 v[134:135], v18 offset:2560
    ds_read_b128 v[148:151], v21 offset:8192
    ds_read_b64_tr_b16 v[136:137], v18 offset:4096
    ds_read_b64_tr_b16 v[138:139], v18 offset:4608
    ds_read_b128 v[152:155], v22 offset:8192
    ds_read_b64_tr_b16 v[140:141], v18 offset:6144
    ds_read_b64_tr_b16 v[142:143], v18 offset:6656
    ds_read_b128 v[156:159], v23 offset:8192
    s_waitcnt vmcnt(24)
    s_waitcnt lgkmcnt(0)
    s_barrier
    s_mov_b32 s79, 2097152
    s_mov_b32 s80, 1024
    s_add_u32 m0, s44, 0
    s_nop 0
    buffer_load_dwordx4 v10, s[4:7], s79 offen lds
    s_add_u32 m0, s44, 1024
    s_nop 0
    buffer_load_dwordx4 v11, s[4:7], s79 offen lds
    s_add_u32 m0, s44, 8192
    s_nop 0
    buffer_load_dwordx4 v12, s[8:11], s80 offen lds
    s_add_u32 m0, s44, 9216
    s_nop 0
    buffer_load_dwordx4 v13, s[8:11], s80 offen lds
    ds_read_b64_tr_b16 v[160:161], v18 offset:16384
    ds_read_b64_tr_b16 v[162:163], v18 offset:16896
    ds_read_b128 v[176:179], v20 offset:24576
    ds_read_b64_tr_b16 v[164:165], v18 offset:18432
    ds_read_b64_tr_b16 v[166:167], v18 offset:18944
    ds_read_b128 v[180:183], v21 offset:24576
    ds_read_b64_tr_b16 v[168:169], v18 offset:20480
    ds_read_b64_tr_b16 v[170:171], v18 offset:20992
    ds_read_b128 v[184:187], v22 offset:24576
    ds_read_b64_tr_b16 v[172:173], v18 offset:22528
    ds_read_b64_tr_b16 v[174:175], v18 offset:23040
    ds_read_b128 v[188:191], v23 offset:24576
    v_mfma_f32_32x32x16_bf16 v[40:55], v[128:131], v[144:147], v[40:55]
    v_mfma_f32_32x32x16_bf16 v[40:55], v[132:135], v[148:151], v[40:55]
    v_mfma_f32_32x32x16_bf16 v[40:55], v[136:139], v[152:155], v[40:55]
    v_mfma_f32_32x32x16_bf16 v[40:55], v[140:143], v[156:159], v[40:55]
    s_waitcnt vmcnt(24)
    s_waitcnt lgkmcnt(0)
    s_barrier
    s_mov_b32 s79, 2359296
    s_mov_b32 s80, 1152
    s_add_u32 m0, s44, 16384
    s_nop 0
    buffer_load_dwordx4 v10, s[4:7], s79 offen lds
    s_add_u32 m0, s44, 17408
    s_nop 0
    buffer_load_dwordx4 v11, s[4:7], s79 offen lds
    s_add_u32 m0, s44, 24576
    s_nop 0
    buffer_load_dwordx4 v12, s[8:11], s80 offen lds
    s_add_u32 m0, s44, 25600
    s_nop 0
    buffer_load_dwordx4 v13, s[8:11], s80 offen lds
    ds_read_b64_tr_b16 v[128:129], v18 offset:32768
    ds_read_b64_tr_b16 v[130:131], v18 offset:33280
    ds_read_b128 v[144:147], v20 offset:40960
    ds_read_b64_tr_b16 v[132:133], v18 offset:34816
    ds_read_b64_tr_b16 v[134:135], v18 offset:35328
    ds_read_b128 v[148:151], v21 offset:40960
    ds_read_b64_tr_b16 v[136:137], v18 offset:36864
    ds_read_b64_tr_b16 v[138:139], v18 offset:37376
    ds_read_b128 v[152:155], v22 offset:40960
    ds_read_b64_tr_b16 v[140:141], v18 offset:38912
    ds_read_b64_tr_b16 v[142:143], v18 offset:39424
    ds_read_b128 v[156:159], v23 offset:40960
    v_mfma_f32_32x32x16_bf16 v[40:55], v[160:163], v[176:179], v[40:55]
    v_mfma_f32_32x32x16_bf16 v[40:55], v[164:167], v[180:183], v[40:55]
    v_mfma_f32_32x32x16_bf16 v[40:55], v[168:171], v[184:187], v[40:55]
    v_mfma_f32_32x32x16_bf16 v[40:55], v[172:175], v[188:191], v[40:55]
    s_waitcnt vmcnt(24)
    s_waitcnt lgkmcnt(0)
    s_barrier
    s_mov_b32 s79, 2621440
    s_mov_b32 s80, 1280
    s_add_u32 m0, s44, 32768
    s_nop 0
    buffer_load_dwordx4 v10, s[4:7], s79 offen lds
    s_add_u32 m0, s44, 33792
    s_nop 0
    buffer_load_dwordx4 v11, s[4:7], s79 offen lds
    s_add_u32 m0, s44, 40960
    s_nop 0
    buffer_load_dwordx4 v12, s[8:11], s80 offen lds
    s_add_u32 m0, s44, 41984
    s_nop 0
    buffer_load_dwordx4 v13, s[8:11], s80 offen lds
    ds_read_b64_tr_b16 v[160:161], v18 offset:49152
    ds_read_b64_tr_b16 v[162:163], v18 offset:49664
    ds_read_b128 v[176:179], v20 offset:57344
    ds_read_b64_tr_b16 v[164:165], v18 offset:51200
    ds_read_b64_tr_b16 v[166:167], v18 offset:51712
    ds_read_b128 v[180:183], v21 offset:57344
    ds_read_b64_tr_b16 v[168:169], v18 offset:53248
    ds_read_b64_tr_b16 v[170:171], v18 offset:53760
    ds_read_b128 v[184:187], v22 offset:57344
    ds_read_b64_tr_b16 v[172:173], v18 offset:55296
    ds_read_b64_tr_b16 v[174:175], v18 offset:55808
    ds_read_b128 v[188:191], v23 offset:57344
    v_mfma_f32_32x32x16_bf16 v[40:55], v[128:131], v[144:147], v[40:55]
    v_mfma_f32_32x32x16_bf16 v[40:55], v[132:135], v[148:151], v[40:55]
    v_mfma_f32_32x32x16_bf16 v[40:55], v[136:139], v[152:155], v[40:55]
    v_mfma_f32_32x32x16_bf16 v[40:55], v[140:143], v[156:159], v[40:55]
    s_waitcnt vmcnt(24)
    s_waitcnt lgkmcnt(0)
    s_barrier
    s_mov_b32 s79, 2883584
    s_mov_b32 s80, 1408
    s_add_u32 m0, s44, 49152
    s_nop 0
    buffer_load_dwordx4 v10, s[4:7], s79 offen lds
    s_add_u32 m0, s44, 50176
    s_nop 0
    buffer_load_dwordx4 v11, s[4:7], s79 offen lds
    s_add_u32 m0, s44, 57344
    s_nop 0
    buffer_load_dwordx4 v12, s[8:11], s80 offen lds
    s_add_u32 m0, s44, 58368
    s_nop 0
    buffer_load_dwordx4 v13, s[8:11], s80 offen lds
    ds_read_b64_tr_b16 v[128:129], v19 offset:0
    ds_read_b64_tr_b16 v[130:131], v19 offset:512
    ds_read_b128 v[144:147], v24 offset:8192
    ds_read_b64_tr_b16 v[132:133], v19 offset:2048
    ds_read_b64_tr_b16 v[134:135], v19 offset:2560
    ds_read_b128 v[148:151], v25 offset:8192
    ds_read_b64_tr_b16 v[136:137], v19 offset:4096
    ds_read_b64_tr_b16 v[138:139], v19 offset:4608
    ds_read_b128 v[152:155], v26 offset:8192
    ds_read_b64_tr_b16 v[140:141], v19 offset:6144
    ds_read_b64_tr_b16 v[142:143], v19 offset:6656
    ds_read_b128 v[156:159], v27 offset:8192
    v_mfma_f32_32x32x16_bf16 v[40:55], v[160:163], v[176:179], v[40:55]
    v_mfma_f32_32x32x16_bf16 v[40:55], v[164:167], v[180:183], v[40:55]
    v_mfma_f32_32x32x16_bf16 v[40:55], v[168:171], v[184:187], v[40:55]
    v_mfma_f32_32x32x16_bf16 v[40:55], v[172:175], v[188:191], v[40:55]
    s_waitcnt vmcnt(24)
    s_waitcnt lgkmcnt(0)
    s_barrier
    s_mov_b32 s79, 3145728
    s_mov_b32 s80, 1536
    s_add_u32 m0, s44, 65536
    s_nop 0
    buffer_load_dwordx4 v10, s[4:7], s79 offen lds
    s_add_u32 m0, s44, 66560
    s_nop 0
    buffer_load_dwordx4 v11, s[4:7], s79 offen lds
    s_add_u32 m0, s44, 73728
    s_nop 0
    buffer_load_dwordx4 v12, s[8:11], s80 offen lds
    s_add_u32 m0, s44, 74752
    s_nop 0
    buffer_load_dwordx4 v13, s[8:11], s80 offen lds
    ds_read_b64_tr_b16 v[160:161], v19 offset:16384
    ds_read_b64_tr_b16 v[162:163], v19 offset:16896
    ds_read_b128 v[176:179], v24 offset:24576
    ds_read_b64_tr_b16 v[164:165], v19 offset:18432
    ds_read_b64_tr_b16 v[166:167], v19 offset:18944
    ds_read_b128 v[180:183], v25 offset:24576
    ds_read_b64_tr_b16 v[168:169], v19 offset:20480
    ds_read_b64_tr_b16 v[170:171], v19 offset:20992
    ds_read_b128 v[184:187], v26 offset:24576
    ds_read_b64_tr_b16 v[172:173], v19 offset:22528
    ds_read_b64_tr_b16 v[174:175], v19 offset:23040
    ds_read_b128 v[188:191], v27 offset:24576
    v_mfma_f32_32x32x16_bf16 v[40:55], v[128:131], v[144:147], v[40:55]
    v_mfma_f32_32x32x16_bf16 v[40:55], v[132:135], v[148:151], v[40:55]
    v_mfma_f32_32x32x16_bf16 v[40:55], v[136:139], v[152:155], v[40:55]
    v_mfma_f32_32x32x16_bf16 v[40:55], v[140:143], v[156:159], v[40:55]
    s_waitcnt vmcnt(24)
    s_waitcnt lgkmcnt(0)
    s_barrier
    s_mov_b32 s79, 3407872
    s_mov_b32 s80, 1664
    s_add_u32 m0, s44, 81920
    s_nop 0
    buffer_load_dwordx4 v10, s[4:7], s79 offen lds
    s_add_u32 m0, s44, 82944
    s_nop 0
    buffer_load_dwordx4 v11, s[4:7], s79 offen lds
    s_add_u32 m0, s44, 90112
    s_nop 0
    buffer_load_dwordx4 v12, s[8:11], s80 offen lds
    s_add_u32 m0, s44, 91136
    s_nop 0
    buffer_load_dwordx4 v13, s[8:11], s80 offen lds
    ds_read_b64_tr_b16 v[128:129], v19 offset:32768
    ds_read_b64_tr_b16 v[130:131], v19 offset:33280
    ds_read_b128 v[144:147], v24 offset:40960
    ds_read_b64_tr_b16 v[132:133], v19 offset:34816
    ds_read_b64_tr_b16 v[134:135], v19 offset:35328
    ds_read_b128 v[148:151], v25 offset:40960
    ds_read_b64_tr_b16 v[136:137], v19 offset:36864
    ds_read_b64_tr_b16 v[138:139], v19 offset:37376
    ds_read_b128 v[152:155], v26 offset:40960
    ds_read_b64_tr_b16 v[140:141], v19 offset:38912
    ds_read_b64_tr_b16 v[142:143], v19 offset:39424
    ds_read_b128 v[156:159], v27 offset:40960
    v_mfma_f32_32x32x16_bf16 v[40:55], v[160:163], v[176:179], v[40:55]
    v_mfma_f32_32x32x16_bf16 v[40:55], v[164:167], v[180:183], v[40:55]
    v_mfma_f32_32x32x16_bf16 v[40:55], v[168:171], v[184:187], v[40:55]
    v_mfma_f32_32x32x16_bf16 v[40:55], v[172:175], v[188:191], v[40:55]
    s_waitcnt vmcnt(24)
    s_waitcnt lgkmcnt(0)
    s_barrier
    s_mov_b32 s79, 3670016
    s_mov_b32 s80, 1792
    s_add_u32 m0, s44, 98304
    s_nop 0
    buffer_load_dwordx4 v10, s[4:7], s79 offen lds
    s_add_u32 m0, s44, 99328
    s_nop 0
    buffer_load_dwordx4 v11, s[4:7], s79 offen lds
    s_add_u32 m0, s44, 106496
    s_nop 0
    buffer_load_dwordx4 v12, s[8:11], s80 offen lds
    s_add_u32 m0, s44, 107520
    s_nop 0
    buffer_load_dwordx4 v13, s[8:11], s80 offen lds
    ds_read_b64_tr_b16 v[160:161], v19 offset:49152
    ds_read_b64_tr_b16 v[162:163], v19 offset:49664
    ds_read_b128 v[176:179], v24 offset:57344
    ds_read_b64_tr_b16 v[164:165], v19 offset:51200
    ds_read_b64_tr_b16 v[166:167], v19 offset:51712
    ds_read_b128 v[180:183], v25 offset:57344
    ds_read_b64_tr_b16 v[168:169], v19 offset:53248
    ds_read_b64_tr_b16 v[170:171], v19 offset:53760
    ds_read_b128 v[184:187], v26 offset:57344
    ds_read_b64_tr_b16 v[172:173], v19 offset:55296
    ds_read_b64_tr_b16 v[174:175], v19 offset:55808
    ds_read_b128 v[188:191], v27 offset:57344
    v_mfma_f32_32x32x16_bf16 v[40:55], v[128:131], v[144:147], v[40:55]
    v_mfma_f32_32x32x16_bf16 v[40:55], v[132:135], v[148:151], v[40:55]
    v_mfma_f32_32x32x16_bf16 v[40:55], v[136:139], v[152:155], v[40:55]
    v_mfma_f32_32x32x16_bf16 v[40:55], v[140:143], v[156:159], v[40:55]
    s_waitcnt vmcnt(24)
    s_waitcnt lgkmcnt(0)
    s_barrier
    s_mov_b32 s79, 3932160
    s_mov_b32 s80, 1920
    s_add_u32 m0, s44, 114688
    s_nop 0
    buffer_load_dwordx4 v10, s[4:7], s79 offen lds
    s_add_u32 m0, s44, 115712
    s_nop 0
    buffer_load_dwordx4 v11, s[4:7], s79 offen lds
    s_add_u32 m0, s44, 122880
    s_nop 0
    buffer_load_dwordx4 v12, s[8:11], s80 offen lds
    s_add_u32 m0, s44, 123904
    s_nop 0
    buffer_load_dwordx4 v13, s[8:11], s80 offen lds
    ds_read_b64_tr_b16 v[128:129], v18 offset:0
    ds_read_b64_tr_b16 v[130:131], v18 offset:512
    ds_read_b128 v[144:147], v20 offset:8192
    ds_read_b64_tr_b16 v[132:133], v18 offset:2048
    ds_read_b64_tr_b16 v[134:135], v18 offset:2560
    ds_read_b128 v[148:151], v21 offset:8192
    ds_read_b64_tr_b16 v[136:137], v18 offset:4096
    ds_read_b64_tr_b16 v[138:139], v18 offset:4608
    ds_read_b128 v[152:155], v22 offset:8192
    ds_read_b64_tr_b16 v[140:141], v18 offset:6144
    ds_read_b64_tr_b16 v[142:143], v18 offset:6656
    ds_read_b128 v[156:159], v23 offset:8192
    v_mfma_f32_32x32x16_bf16 v[40:55], v[160:163], v[176:179], v[40:55]
    v_mfma_f32_32x32x16_bf16 v[40:55], v[164:167], v[180:183], v[40:55]
    v_mfma_f32_32x32x16_bf16 v[40:55], v[168:171], v[184:187], v[40:55]
    v_mfma_f32_32x32x16_bf16 v[40:55], v[172:175], v[188:191], v[40:55]
    s_waitcnt vmcnt(24)
    s_waitcnt lgkmcnt(0)
    s_barrier
    s_mov_b32 s79, 4194304
    s_mov_b32 s80, 2048
    s_add_u32 m0, s44, 0
    s_nop 0
    buffer_load_dwordx4 v10, s[4:7], s79 offen lds
    s_add_u32 m0, s44, 1024
    s_nop 0
    buffer_load_dwordx4 v11, s[4:7], s79 offen lds
    s_add_u32 m0, s44, 8192
    s_nop 0
    buffer_load_dwordx4 v12, s[8:11], s80 offen lds
    s_add_u32 m0, s44, 9216
    s_nop 0
    buffer_load_dwordx4 v13, s[8:11], s80 offen lds
    ds_read_b64_tr_b16 v[160:161], v18 offset:16384
    ds_read_b64_tr_b16 v[162:163], v18 offset:16896
    ds_read_b128 v[176:179], v20 offset:24576
    ds_read_b64_tr_b16 v[164:165], v18 offset:18432
    ds_read_b64_tr_b16 v[166:167], v18 offset:18944
    ds_read_b128 v[180:183], v21 offset:24576
    ds_read_b64_tr_b16 v[168:169], v18 offset:20480
    ds_read_b64_tr_b16 v[170:171], v18 offset:20992
    ds_read_b128 v[184:187], v22 offset:24576
    ds_read_b64_tr_b16 v[172:173], v18 offset:22528
    ds_read_b64_tr_b16 v[174:175], v18 offset:23040
    ds_read_b128 v[188:191], v23 offset:24576
    v_mfma_f32_32x32x16_bf16 v[40:55], v[128:131], v[144:147], v[40:55]
    v_mfma_f32_32x32x16_bf16 v[40:55], v[132:135], v[148:151], v[40:55]
    v_mfma_f32_32x32x16_bf16 v[40:55], v[136:139], v[152:155], v[40:55]
    v_mfma_f32_32x32x16_bf16 v[40:55], v[140:143], v[156:159], v[40:55]
    s_waitcnt vmcnt(24)
    s_waitcnt lgkmcnt(0)
    s_barrier
    s_mov_b32 s79, 4456448
    s_mov_b32 s80, 2176
    s_add_u32 m0, s44, 16384
    s_nop 0
    buffer_load_dwordx4 v10, s[4:7], s79 offen lds
    s_add_u32 m0, s44, 17408
    s_nop 0
    buffer_load_dwordx4 v11, s[4:7], s79 offen lds
    s_add_u32 m0, s44, 24576
    s_nop 0
    buffer_load_dwordx4 v12, s[8:11], s80 offen lds
    s_add_u32 m0, s44, 25600
    s_nop 0
    buffer_load_dwordx4 v13, s[8:11], s80 offen lds
    ds_read_b64_tr_b16 v[128:129], v18 offset:32768
    ds_read_b64_tr_b16 v[130:131], v18 offset:33280
    ds_read_b128 v[144:147], v20 offset:40960
    ds_read_b64_tr_b16 v[132:133], v18 offset:34816
    ds_read_b64_tr_b16 v[134:135], v18 offset:35328
    ds_read_b128 v[148:151], v21 offset:40960
    ds_read_b64_tr_b16 v[136:137], v18 offset:36864
    ds_read_b64_tr_b16 v[138:139], v18 offset:37376
    ds_read_b128 v[152:155], v22 offset:40960
    ds_read_b64_tr_b16 v[140:141], v18 offset:38912
    ds_read_b64_tr_b16 v[142:143], v18 offset:39424
    ds_read_b128 v[156:159], v23 offset:40960
    v_mfma_f32_32x32x16_bf16 v[40:55], v[160:163], v[176:179], v[40:55]
    v_mfma_f32_32x32x16_bf16 v[40:55], v[164:167], v[180:183], v[40:55]
    v_mfma_f32_32x32x16_bf16 v[40:55], v[168:171], v[184:187], v[40:55]
    v_mfma_f32_32x32x16_bf16 v[40:55], v[172:175], v[188:191], v[40:55]
    s_waitcnt vmcnt(24)
    s_waitcnt lgkmcnt(0)
    s_barrier
    s_mov_b32 s79, 4718592
    s_mov_b32 s80, 2304
    s_add_u32 m0, s44, 32768
    s_nop 0
    buffer_load_dwordx4 v10, s[4:7], s79 offen lds
    s_add_u32 m0, s44, 33792
    s_nop 0
    buffer_load_dwordx4 v11, s[4:7], s79 offen lds
    s_add_u32 m0, s44, 40960
    s_nop 0
    buffer_load_dwordx4 v12, s[8:11], s80 offen lds
    s_add_u32 m0, s44, 41984
    s_nop 0
    buffer_load_dwordx4 v13, s[8:11], s80 offen lds
    ds_read_b64_tr_b16 v[160:161], v18 offset:49152
    ds_read_b64_tr_b16 v[162:163], v18 offset:49664
    ds_read_b128 v[176:179], v20 offset:57344
    ds_read_b64_tr_b16 v[164:165], v18 offset:51200
    ds_read_b64_tr_b16 v[166:167], v18 offset:51712
    ds_read_b128 v[180:183], v21 offset:57344
    ds_read_b64_tr_b16 v[168:169], v18 offset:53248
    ds_read_b64_tr_b16 v[170:171], v18 offset:53760
    ds_read_b128 v[184:187], v22 offset:57344
    ds_read_b64_tr_b16 v[172:173], v18 offset:55296
    ds_read_b64_tr_b16 v[174:175], v18 offset:55808
    ds_read_b128 v[188:191], v23 offset:57344
    v_mfma_f32_32x32x16_bf16 v[40:55], v[128:131], v[144:147], v[40:55]
    v_mfma_f32_32x32x16_bf16 v[40:55], v[132:135], v[148:151], v[40:55]
    v_mfma_f32_32x32x16_bf16 v[40:55], v[136:139], v[152:155], v[40:55]
    v_mfma_f32_32x32x16_bf16 v[40:55], v[140:143], v[156:159], v[40:55]
    s_waitcnt vmcnt(24)
    s_waitcnt lgkmcnt(0)
    s_barrier
    s_mov_b32 s79, 4980736
    s_mov_b32 s80, 2432
    s_add_u32 m0, s44, 49152
    s_nop 0
    buffer_load_dwordx4 v10, s[4:7], s79 offen lds
    s_add_u32 m0, s44, 50176
    s_nop 0
    buffer_load_dwordx4 v11, s[4:7], s79 offen lds
    s_add_u32 m0, s44, 57344
    s_nop 0
    buffer_load_dwordx4 v12, s[8:11], s80 offen lds
    s_add_u32 m0, s44, 58368
    s_nop 0
    buffer_load_dwordx4 v13, s[8:11], s80 offen lds
    ds_read_b64_tr_b16 v[128:129], v19 offset:0
    ds_read_b64_tr_b16 v[130:131], v19 offset:512
    ds_read_b128 v[144:147], v24 offset:8192
    ds_read_b64_tr_b16 v[132:133], v19 offset:2048
    ds_read_b64_tr_b16 v[134:135], v19 offset:2560
    ds_read_b128 v[148:151], v25 offset:8192
    ds_read_b64_tr_b16 v[136:137], v19 offset:4096
    ds_read_b64_tr_b16 v[138:139], v19 offset:4608
    ds_read_b128 v[152:155], v26 offset:8192
    ds_read_b64_tr_b16 v[140:141], v19 offset:6144
    ds_read_b64_tr_b16 v[142:143], v19 offset:6656
    ds_read_b128 v[156:159], v27 offset:8192
    v_mfma_f32_32x32x16_bf16 v[40:55], v[160:163], v[176:179], v[40:55]
    v_mfma_f32_32x32x16_bf16 v[40:55], v[164:167], v[180:183], v[40:55]
    v_mfma_f32_32x32x16_bf16 v[40:55], v[168:171], v[184:187], v[40:55]
    v_mfma_f32_32x32x16_bf16 v[40:55], v[172:175], v[188:191], v[40:55]
    s_waitcnt vmcnt(24)
    s_waitcnt lgkmcnt(0)
    s_barrier
    s_mov_b32 s79, 5242880
    s_mov_b32 s80, 2560
    s_add_u32 m0, s44, 65536
    s_nop 0
    buffer_load_dwordx4 v10, s[4:7], s79 offen lds
    s_add_u32 m0, s44, 66560
    s_nop 0
    buffer_load_dwordx4 v11, s[4:7], s79 offen lds
    s_add_u32 m0, s44, 73728
    s_nop 0
    buffer_load_dwordx4 v12, s[8:11], s80 offen lds
    s_add_u32 m0, s44, 74752
    s_nop 0
    buffer_load_dwordx4 v13, s[8:11], s80 offen lds
    ds_read_b64_tr_b16 v[160:161], v19 offset:16384
    ds_read_b64_tr_b16 v[162:163], v19 offset:16896
    ds_read_b128 v[176:179], v24 offset:24576
    ds_read_b64_tr_b16 v[164:165], v19 offset:18432
    ds_read_b64_tr_b16 v[166:167], v19 offset:18944
    ds_read_b128 v[180:183], v25 offset:24576
    ds_read_b64_tr_b16 v[168:169], v19 offset:20480
    ds_read_b64_tr_b16 v[170:171], v19 offset:20992
    ds_read_b128 v[184:187], v26 offset:24576
    ds_read_b64_tr_b16 v[172:173], v19 offset:22528
    ds_read_b64_tr_b16 v[174:175], v19 offset:23040
    ds_read_b128 v[188:191], v27 offset:24576
    v_mfma_f32_32x32x16_bf16 v[40:55], v[128:131], v[144:147], v[40:55]
    v_mfma_f32_32x32x16_bf16 v[40:55], v[132:135], v[148:151], v[40:55]
    v_mfma_f32_32x32x16_bf16 v[40:55], v[136:139], v[152:155], v[40:55]
    v_mfma_f32_32x32x16_bf16 v[40:55], v[140:143], v[156:159], v[40:55]
    s_waitcnt vmcnt(24)
    s_waitcnt lgkmcnt(0)
    s_barrier
    s_mov_b32 s79, 5505024
    s_mov_b32 s80, 2688
    s_add_u32 m0, s44, 81920
    s_nop 0
    buffer_load_dwordx4 v10, s[4:7], s79 offen lds
    s_add_u32 m0, s44, 82944
    s_nop 0
    buffer_load_dwordx4 v11, s[4:7], s79 offen lds
    s_add_u32 m0, s44, 90112
    s_nop 0
    buffer_load_dwordx4 v12, s[8:11], s80 offen lds
    s_add_u32 m0, s44, 91136
    s_nop 0
    buffer_load_dwordx4 v13, s[8:11], s80 offen lds
    ds_read_b64_tr_b16 v[128:129], v19 offset:32768
    ds_read_b64_tr_b16 v[130:131], v19 offset:33280
    ds_read_b128 v[144:147], v24 offset:40960
    ds_read_b64_tr_b16 v[132:133], v19 offset:34816
    ds_read_b64_tr_b16 v[134:135], v19 offset:35328
    ds_read_b128 v[148:151], v25 offset:40960
    ds_read_b64_tr_b16 v[136:137], v19 offset:36864
    ds_read_b64_tr_b16 v[138:139], v19 offset:37376
    ds_read_b128 v[152:155], v26 offset:40960
    ds_read_b64_tr_b16 v[140:141], v19 offset:38912
    ds_read_b64_tr_b16 v[142:143], v19 offset:39424
    ds_read_b128 v[156:159], v27 offset:40960
    v_mfma_f32_32x32x16_bf16 v[40:55], v[160:163], v[176:179], v[40:55]
    v_mfma_f32_32x32x16_bf16 v[40:55], v[164:167], v[180:183], v[40:55]
    v_mfma_f32_32x32x16_bf16 v[40:55], v[168:171], v[184:187], v[40:55]
    v_mfma_f32_32x32x16_bf16 v[40:55], v[172:175], v[188:191], v[40:55]
    s_waitcnt vmcnt(24)
    s_waitcnt lgkmcnt(0)
    s_barrier
    s_mov_b32 s79, 5767168
    s_mov_b32 s80, 2816
    s_add_u32 m0, s44, 98304
    s_nop 0
    buffer_load_dwordx4 v10, s[4:7], s79 offen lds
    s_add_u32 m0, s44, 99328
    s_nop 0
    buffer_load_dwordx4 v11, s[4:7], s79 offen lds
    s_add_u32 m0, s44, 106496
    s_nop 0
    buffer_load_dwordx4 v12, s[8:11], s80 offen lds
    s_add_u32 m0, s44, 107520
    s_nop 0
    buffer_load_dwordx4 v13, s[8:11], s80 offen lds
    ds_read_b64_tr_b16 v[160:161], v19 offset:49152
    ds_read_b64_tr_b16 v[162:163], v19 offset:49664
    ds_read_b128 v[176:179], v24 offset:57344
    ds_read_b64_tr_b16 v[164:165], v19 offset:51200
    ds_read_b64_tr_b16 v[166:167], v19 offset:51712
    ds_read_b128 v[180:183], v25 offset:57344
    ds_read_b64_tr_b16 v[168:169], v19 offset:53248
    ds_read_b64_tr_b16 v[170:171], v19 offset:53760
    ds_read_b128 v[184:187], v26 offset:57344
    ds_read_b64_tr_b16 v[172:173], v19 offset:55296
    ds_read_b64_tr_b16 v[174:175], v19 offset:55808
    ds_read_b128 v[188:191], v27 offset:57344
    v_mfma_f32_32x32x16_bf16 v[40:55], v[128:131], v[144:147], v[40:55]
    v_mfma_f32_32x32x16_bf16 v[40:55], v[132:135], v[148:151], v[40:55]
    v_mfma_f32_32x32x16_bf16 v[40:55], v[136:139], v[152:155], v[40:55]
    v_mfma_f32_32x32x16_bf16 v[40:55], v[140:143], v[156:159], v[40:55]
    s_waitcnt vmcnt(24)
    s_waitcnt lgkmcnt(0)
    s_barrier
    s_mov_b32 s79, 6029312
    s_mov_b32 s80, 2944
    s_add_u32 m0, s44, 114688
    s_nop 0
    buffer_load_dwordx4 v10, s[4:7], s79 offen lds
    s_add_u32 m0, s44, 115712
    s_nop 0
    buffer_load_dwordx4 v11, s[4:7], s79 offen lds
    s_add_u32 m0, s44, 122880
    s_nop 0
    buffer_load_dwordx4 v12, s[8:11], s80 offen lds
    s_add_u32 m0, s44, 123904
    s_nop 0
    buffer_load_dwordx4 v13, s[8:11], s80 offen lds
    ds_read_b64_tr_b16 v[128:129], v18 offset:0
    ds_read_b64_tr_b16 v[130:131], v18 offset:512
    ds_read_b128 v[144:147], v20 offset:8192
    ds_read_b64_tr_b16 v[132:133], v18 offset:2048
    ds_read_b64_tr_b16 v[134:135], v18 offset:2560
    ds_read_b128 v[148:151], v21 offset:8192
    ds_read_b64_tr_b16 v[136:137], v18 offset:4096
    ds_read_b64_tr_b16 v[138:139], v18 offset:4608
    ds_read_b128 v[152:155], v22 offset:8192
    ds_read_b64_tr_b16 v[140:141], v18 offset:6144
    ds_read_b64_tr_b16 v[142:143], v18 offset:6656
    ds_read_b128 v[156:159], v23 offset:8192
    v_mfma_f32_32x32x16_bf16 v[40:55], v[160:163], v[176:179], v[40:55]
    v_mfma_f32_32x32x16_bf16 v[40:55], v[164:167], v[180:183], v[40:55]
    v_mfma_f32_32x32x16_bf16 v[40:55], v[168:171], v[184:187], v[40:55]
    v_mfma_f32_32x32x16_bf16 v[40:55], v[172:175], v[188:191], v[40:55]
    s_waitcnt vmcnt(24)
    s_waitcnt lgkmcnt(0)
    s_barrier
    s_mov_b32 s79, 6291456
    s_mov_b32 s80, 3072
    s_add_u32 m0, s44, 0
    s_nop 0
    buffer_load_dwordx4 v10, s[4:7], s79 offen lds
    s_add_u32 m0, s44, 1024
    s_nop 0
    buffer_load_dwordx4 v11, s[4:7], s79 offen lds
    s_add_u32 m0, s44, 8192
    s_nop 0
    buffer_load_dwordx4 v12, s[8:11], s80 offen lds
    s_add_u32 m0, s44, 9216
    s_nop 0
    buffer_load_dwordx4 v13, s[8:11], s80 offen lds
    ds_read_b64_tr_b16 v[160:161], v18 offset:16384
    ds_read_b64_tr_b16 v[162:163], v18 offset:16896
    ds_read_b128 v[176:179], v20 offset:24576
    ds_read_b64_tr_b16 v[164:165], v18 offset:18432
    ds_read_b64_tr_b16 v[166:167], v18 offset:18944
    ds_read_b128 v[180:183], v21 offset:24576
    ds_read_b64_tr_b16 v[168:169], v18 offset:20480
    ds_read_b64_tr_b16 v[170:171], v18 offset:20992
    ds_read_b128 v[184:187], v22 offset:24576
    ds_read_b64_tr_b16 v[172:173], v18 offset:22528
    ds_read_b64_tr_b16 v[174:175], v18 offset:23040
    ds_read_b128 v[188:191], v23 offset:24576
    v_mfma_f32_32x32x16_bf16 v[40:55], v[128:131], v[144:147], v[40:55]
    v_mfma_f32_32x32x16_bf16 v[40:55], v[132:135], v[148:151], v[40:55]
    v_mfma_f32_32x32x16_bf16 v[40:55], v[136:139], v[152:155], v[40:55]
    v_mfma_f32_32x32x16_bf16 v[40:55], v[140:143], v[156:159], v[40:55]
    s_waitcnt vmcnt(24)
    s_waitcnt lgkmcnt(0)
    s_barrier
    s_mov_b32 s79, 6553600
    s_mov_b32 s80, 3200
    s_add_u32 m0, s44, 16384
    s_nop 0
    buffer_load_dwordx4 v10, s[4:7], s79 offen lds
    s_add_u32 m0, s44, 17408
    s_nop 0
    buffer_load_dwordx4 v11, s[4:7], s79 offen lds
    s_add_u32 m0, s44, 24576
    s_nop 0
    buffer_load_dwordx4 v12, s[8:11], s80 offen lds
    s_add_u32 m0, s44, 25600
    s_nop 0
    buffer_load_dwordx4 v13, s[8:11], s80 offen lds
    ds_read_b64_tr_b16 v[128:129], v18 offset:32768
    ds_read_b64_tr_b16 v[130:131], v18 offset:33280
    ds_read_b128 v[144:147], v20 offset:40960
    ds_read_b64_tr_b16 v[132:133], v18 offset:34816
    ds_read_b64_tr_b16 v[134:135], v18 offset:35328
    ds_read_b128 v[148:151], v21 offset:40960
    ds_read_b64_tr_b16 v[136:137], v18 offset:36864
    ds_read_b64_tr_b16 v[138:139], v18 offset:37376
    ds_read_b128 v[152:155], v22 offset:40960
    ds_read_b64_tr_b16 v[140:141], v18 offset:38912
    ds_read_b64_tr_b16 v[142:143], v18 offset:39424
    ds_read_b128 v[156:159], v23 offset:40960
    v_mfma_f32_32x32x16_bf16 v[40:55], v[160:163], v[176:179], v[40:55]
    v_mfma_f32_32x32x16_bf16 v[40:55], v[164:167], v[180:183], v[40:55]
    v_mfma_f32_32x32x16_bf16 v[40:55], v[168:171], v[184:187], v[40:55]
    v_mfma_f32_32x32x16_bf16 v[40:55], v[172:175], v[188:191], v[40:55]
    s_waitcnt vmcnt(24)
    s_waitcnt lgkmcnt(0)
    s_barrier
    s_mov_b32 s79, 6815744
    s_mov_b32 s80, 3328
    s_add_u32 m0, s44, 32768
    s_nop 0
    buffer_load_dwordx4 v10, s[4:7], s79 offen lds
    s_add_u32 m0, s44, 33792
    s_nop 0
    buffer_load_dwordx4 v11, s[4:7], s79 offen lds
    s_add_u32 m0, s44, 40960
    s_nop 0
    buffer_load_dwordx4 v12, s[8:11], s80 offen lds
    s_add_u32 m0, s44, 41984
    s_nop 0
    buffer_load_dwordx4 v13, s[8:11], s80 offen lds
    ds_read_b64_tr_b16 v[160:161], v18 offset:49152
    ds_read_b64_tr_b16 v[162:163], v18 offset:49664
    ds_read_b128 v[176:179], v20 offset:57344
    ds_read_b64_tr_b16 v[164:165], v18 offset:51200
    ds_read_b64_tr_b16 v[166:167], v18 offset:51712
    ds_read_b128 v[180:183], v21 offset:57344
    ds_read_b64_tr_b16 v[168:169], v18 offset:53248
    ds_read_b64_tr_b16 v[170:171], v18 offset:53760
    ds_read_b128 v[184:187], v22 offset:57344
    ds_read_b64_tr_b16 v[172:173], v18 offset:55296
    ds_read_b64_tr_b16 v[174:175], v18 offset:55808
    ds_read_b128 v[188:191], v23 offset:57344
    v_mfma_f32_32x32x16_bf16 v[40:55], v[128:131], v[144:147], v[40:55]
    v_mfma_f32_32x32x16_bf16 v[40:55], v[132:135], v[148:151], v[40:55]
    v_mfma_f32_32x32x16_bf16 v[40:55], v[136:139], v[152:155], v[40:55]
    v_mfma_f32_32x32x16_bf16 v[40:55], v[140:143], v[156:159], v[40:55]
    s_waitcnt vmcnt(24)
    s_waitcnt lgkmcnt(0)
    s_barrier
    s_mov_b32 s79, 7077888
    s_mov_b32 s80, 3456
    s_add_u32 m0, s44, 49152
    s_nop 0
    buffer_load_dwordx4 v10, s[4:7], s79 offen lds
    s_add_u32 m0, s44, 50176
    s_nop 0
    buffer_load_dwordx4 v11, s[4:7], s79 offen lds
    s_add_u32 m0, s44, 57344
    s_nop 0
    buffer_load_dwordx4 v12, s[8:11], s80 offen lds
    s_add_u32 m0, s44, 58368
    s_nop 0
    buffer_load_dwordx4 v13, s[8:11], s80 offen lds
    ds_read_b64_tr_b16 v[128:129], v19 offset:0
    ds_read_b64_tr_b16 v[130:131], v19 offset:512
    ds_read_b128 v[144:147], v24 offset:8192
    ds_read_b64_tr_b16 v[132:133], v19 offset:2048
    ds_read_b64_tr_b16 v[134:135], v19 offset:2560
    ds_read_b128 v[148:151], v25 offset:8192
    ds_read_b64_tr_b16 v[136:137], v19 offset:4096
    ds_read_b64_tr_b16 v[138:139], v19 offset:4608
    ds_read_b128 v[152:155], v26 offset:8192
    ds_read_b64_tr_b16 v[140:141], v19 offset:6144
    ds_read_b64_tr_b16 v[142:143], v19 offset:6656
    ds_read_b128 v[156:159], v27 offset:8192
    v_mfma_f32_32x32x16_bf16 v[40:55], v[160:163], v[176:179], v[40:55]
    v_mfma_f32_32x32x16_bf16 v[40:55], v[164:167], v[180:183], v[40:55]
    v_mfma_f32_32x32x16_bf16 v[40:55], v[168:171], v[184:187], v[40:55]
    v_mfma_f32_32x32x16_bf16 v[40:55], v[172:175], v[188:191], v[40:55]
    s_waitcnt vmcnt(24)
    s_waitcnt lgkmcnt(0)
    s_barrier
    s_mov_b32 s79, 0
    s_mov_b32 s80, 0
    s_add_u32 m0, s44, 65536
    s_nop 0
    buffer_load_dwordx4 v14, s[12:15], s79 offen lds
    s_add_u32 m0, s44, 66560
    s_nop 0
    buffer_load_dwordx4 v15, s[12:15], s79 offen lds
    s_add_u32 m0, s44, 73728
    s_nop 0
    buffer_load_dwordx4 v16, s[16:19], s80 offen lds
    s_add_u32 m0, s44, 74752
    s_nop 0
    buffer_load_dwordx4 v17, s[16:19], s80 offen lds
    ds_read_b64_tr_b16 v[160:161], v19 offset:16384
    ds_read_b64_tr_b16 v[162:163], v19 offset:16896
    ds_read_b128 v[176:179], v24 offset:24576
    ds_read_b64_tr_b16 v[164:165], v19 offset:18432
    ds_read_b64_tr_b16 v[166:167], v19 offset:18944
    ds_read_b128 v[180:183], v25 offset:24576
    ds_read_b64_tr_b16 v[168:169], v19 offset:20480
    ds_read_b64_tr_b16 v[170:171], v19 offset:20992
    ds_read_b128 v[184:187], v26 offset:24576
    ds_read_b64_tr_b16 v[172:173], v19 offset:22528
    ds_read_b64_tr_b16 v[174:175], v19 offset:23040
    ds_read_b128 v[188:191], v27 offset:24576
    v_mfma_f32_32x32x16_bf16 v[40:55], v[128:131], v[144:147], v[40:55]
    v_mfma_f32_32x32x16_bf16 v[40:55], v[132:135], v[148:151], v[40:55]
    v_mfma_f32_32x32x16_bf16 v[40:55], v[136:139], v[152:155], v[40:55]
    v_mfma_f32_32x32x16_bf16 v[40:55], v[140:143], v[156:159], v[40:55]
    s_waitcnt vmcnt(24)
    s_waitcnt lgkmcnt(0)
    s_barrier
    s_mov_b32 s79, 128
    s_mov_b32 s80, 128
    s_add_u32 m0, s44, 81920
    s_nop 0
    buffer_load_dwordx4 v14, s[12:15], s79 offen lds
    s_add_u32 m0, s44, 82944
    s_nop 0
    buffer_load_dwordx4 v15, s[12:15], s79 offen lds
    s_add_u32 m0, s44, 90112
    s_nop 0
    buffer_load_dwordx4 v16, s[16:19], s80 offen lds
    s_add_u32 m0, s44, 91136
    s_nop 0
    buffer_load_dwordx4 v17, s[16:19], s80 offen lds
    ds_read_b64_tr_b16 v[128:129], v19 offset:32768
    ds_read_b64_tr_b16 v[130:131], v19 offset:33280
    ds_read_b128 v[144:147], v24 offset:40960
    ds_read_b64_tr_b16 v[132:133], v19 offset:34816
    ds_read_b64_tr_b16 v[134:135], v19 offset:35328
    ds_read_b128 v[148:151], v25 offset:40960
    ds_read_b64_tr_b16 v[136:137], v19 offset:36864
    ds_read_b64_tr_b16 v[138:139], v19 offset:37376
    ds_read_b128 v[152:155], v26 offset:40960
    ds_read_b64_tr_b16 v[140:141], v19 offset:38912
    ds_read_b64_tr_b16 v[142:143], v19 offset:39424
    ds_read_b128 v[156:159], v27 offset:40960
    v_mfma_f32_32x32x16_bf16 v[40:55], v[160:163], v[176:179], v[40:55]
    v_mfma_f32_32x32x16_bf16 v[40:55], v[164:167], v[180:183], v[40:55]
    v_mfma_f32_32x32x16_bf16 v[40:55], v[168:171], v[184:187], v[40:55]
    v_mfma_f32_32x32x16_bf16 v[40:55], v[172:175], v[188:191], v[40:55]
    s_waitcnt vmcnt(24)
    s_waitcnt lgkmcnt(0)
    s_barrier
    s_mov_b32 s79, 256
    s_mov_b32 s80, 256
    s_add_u32 m0, s44, 98304
    s_nop 0
    buffer_load_dwordx4 v14, s[12:15], s79 offen lds
    s_add_u32 m0, s44, 99328
    s_nop 0
    buffer_load_dwordx4 v15, s[12:15], s79 offen lds
    s_add_u32 m0, s44, 106496
    s_nop 0
    buffer_load_dwordx4 v16, s[16:19], s80 offen lds
    s_add_u32 m0, s44, 107520
    s_nop 0
    buffer_load_dwordx4 v17, s[16:19], s80 offen lds
    ds_read_b64_tr_b16 v[160:161], v19 offset:49152
    ds_read_b64_tr_b16 v[162:163], v19 offset:49664
    ds_read_b128 v[176:179], v24 offset:57344
    ds_read_b64_tr_b16 v[164:165], v19 offset:51200
    ds_read_b64_tr_b16 v[166:167], v19 offset:51712
    ds_read_b128 v[180:183], v25 offset:57344
    ds_read_b64_tr_b16 v[168:169], v19 offset:53248
    ds_read_b64_tr_b16 v[170:171], v19 offset:53760
    ds_read_b128 v[184:187], v26 offset:57344
    ds_read_b64_tr_b16 v[172:173], v19 offset:55296
    ds_read_b64_tr_b16 v[174:175], v19 offset:55808
    ds_read_b128 v[188:191], v27 offset:57344
    v_mfma_f32_32x32x16_bf16 v[40:55], v[128:131], v[144:147], v[40:55]
    v_mfma_f32_32x32x16_bf16 v[40:55], v[132:135], v[148:151], v[40:55]
    v_mfma_f32_32x32x16_bf16 v[40:55], v[136:139], v[152:155], v[40:55]
    v_mfma_f32_32x32x16_bf16 v[40:55], v[140:143], v[156:159], v[40:55]
    s_waitcnt vmcnt(24)
    s_waitcnt lgkmcnt(0)
    s_barrier
    s_mov_b32 s79, 384
    s_mov_b32 s80, 384
    s_add_u32 m0, s44, 114688
    s_nop 0
    buffer_load_dwordx4 v14, s[12:15], s79 offen lds
    s_add_u32 m0, s44, 115712
    s_nop 0
    buffer_load_dwordx4 v15, s[12:15], s79 offen lds
    s_add_u32 m0, s44, 122880
    s_nop 0
    buffer_load_dwordx4 v16, s[16:19], s80 offen lds
    s_add_u32 m0, s44, 123904
    s_nop 0
    buffer_load_dwordx4 v17, s[16:19], s80 offen lds
    ds_read_b64_tr_b16 v[128:129], v18 offset:0
    ds_read_b64_tr_b16 v[130:131], v18 offset:512
    ds_read_b128 v[144:147], v20 offset:8192
    ds_read_b64_tr_b16 v[132:133], v18 offset:2048
    ds_read_b64_tr_b16 v[134:135], v18 offset:2560
    ds_read_b128 v[148:151], v21 offset:8192
    ds_read_b64_tr_b16 v[136:137], v18 offset:4096
    ds_read_b64_tr_b16 v[138:139], v18 offset:4608
    ds_read_b128 v[152:155], v22 offset:8192
    ds_read_b64_tr_b16 v[140:141], v18 offset:6144
    ds_read_b64_tr_b16 v[142:143], v18 offset:6656
    ds_read_b128 v[156:159], v23 offset:8192
    v_mfma_f32_32x32x16_bf16 v[40:55], v[160:163], v[176:179], v[40:55]
    v_mfma_f32_32x32x16_bf16 v[40:55], v[164:167], v[180:183], v[40:55]
    v_mfma_f32_32x32x16_bf16 v[40:55], v[168:171], v[184:187], v[40:55]
    v_mfma_f32_32x32x16_bf16 v[40:55], v[172:175], v[188:191], v[40:55]
    s_waitcnt vmcnt(24)
    s_waitcnt lgkmcnt(0)
    s_barrier
    s_mov_b32 s79, 512
    s_mov_b32 s80, 512
    s_add_u32 m0, s44, 0
    s_nop 0
    buffer_load_dwordx4 v14, s[12:15], s79 offen lds
    s_add_u32 m0, s44, 1024
    s_nop 0
    buffer_load_dwordx4 v15, s[12:15], s79 offen lds
    s_add_u32 m0, s44, 8192
    s_nop 0
    buffer_load_dwordx4 v16, s[16:19], s80 offen lds
    s_add_u32 m0, s44, 9216
    s_nop 0
    buffer_load_dwordx4 v17, s[16:19], s80 offen lds
    ds_read_b64_tr_b16 v[160:161], v18 offset:16384
    ds_read_b64_tr_b16 v[162:163], v18 offset:16896
    ds_read_b128 v[176:179], v20 offset:24576
    ds_read_b64_tr_b16 v[164:165], v18 offset:18432
    ds_read_b64_tr_b16 v[166:167], v18 offset:18944
    ds_read_b128 v[180:183], v21 offset:24576
    ds_read_b64_tr_b16 v[168:169], v18 offset:20480
    ds_read_b64_tr_b16 v[170:171], v18 offset:20992
    ds_read_b128 v[184:187], v22 offset:24576
    ds_read_b64_tr_b16 v[172:173], v18 offset:22528
    ds_read_b64_tr_b16 v[174:175], v18 offset:23040
    ds_read_b128 v[188:191], v23 offset:24576
    v_mfma_f32_32x32x16_bf16 v[40:55], v[128:131], v[144:147], v[40:55]
    v_mfma_f32_32x32x16_bf16 v[40:55], v[132:135], v[148:151], v[40:55]
    v_mfma_f32_32x32x16_bf16 v[40:55], v[136:139], v[152:155], v[40:55]
    v_mfma_f32_32x32x16_bf16 v[40:55], v[140:143], v[156:159], v[40:55]
    s_waitcnt vmcnt(24)
    s_waitcnt lgkmcnt(0)
    s_barrier
    s_mov_b32 s79, 640
    s_mov_b32 s80, 640
    s_add_u32 m0, s44, 16384
    s_nop 0
    buffer_load_dwordx4 v14, s[12:15], s79 offen lds
    s_add_u32 m0, s44, 17408
    s_nop 0
    buffer_load_dwordx4 v15, s[12:15], s79 offen lds
    s_add_u32 m0, s44, 24576
    s_nop 0
    buffer_load_dwordx4 v16, s[16:19], s80 offen lds
    s_add_u32 m0, s44, 25600
    s_nop 0
    buffer_load_dwordx4 v17, s[16:19], s80 offen lds
    ds_read_b64_tr_b16 v[128:129], v18 offset:32768
    ds_read_b64_tr_b16 v[130:131], v18 offset:33280
    ds_read_b128 v[144:147], v20 offset:40960
    ds_read_b64_tr_b16 v[132:133], v18 offset:34816
    ds_read_b64_tr_b16 v[134:135], v18 offset:35328
    ds_read_b128 v[148:151], v21 offset:40960
    ds_read_b64_tr_b16 v[136:137], v18 offset:36864
    ds_read_b64_tr_b16 v[138:139], v18 offset:37376
    ds_read_b128 v[152:155], v22 offset:40960
    ds_read_b64_tr_b16 v[140:141], v18 offset:38912
    ds_read_b64_tr_b16 v[142:143], v18 offset:39424
    ds_read_b128 v[156:159], v23 offset:40960
    v_mfma_f32_32x32x16_bf16 v[40:55], v[160:163], v[176:179], v[40:55]
    v_mfma_f32_32x32x16_bf16 v[40:55], v[164:167], v[180:183], v[40:55]
    v_mfma_f32_32x32x16_bf16 v[40:55], v[168:171], v[184:187], v[40:55]
    v_mfma_f32_32x32x16_bf16 v[40:55], v[172:175], v[188:191], v[40:55]
    s_waitcnt vmcnt(24)
    s_waitcnt lgkmcnt(0)
    s_barrier
    s_mov_b32 s79, 768
    s_mov_b32 s80, 768
    s_add_u32 m0, s44, 32768
    s_nop 0
    buffer_load_dwordx4 v14, s[12:15], s79 offen lds
    s_add_u32 m0, s44, 33792
    s_nop 0
    buffer_load_dwordx4 v15, s[12:15], s79 offen lds
    s_add_u32 m0, s44, 40960
    s_nop 0
    buffer_load_dwordx4 v16, s[16:19], s80 offen lds
    s_add_u32 m0, s44, 41984
    s_nop 0
    buffer_load_dwordx4 v17, s[16:19], s80 offen lds
    ds_read_b64_tr_b16 v[160:161], v18 offset:49152
    ds_read_b64_tr_b16 v[162:163], v18 offset:49664
    ds_read_b128 v[176:179], v20 offset:57344
    ds_read_b64_tr_b16 v[164:165], v18 offset:51200
    ds_read_b64_tr_b16 v[166:167], v18 offset:51712
    ds_read_b128 v[180:183], v21 offset:57344
    ds_read_b64_tr_b16 v[168:169], v18 offset:53248
    ds_read_b64_tr_b16 v[170:171], v18 offset:53760
    ds_read_b128 v[184:187], v22 offset:57344
    ds_read_b64_tr_b16 v[172:173], v18 offset:55296
    ds_read_b64_tr_b16 v[174:175], v18 offset:55808
    ds_read_b128 v[188:191], v23 offset:57344
    v_mfma_f32_32x32x16_bf16 v[40:55], v[128:131], v[144:147], v[40:55]
    v_mfma_f32_32x32x16_bf16 v[40:55], v[132:135], v[148:151], v[40:55]
    v_mfma_f32_32x32x16_bf16 v[40:55], v[136:139], v[152:155], v[40:55]
    v_mfma_f32_32x32x16_bf16 v[40:55], v[140:143], v[156:159], v[40:55]
    s_waitcnt vmcnt(24)
    s_waitcnt lgkmcnt(0)
    s_barrier
    s_mov_b32 s79, 896
    s_mov_b32 s80, 896
    s_add_u32 m0, s44, 49152
    s_nop 0
    buffer_load_dwordx4 v14, s[12:15], s79 offen lds
    s_add_u32 m0, s44, 50176
    s_nop 0
    buffer_load_dwordx4 v15, s[12:15], s79 offen lds
    s_add_u32 m0, s44, 57344
    s_nop 0
    buffer_load_dwordx4 v16, s[16:19], s80 offen lds
    s_add_u32 m0, s44, 58368
    s_nop 0
    buffer_load_dwordx4 v17, s[16:19], s80 offen lds
    ds_read_b128 v[128:131], v32 offset:0
    ds_read_b128 v[144:147], v24 offset:8192
    ds_read_b128 v[132:135], v33 offset:0
    ds_read_b128 v[148:151], v25 offset:8192
    ds_read_b128 v[136:139], v34 offset:0
    ds_read_b128 v[152:155], v26 offset:8192
    ds_read_b128 v[140:143], v35 offset:0
    ds_read_b128 v[156:159], v27 offset:8192
    v_mfma_f32_32x32x16_bf16 v[40:55], v[160:163], v[176:179], v[40:55]
    v_mfma_f32_32x32x16_bf16 v[40:55], v[164:167], v[180:183], v[40:55]
    v_mfma_f32_32x32x16_bf16 v[40:55], v[168:171], v[184:187], v[40:55]
    v_mfma_f32_32x32x16_bf16 v[40:55], v[172:175], v[188:191], v[40:55]
    s_waitcnt vmcnt(24)
    s_waitcnt lgkmcnt(0)
    s_barrier
    s_mov_b32 s79, 1024
    s_mov_b32 s80, 0
    s_add_u32 m0, s44, 65536
    s_nop 0
    buffer_load_dwordx4 v14, s[12:15], s79 offen lds
    s_add_u32 m0, s44, 66560
    s_nop 0
    buffer_load_dwordx4 v15, s[12:15], s79 offen lds
    s_add_u32 m0, s44, 73728
    s_nop 0
    buffer_load_dwordx4 v16, s[20:23], s80 offen lds
    s_add_u32 m0, s44, 74752
    s_nop 0
    buffer_load_dwordx4 v17, s[20:23], s80 offen lds
    ds_read_b128 v[160:163], v32 offset:16384
    ds_read_b128 v[176:179], v24 offset:24576
    ds_read_b128 v[164:167], v33 offset:16384
    ds_read_b128 v[180:183], v25 offset:24576
    ds_read_b128 v[168:171], v34 offset:16384
    ds_read_b128 v[184:187], v26 offset:24576
    ds_read_b128 v[172:175], v35 offset:16384
    ds_read_b128 v[188:191], v27 offset:24576
    v_mfma_f32_32x32x16_bf16 v[56:71], v[128:131], v[144:147], v[56:71]
    v_mfma_f32_32x32x16_bf16 v[56:71], v[132:135], v[148:151], v[56:71]
    v_mfma_f32_32x32x16_bf16 v[56:71], v[136:139], v[152:155], v[56:71]
    v_mfma_f32_32x32x16_bf16 v[56:71], v[140:143], v[156:159], v[56:71]
    s_waitcnt vmcnt(24)
    s_waitcnt lgkmcnt(0)
    s_barrier
    s_mov_b32 s79, 1152
    s_mov_b32 s80, 128
    s_add_u32 m0, s44, 81920
    s_nop 0
    buffer_load_dwordx4 v14, s[12:15], s79 offen lds
    s_add_u32 m0, s44, 82944
    s_nop 0
    buffer_load_dwordx4 v15, s[12:15], s79 offen lds
    s_add_u32 m0, s44, 90112
    s_nop 0
    buffer_load_dwordx4 v16, s[20:23], s80 offen lds
    s_add_u32 m0, s44, 91136
    s_nop 0
    buffer_load_dwordx4 v17, s[20:23], s80 offen lds
    ds_read_b128 v[128:131], v32 offset:32768
    ds_read_b128 v[144:147], v24 offset:40960
    ds_read_b128 v[132:135], v33 offset:32768
    ds_read_b128 v[148:151], v25 offset:40960
    ds_read_b128 v[136:139], v34 offset:32768
    ds_read_b128 v[152:155], v26 offset:40960
    ds_read_b128 v[140:143], v35 offset:32768
    ds_read_b128 v[156:159], v27 offset:40960
    v_mfma_f32_32x32x16_bf16 v[56:71], v[160:163], v[176:179], v[56:71]
    v_mfma_f32_32x32x16_bf16 v[56:71], v[164:167], v[180:183], v[56:71]
    v_mfma_f32_32x32x16_bf16 v[56:71], v[168:171], v[184:187], v[56:71]
    v_mfma_f32_32x32x16_bf16 v[56:71], v[172:175], v[188:191], v[56:71]
    s_waitcnt vmcnt(24)
    s_waitcnt lgkmcnt(0)
    s_barrier
    s_mov_b32 s79, 1280
    s_mov_b32 s80, 256
    s_add_u32 m0, s44, 98304
    s_nop 0
    buffer_load_dwordx4 v14, s[12:15], s79 offen lds
    s_add_u32 m0, s44, 99328
    s_nop 0
    buffer_load_dwordx4 v15, s[12:15], s79 offen lds
    s_add_u32 m0, s44, 106496
    s_nop 0
    buffer_load_dwordx4 v16, s[20:23], s80 offen lds
    s_add_u32 m0, s44, 107520
    s_nop 0
    buffer_load_dwordx4 v17, s[20:23], s80 offen lds
    ds_read_b128 v[160:163], v32 offset:49152
    ds_read_b128 v[176:179], v24 offset:57344
    ds_read_b128 v[164:167], v33 offset:49152
    ds_read_b128 v[180:183], v25 offset:57344
    ds_read_b128 v[168:171], v34 offset:49152
    ds_read_b128 v[184:187], v26 offset:57344
    ds_read_b128 v[172:175], v35 offset:49152
    ds_read_b128 v[188:191], v27 offset:57344
    v_mfma_f32_32x32x16_bf16 v[56:71], v[128:131], v[144:147], v[56:71]
    v_mfma_f32_32x32x16_bf16 v[56:71], v[132:135], v[148:151], v[56:71]
    v_mfma_f32_32x32x16_bf16 v[56:71], v[136:139], v[152:155], v[56:71]
    v_mfma_f32_32x32x16_bf16 v[56:71], v[140:143], v[156:159], v[56:71]
    s_waitcnt vmcnt(24)
    s_waitcnt lgkmcnt(0)
    s_barrier
    s_mov_b32 s79, 1408
    s_mov_b32 s80, 384
    s_add_u32 m0, s44, 114688
    s_nop 0
    buffer_load_dwordx4 v14, s[12:15], s79 offen lds
    s_add_u32 m0, s44, 115712
    s_nop 0
    buffer_load_dwordx4 v15, s[12:15], s79 offen lds
    s_add_u32 m0, s44, 122880
    s_nop 0
    buffer_load_dwordx4 v16, s[20:23], s80 offen lds
    s_add_u32 m0, s44, 123904
    s_nop 0
    buffer_load_dwordx4 v17, s[20:23], s80 offen lds
    ds_read_b128 v[128:131], v28 offset:0
    ds_read_b128 v[144:147], v20 offset:8192
    ds_read_b128 v[132:135], v29 offset:0
    ds_read_b128 v[148:151], v21 offset:8192
    ds_read_b128 v[136:139], v30 offset:0
    ds_read_b128 v[152:155], v22 offset:8192
    ds_read_b128 v[140:143], v31 offset:0
    ds_read_b128 v[156:159], v23 offset:8192
    v_mfma_f32_32x32x16_bf16 v[56:71], v[160:163], v[176:179], v[56:71]
    v_mfma_f32_32x32x16_bf16 v[56:71], v[164:167], v[180:183], v[56:71]
    v_mfma_f32_32x32x16_bf16 v[56:71], v[168:171], v[184:187], v[56:71]
    v_mfma_f32_32x32x16_bf16 v[56:71], v[172:175], v[188:191], v[56:71]
    s_waitcnt vmcnt(24)
    s_waitcnt lgkmcnt(0)
    s_barrier
    s_mov_b32 s79, 1536
    s_mov_b32 s80, 512
    s_add_u32 m0, s44, 0
    s_nop 0
    buffer_load_dwordx4 v14, s[12:15], s79 offen lds
    s_add_u32 m0, s44, 1024
    s_nop 0
    buffer_load_dwordx4 v15, s[12:15], s79 offen lds
    s_add_u32 m0, s44, 8192
    s_nop 0
    buffer_load_dwordx4 v16, s[20:23], s80 offen lds
    s_add_u32 m0, s44, 9216
    s_nop 0
    buffer_load_dwordx4 v17, s[20:23], s80 offen lds
    ds_read_b128 v[160:163], v28 offset:16384
    ds_read_b128 v[176:179], v20 offset:24576
    ds_read_b128 v[164:167], v29 offset:16384
    ds_read_b128 v[180:183], v21 offset:24576
    ds_read_b128 v[168:171], v30 offset:16384
    ds_read_b128 v[184:187], v22 offset:24576
    ds_read_b128 v[172:175], v31 offset:16384
    ds_read_b128 v[188:191], v23 offset:24576
    v_mfma_f32_32x32x16_bf16 v[56:71], v[128:131], v[144:147], v[56:71]
    v_mfma_f32_32x32x16_bf16 v[56:71], v[132:135], v[148:151], v[56:71]
    v_mfma_f32_32x32x16_bf16 v[56:71], v[136:139], v[152:155], v[56:71]
    v_mfma_f32_32x32x16_bf16 v[56:71], v[140:143], v[156:159], v[56:71]
    s_waitcnt vmcnt(24)
    s_waitcnt lgkmcnt(0)
    s_barrier
    s_mov_b32 s79, 1664
    s_mov_b32 s80, 640
    s_add_u32 m0, s44, 16384
    s_nop 0
    buffer_load_dwordx4 v14, s[12:15], s79 offen lds
    s_add_u32 m0, s44, 17408
    s_nop 0
    buffer_load_dwordx4 v15, s[12:15], s79 offen lds
    s_add_u32 m0, s44, 24576
    s_nop 0
    buffer_load_dwordx4 v16, s[20:23], s80 offen lds
    s_add_u32 m0, s44, 25600
    s_nop 0
    buffer_load_dwordx4 v17, s[20:23], s80 offen lds
    ds_read_b128 v[128:131], v28 offset:32768
    ds_read_b128 v[144:147], v20 offset:40960
    ds_read_b128 v[132:135], v29 offset:32768
    ds_read_b128 v[148:151], v21 offset:40960
    ds_read_b128 v[136:139], v30 offset:32768
    ds_read_b128 v[152:155], v22 offset:40960
    ds_read_b128 v[140:143], v31 offset:32768
    ds_read_b128 v[156:159], v23 offset:40960
    v_mfma_f32_32x32x16_bf16 v[56:71], v[160:163], v[176:179], v[56:71]
    v_mfma_f32_32x32x16_bf16 v[56:71], v[164:167], v[180:183], v[56:71]
    v_mfma_f32_32x32x16_bf16 v[56:71], v[168:171], v[184:187], v[56:71]
    v_mfma_f32_32x32x16_bf16 v[56:71], v[172:175], v[188:191], v[56:71]
    s_waitcnt vmcnt(24)
    s_waitcnt lgkmcnt(0)
    s_barrier
    s_mov_b32 s79, 1792
    s_mov_b32 s80, 768
    s_add_u32 m0, s44, 32768
    s_nop 0
    buffer_load_dwordx4 v14, s[12:15], s79 offen lds
    s_add_u32 m0, s44, 33792
    s_nop 0
    buffer_load_dwordx4 v15, s[12:15], s79 offen lds
    s_add_u32 m0, s44, 40960
    s_nop 0
    buffer_load_dwordx4 v16, s[20:23], s80 offen lds
    s_add_u32 m0, s44, 41984
    s_nop 0
    buffer_load_dwordx4 v17, s[20:23], s80 offen lds
    ds_read_b128 v[160:163], v28 offset:49152
    ds_read_b128 v[176:179], v20 offset:57344
    ds_read_b128 v[164:167], v29 offset:49152
    ds_read_b128 v[180:183], v21 offset:57344
    ds_read_b128 v[168:171], v30 offset:49152
    ds_read_b128 v[184:187], v22 offset:57344
    ds_read_b128 v[172:175], v31 offset:49152
    ds_read_b128 v[188:191], v23 offset:57344
    v_mfma_f32_32x32x16_bf16 v[56:71], v[128:131], v[144:147], v[56:71]
    v_mfma_f32_32x32x16_bf16 v[56:71], v[132:135], v[148:151], v[56:71]
    v_mfma_f32_32x32x16_bf16 v[56:71], v[136:139], v[152:155], v[56:71]
    v_mfma_f32_32x32x16_bf16 v[56:71], v[140:143], v[156:159], v[56:71]
    s_waitcnt vmcnt(24)
    s_waitcnt lgkmcnt(0)
    s_barrier
    s_mov_b32 s79, 1920
    s_mov_b32 s80, 896
    s_add_u32 m0, s44, 49152
    s_nop 0
    buffer_load_dwordx4 v14, s[12:15], s79 offen lds
    s_add_u32 m0, s44, 50176
    s_nop 0
    buffer_load_dwordx4 v15, s[12:15], s79 offen lds
    s_add_u32 m0, s44, 57344
    s_nop 0
    buffer_load_dwordx4 v16, s[20:23], s80 offen lds
    s_add_u32 m0, s44, 58368
    s_nop 0
    buffer_load_dwordx4 v17, s[20:23], s80 offen lds
    ds_read_b128 v[128:131], v32 offset:0
    ds_read_b128 v[144:147], v24 offset:8192
    ds_read_b128 v[132:135], v33 offset:0
    ds_read_b128 v[148:151], v25 offset:8192
    ds_read_b128 v[136:139], v34 offset:0
    ds_read_b128 v[152:155], v26 offset:8192
    ds_read_b128 v[140:143], v35 offset:0
    ds_read_b128 v[156:159], v27 offset:8192
    v_mfma_f32_32x32x16_bf16 v[56:71], v[160:163], v[176:179], v[56:71]
    v_mfma_f32_32x32x16_bf16 v[56:71], v[164:167], v[180:183], v[56:71]
    v_mfma_f32_32x32x16_bf16 v[56:71], v[168:171], v[184:187], v[56:71]
    v_mfma_f32_32x32x16_bf16 v[56:71], v[172:175], v[188:191], v[56:71]
    s_waitcnt vmcnt(24)
    s_waitcnt lgkmcnt(0)
    s_barrier
    ds_read_b128 v[160:163], v32 offset:16384
    ds_read_b128 v[176:179], v24 offset:24576
    ds_read_b128 v[164:167], v33 offset:16384
    ds_read_b128 v[180:183], v25 offset:24576
    ds_read_b128 v[168:171], v34 offset:16384
    ds_read_b128 v[184:187], v26 offset:24576
    ds_read_b128 v[172:175], v35 offset:16384
    ds_read_b128 v[188:191], v27 offset:24576
    v_mfma_f32_32x32x16_bf16 v[56:71], v[128:131], v[144:147], v[56:71]
    v_mfma_f32_32x32x16_bf16 v[56:71], v[132:135], v[148:151], v[56:71]
    v_mfma_f32_32x32x16_bf16 v[56:71], v[136:139], v[152:155], v[56:71]
    v_mfma_f32_32x32x16_bf16 v[56:71], v[140:143], v[156:159], v[56:71]
    s_waitcnt vmcnt(20)
    s_waitcnt lgkmcnt(0)
    s_barrier
    ds_read_b128 v[128:131], v32 offset:32768
    ds_read_b128 v[144:147], v24 offset:40960
    ds_read_b128 v[132:135], v33 offset:32768
    ds_read_b128 v[148:151], v25 offset:40960
    ds_read_b128 v[136:139], v34 offset:32768
    ds_read_b128 v[152:155], v26 offset:40960
    ds_read_b128 v[140:143], v35 offset:32768
    ds_read_b128 v[156:159], v27 offset:40960
    v_mfma_f32_32x32x16_bf16 v[56:71], v[160:163], v[176:179], v[56:71]
    v_mfma_f32_32x32x16_bf16 v[56:71], v[164:167], v[180:183], v[56:71]
    v_mfma_f32_32x32x16_bf16 v[56:71], v[168:171], v[184:187], v[56:71]
    v_mfma_f32_32x32x16_bf16 v[56:71], v[172:175], v[188:191], v[56:71]
    s_waitcnt vmcnt(16)
    s_waitcnt lgkmcnt(0)
    s_barrier
    ds_read_b128 v[160:163], v32 offset:49152
    ds_read_b128 v[176:179], v24 offset:57344
    ds_read_b128 v[164:167], v33 offset:49152
    ds_read_b128 v[180:183], v25 offset:57344
    ds_read_b128 v[168:171], v34 offset:49152
    ds_read_b128 v[184:187], v26 offset:57344
    ds_read_b128 v[172:175], v35 offset:49152
    ds_read_b128 v[188:191], v27 offset:57344
    v_mfma_f32_32x32x16_bf16 v[56:71], v[128:131], v[144:147], v[56:71]
    v_mfma_f32_32x32x16_bf16 v[56:71], v[132:135], v[148:151], v[56:71]
    v_mfma_f32_32x32x16_bf16 v[56:71], v[136:139], v[152:155], v[56:71]
    v_mfma_f32_32x32x16_bf16 v[56:71], v[140:143], v[156:159], v[56:71]
    s_waitcnt vmcnt(12)
    s_waitcnt lgkmcnt(0)
    s_barrier
    ds_read_b128 v[128:131], v28 offset:0
    ds_read_b128 v[144:147], v20 offset:8192
    ds_read_b128 v[132:135], v29 offset:0
    ds_read_b128 v[148:151], v21 offset:8192
    ds_read_b128 v[136:139], v30 offset:0
    ds_read_b128 v[152:155], v22 offset:8192
    ds_read_b128 v[140:143], v31 offset:0
    ds_read_b128 v[156:159], v23 offset:8192
    v_mfma_f32_32x32x16_bf16 v[56:71], v[160:163], v[176:179], v[56:71]
    v_mfma_f32_32x32x16_bf16 v[56:71], v[164:167], v[180:183], v[56:71]
    v_mfma_f32_32x32x16_bf16 v[56:71], v[168:171], v[184:187], v[56:71]
    v_mfma_f32_32x32x16_bf16 v[56:71], v[172:175], v[188:191], v[56:71]
    s_waitcnt vmcnt(8)
    s_waitcnt lgkmcnt(0)
    s_barrier
    ds_read_b128 v[160:163], v28 offset:16384
    ds_read_b128 v[176:179], v20 offset:24576
    ds_read_b128 v[164:167], v29 offset:16384
    ds_read_b128 v[180:183], v21 offset:24576
    ds_read_b128 v[168:171], v30 offset:16384
    ds_read_b128 v[184:187], v22 offset:24576
    ds_read_b128 v[172:175], v31 offset:16384
    ds_read_b128 v[188:191], v23 offset:24576
    v_mfma_f32_32x32x16_bf16 v[56:71], v[128:131], v[144:147], v[56:71]
    v_mfma_f32_32x32x16_bf16 v[56:71], v[132:135], v[148:151], v[56:71]
    v_mfma_f32_32x32x16_bf16 v[56:71], v[136:139], v[152:155], v[56:71]
    v_mfma_f32_32x32x16_bf16 v[56:71], v[140:143], v[156:159], v[56:71]
    s_waitcnt vmcnt(4)
    s_waitcnt lgkmcnt(0)
    s_barrier
    ds_read_b128 v[128:131], v28 offset:32768
    ds_read_b128 v[144:147], v20 offset:40960
    ds_read_b128 v[132:135], v29 offset:32768
    ds_read_b128 v[148:151], v21 offset:40960
    ds_read_b128 v[136:139], v30 offset:32768
    ds_read_b128 v[152:155], v22 offset:40960
    ds_read_b128 v[140:143], v31 offset:32768
    ds_read_b128 v[156:159], v23 offset:40960
    v_mfma_f32_32x32x16_bf16 v[56:71], v[160:163], v[176:179], v[56:71]
    v_mfma_f32_32x32x16_bf16 v[56:71], v[164:167], v[180:183], v[56:71]
    v_mfma_f32_32x32x16_bf16 v[56:71], v[168:171], v[184:187], v[56:71]
    v_mfma_f32_32x32x16_bf16 v[56:71], v[172:175], v[188:191], v[56:71]
    s_waitcnt vmcnt(0)
    s_waitcnt lgkmcnt(0)
    s_barrier
    ds_read_b128 v[160:163], v28 offset:49152
    ds_read_b128 v[176:179], v20 offset:57344
    ds_read_b128 v[164:167], v29 offset:49152
    ds_read_b128 v[180:183], v21 offset:57344
    ds_read_b128 v[168:171], v30 offset:49152
    ds_read_b128 v[184:187], v22 offset:57344
    ds_read_b128 v[172:175], v31 offset:49152
    ds_read_b128 v[188:191], v23 offset:57344
    v_mfma_f32_32x32x16_bf16 v[56:71], v[128:131], v[144:147], v[56:71]
    v_mfma_f32_32x32x16_bf16 v[56:71], v[132:135], v[148:151], v[56:71]
    v_mfma_f32_32x32x16_bf16 v[56:71], v[136:139], v[152:155], v[56:71]
    v_mfma_f32_32x32x16_bf16 v[56:71], v[140:143], v[156:159], v[56:71]
    s_waitcnt lgkmcnt(0)
    s_barrier
    v_mfma_f32_32x32x16_bf16 v[56:71], v[160:163], v[176:179], v[56:71]
    v_mfma_f32_32x32x16_bf16 v[56:71], v[164:167], v[180:183], v[56:71]
    v_mfma_f32_32x32x16_bf16 v[56:71], v[168:171], v[184:187], v[56:71]
    v_mfma_f32_32x32x16_bf16 v[56:71], v[172:175], v[188:191], v[56:71]
    s_waitcnt vmcnt(0)
    v_lshlrev_b32 v120, 16, v120
    s_mov_b32 s55, 3216550459
    s_nop 11
    v_cvt_pk_bf16_f32 v2, v40, v40
    v_lshlrev_b32 v2, 16, v2
    v_lshlrev_b32 v3, 16, v104
    v_add_f32 v2, v2, v3
    v_cvt_pk_bf16_f32 v2, v2, v2
    v_lshlrev_b32 v2, 16, v2
    v_mul_f32 v3, s55, v2
    v_exp_f32 v3, v3
    v_lshlrev_b32 v5, 16, v88
    v_add_f32 v3, 1.0, v3
    v_rcp_f32 v3, v3
    v_mul_f32 v5, v5, v120
    v_mul_f32 v3, v3, v2
    v_cvt_pk_bf16_f32 v3, v3, v3
    v_lshlrev_b32 v3, 16, v3
    v_cvt_pk_bf16_f32 v5, v5, v5
    v_lshlrev_b32 v5, 16, v5
    v_fma_f32 v5, 2.0, v56, v5
    v_lshlrev_b32 v2, 16, v72
    v_fma_f32 v2, v5, v3, v2
    s_mov_b32 s43, 0
    buffer_store_dword v2, v8, s[56:59], s43 offen
    s_nop 0
    v_cvt_pk_bf16_f32 v2, v41, v41
    v_lshlrev_b32 v2, 16, v2
    v_lshlrev_b32 v3, 16, v105
    v_add_f32 v2, v2, v3
    v_cvt_pk_bf16_f32 v2, v2, v2
    v_lshlrev_b32 v2, 16, v2
    v_mul_f32 v3, s55, v2
    v_exp_f32 v3, v3
    v_lshlrev_b32 v5, 16, v89
    v_add_f32 v3, 1.0, v3
    v_rcp_f32 v3, v3
    v_mul_f32 v5, v5, v120
    v_mul_f32 v3, v3, v2
    v_cvt_pk_bf16_f32 v3, v3, v3
    v_lshlrev_b32 v3, 16, v3
    v_cvt_pk_bf16_f32 v5, v5, v5
    v_lshlrev_b32 v5, 16, v5
    v_fma_f32 v5, 2.0, v57, v5
    v_lshlrev_b32 v2, 16, v73
    v_fma_f32 v2, v5, v3, v2
    s_mov_b32 s43, 2048
    buffer_store_dword v2, v8, s[56:59], s43 offen
    s_nop 0
    v_cvt_pk_bf16_f32 v2, v42, v42
    v_lshlrev_b32 v2, 16, v2
    v_lshlrev_b32 v3, 16, v106
    v_add_f32 v2, v2, v3
    v_cvt_pk_bf16_f32 v2, v2, v2
    v_lshlrev_b32 v2, 16, v2
    v_mul_f32 v3, s55, v2
    v_exp_f32 v3, v3
    v_lshlrev_b32 v5, 16, v90
    v_add_f32 v3, 1.0, v3
    v_rcp_f32 v3, v3
    v_mul_f32 v5, v5, v120
    v_mul_f32 v3, v3, v2
    v_cvt_pk_bf16_f32 v3, v3, v3
    v_lshlrev_b32 v3, 16, v3
    v_cvt_pk_bf16_f32 v5, v5, v5
    v_lshlrev_b32 v5, 16, v5
    v_fma_f32 v5, 2.0, v58, v5
    v_lshlrev_b32 v2, 16, v74
    v_fma_f32 v2, v5, v3, v2
    s_mov_b32 s43, 4096
    buffer_store_dword v2, v8, s[56:59], s43 offen
    s_nop 0
    v_cvt_pk_bf16_f32 v2, v43, v43
    v_lshlrev_b32 v2, 16, v2
    v_lshlrev_b32 v3, 16, v107
    v_add_f32 v2, v2, v3
    v_cvt_pk_bf16_f32 v2, v2, v2
    v_lshlrev_b32 v2, 16, v2
    v_mul_f32 v3, s55, v2
    v_exp_f32 v3, v3
    v_lshlrev_b32 v5, 16, v91
    v_add_f32 v3, 1.0, v3
    v_rcp_f32 v3, v3
    v_mul_f32 v5, v5, v120
    v_mul_f32 v3, v3, v2
    v_cvt_pk_bf16_f32 v3, v3, v3
    v_lshlrev_b32 v3, 16, v3
    v_cvt_pk_bf16_f32 v5, v5, v5
    v_lshlrev_b32 v5, 16, v5
    v_fma_f32 v5, 2.0, v59, v5
    v_lshlrev_b32 v2, 16, v75
    v_fma_f32 v2, v5, v3, v2
    s_mov_b32 s43, 6144
    buffer_store_dword v2, v8, s[56:59], s43 offen
    s_nop 0
    v_cvt_pk_bf16_f32 v2, v44, v44
    v_lshlrev_b32 v2, 16, v2
    v_lshlrev_b32 v3, 16, v108
    v_add_f32 v2, v2, v3
    v_cvt_pk_bf16_f32 v2, v2, v2
    v_lshlrev_b32 v2, 16, v2
    v_mul_f32 v3, s55, v2
    v_exp_f32 v3, v3
    v_lshlrev_b32 v5, 16, v92
    v_add_f32 v3, 1.0, v3
    v_rcp_f32 v3, v3
    v_mul_f32 v5, v5, v120
    v_mul_f32 v3, v3, v2
    v_cvt_pk_bf16_f32 v3, v3, v3
    v_lshlrev_b32 v3, 16, v3
    v_cvt_pk_bf16_f32 v5, v5, v5
    v_lshlrev_b32 v5, 16, v5
    v_fma_f32 v5, 2.0, v60, v5
    v_lshlrev_b32 v2, 16, v76
    v_fma_f32 v2, v5, v3, v2
    s_mov_b32 s43, 16384
    buffer_store_dword v2, v8, s[56:59], s43 offen
    s_nop 0
    v_cvt_pk_bf16_f32 v2, v45, v45
    v_lshlrev_b32 v2, 16, v2
    v_lshlrev_b32 v3, 16, v109
    v_add_f32 v2, v2, v3
    v_cvt_pk_bf16_f32 v2, v2, v2
    v_lshlrev_b32 v2, 16, v2
    v_mul_f32 v3, s55, v2
    v_exp_f32 v3, v3
    v_lshlrev_b32 v5, 16, v93
    v_add_f32 v3, 1.0, v3
    v_rcp_f32 v3, v3
    v_mul_f32 v5, v5, v120
    v_mul_f32 v3, v3, v2
    v_cvt_pk_bf16_f32 v3, v3, v3
    v_lshlrev_b32 v3, 16, v3
    v_cvt_pk_bf16_f32 v5, v5, v5
    v_lshlrev_b32 v5, 16, v5
    v_fma_f32 v5, 2.0, v61, v5
    v_lshlrev_b32 v2, 16, v77
    v_fma_f32 v2, v5, v3, v2
    s_mov_b32 s43, 18432
    buffer_store_dword v2, v8, s[56:59], s43 offen
    s_nop 0
    v_cvt_pk_bf16_f32 v2, v46, v46
    v_lshlrev_b32 v2, 16, v2
    v_lshlrev_b32 v3, 16, v110
    v_add_f32 v2, v2, v3
    v_cvt_pk_bf16_f32 v2, v2, v2
    v_lshlrev_b32 v2, 16, v2
    v_mul_f32 v3, s55, v2
    v_exp_f32 v3, v3
    v_lshlrev_b32 v5, 16, v94
    v_add_f32 v3, 1.0, v3
    v_rcp_f32 v3, v3
    v_mul_f32 v5, v5, v120
    v_mul_f32 v3, v3, v2
    v_cvt_pk_bf16_f32 v3, v3, v3
    v_lshlrev_b32 v3, 16, v3
    v_cvt_pk_bf16_f32 v5, v5, v5
    v_lshlrev_b32 v5, 16, v5
    v_fma_f32 v5, 2.0, v62, v5
    v_lshlrev_b32 v2, 16, v78
    v_fma_f32 v2, v5, v3, v2
    s_mov_b32 s43, 20480
    buffer_store_dword v2, v8, s[56:59], s43 offen
    s_nop 0
    v_cvt_pk_bf16_f32 v2, v47, v47
    v_lshlrev_b32 v2, 16, v2
    v_lshlrev_b32 v3, 16, v111
    v_add_f32 v2, v2, v3
    v_cvt_pk_bf16_f32 v2, v2, v2
    v_lshlrev_b32 v2, 16, v2
    v_mul_f32 v3, s55, v2
    v_exp_f32 v3, v3
    v_lshlrev_b32 v5, 16, v95
    v_add_f32 v3, 1.0, v3
    v_rcp_f32 v3, v3
    v_mul_f32 v5, v5, v120
    v_mul_f32 v3, v3, v2
    v_cvt_pk_bf16_f32 v3, v3, v3
    v_lshlrev_b32 v3, 16, v3
    v_cvt_pk_bf16_f32 v5, v5, v5
    v_lshlrev_b32 v5, 16, v5
    v_fma_f32 v5, 2.0, v63, v5
    v_lshlrev_b32 v2, 16, v79
    v_fma_f32 v2, v5, v3, v2
    s_mov_b32 s43, 22528
    buffer_store_dword v2, v8, s[56:59], s43 offen
    s_nop 0
    v_cvt_pk_bf16_f32 v2, v48, v48
    v_lshlrev_b32 v2, 16, v2
    v_lshlrev_b32 v3, 16, v112
    v_add_f32 v2, v2, v3
    v_cvt_pk_bf16_f32 v2, v2, v2
    v_lshlrev_b32 v2, 16, v2
    v_mul_f32 v3, s55, v2
    v_exp_f32 v3, v3
    v_lshlrev_b32 v5, 16, v96
    v_add_f32 v3, 1.0, v3
    v_rcp_f32 v3, v3
    v_mul_f32 v5, v5, v120
    v_mul_f32 v3, v3, v2
    v_cvt_pk_bf16_f32 v3, v3, v3
    v_lshlrev_b32 v3, 16, v3
    v_cvt_pk_bf16_f32 v5, v5, v5
    v_lshlrev_b32 v5, 16, v5
    v_fma_f32 v5, 2.0, v64, v5
    v_lshlrev_b32 v2, 16, v80
    v_fma_f32 v2, v5, v3, v2
    s_mov_b32 s43, 32768
    buffer_store_dword v2, v8, s[56:59], s43 offen
    s_nop 0
    v_cvt_pk_bf16_f32 v2, v49, v49
    v_lshlrev_b32 v2, 16, v2
    v_lshlrev_b32 v3, 16, v113
    v_add_f32 v2, v2, v3
    v_cvt_pk_bf16_f32 v2, v2, v2
    v_lshlrev_b32 v2, 16, v2
    v_mul_f32 v3, s55, v2
    v_exp_f32 v3, v3
    v_lshlrev_b32 v5, 16, v97
    v_add_f32 v3, 1.0, v3
    v_rcp_f32 v3, v3
    v_mul_f32 v5, v5, v120
    v_mul_f32 v3, v3, v2
    v_cvt_pk_bf16_f32 v3, v3, v3
    v_lshlrev_b32 v3, 16, v3
    v_cvt_pk_bf16_f32 v5, v5, v5
    v_lshlrev_b32 v5, 16, v5
    v_fma_f32 v5, 2.0, v65, v5
    v_lshlrev_b32 v2, 16, v81
    v_fma_f32 v2, v5, v3, v2
    s_mov_b32 s43, 34816
    buffer_store_dword v2, v8, s[56:59], s43 offen
    s_nop 0
    v_cvt_pk_bf16_f32 v2, v50, v50
    v_lshlrev_b32 v2, 16, v2
    v_lshlrev_b32 v3, 16, v114
    v_add_f32 v2, v2, v3
    v_cvt_pk_bf16_f32 v2, v2, v2
    v_lshlrev_b32 v2, 16, v2
    v_mul_f32 v3, s55, v2
    v_exp_f32 v3, v3
    v_lshlrev_b32 v5, 16, v98
    v_add_f32 v3, 1.0, v3
    v_rcp_f32 v3, v3
    v_mul_f32 v5, v5, v120
    v_mul_f32 v3, v3, v2
    v_cvt_pk_bf16_f32 v3, v3, v3
    v_lshlrev_b32 v3, 16, v3
    v_cvt_pk_bf16_f32 v5, v5, v5
    v_lshlrev_b32 v5, 16, v5
    v_fma_f32 v5, 2.0, v66, v5
    v_lshlrev_b32 v2, 16, v82
    v_fma_f32 v2, v5, v3, v2
    s_mov_b32 s43, 36864
    buffer_store_dword v2, v8, s[56:59], s43 offen
    s_nop 0
    v_cvt_pk_bf16_f32 v2, v51, v51
    v_lshlrev_b32 v2, 16, v2
    v_lshlrev_b32 v3, 16, v115
    v_add_f32 v2, v2, v3
    v_cvt_pk_bf16_f32 v2, v2, v2
    v_lshlrev_b32 v2, 16, v2
    v_mul_f32 v3, s55, v2
    v_exp_f32 v3, v3
    v_lshlrev_b32 v5, 16, v99
    v_add_f32 v3, 1.0, v3
    v_rcp_f32 v3, v3
    v_mul_f32 v5, v5, v120
    v_mul_f32 v3, v3, v2
    v_cvt_pk_bf16_f32 v3, v3, v3
    v_lshlrev_b32 v3, 16, v3
    v_cvt_pk_bf16_f32 v5, v5, v5
    v_lshlrev_b32 v5, 16, v5
    v_fma_f32 v5, 2.0, v67, v5
    v_lshlrev_b32 v2, 16, v83
    v_fma_f32 v2, v5, v3, v2
    s_mov_b32 s43, 38912
    buffer_store_dword v2, v8, s[56:59], s43 offen
    s_nop 0
    v_cvt_pk_bf16_f32 v2, v52, v52
    v_lshlrev_b32 v2, 16, v2
    v_lshlrev_b32 v3, 16, v116
    v_add_f32 v2, v2, v3
    v_cvt_pk_bf16_f32 v2, v2, v2
    v_lshlrev_b32 v2, 16, v2
    v_mul_f32 v3, s55, v2
    v_exp_f32 v3, v3
    v_lshlrev_b32 v5, 16, v100
    v_add_f32 v3, 1.0, v3
    v_rcp_f32 v3, v3
    v_mul_f32 v5, v5, v120
    v_mul_f32 v3, v3, v2
    v_cvt_pk_bf16_f32 v3, v3, v3
    v_lshlrev_b32 v3, 16, v3
    v_cvt_pk_bf16_f32 v5, v5, v5
    v_lshlrev_b32 v5, 16, v5
    v_fma_f32 v5, 2.0, v68, v5
    v_lshlrev_b32 v2, 16, v84
    v_fma_f32 v2, v5, v3, v2
    s_mov_b32 s43, 49152
    buffer_store_dword v2, v8, s[56:59], s43 offen
    s_nop 0
    v_cvt_pk_bf16_f32 v2, v53, v53
    v_lshlrev_b32 v2, 16, v2
    v_lshlrev_b32 v3, 16, v117
    v_add_f32 v2, v2, v3
    v_cvt_pk_bf16_f32 v2, v2, v2
    v_lshlrev_b32 v2, 16, v2
    v_mul_f32 v3, s55, v2
    v_exp_f32 v3, v3
    v_lshlrev_b32 v5, 16, v101
    v_add_f32 v3, 1.0, v3
    v_rcp_f32 v3, v3
    v_mul_f32 v5, v5, v120
    v_mul_f32 v3, v3, v2
    v_cvt_pk_bf16_f32 v3, v3, v3
    v_lshlrev_b32 v3, 16, v3
    v_cvt_pk_bf16_f32 v5, v5, v5
    v_lshlrev_b32 v5, 16, v5
    v_fma_f32 v5, 2.0, v69, v5
    v_lshlrev_b32 v2, 16, v85
    v_fma_f32 v2, v5, v3, v2
    s_mov_b32 s43, 51200
    buffer_store_dword v2, v8, s[56:59], s43 offen
    s_nop 0
    v_cvt_pk_bf16_f32 v2, v54, v54
    v_lshlrev_b32 v2, 16, v2
    v_lshlrev_b32 v3, 16, v118
    v_add_f32 v2, v2, v3
    v_cvt_pk_bf16_f32 v2, v2, v2
    v_lshlrev_b32 v2, 16, v2
    v_mul_f32 v3, s55, v2
    v_exp_f32 v3, v3
    v_lshlrev_b32 v5, 16, v102
    v_add_f32 v3, 1.0, v3
    v_rcp_f32 v3, v3
    v_mul_f32 v5, v5, v120
    v_mul_f32 v3, v3, v2
    v_cvt_pk_bf16_f32 v3, v3, v3
    v_lshlrev_b32 v3, 16, v3
    v_cvt_pk_bf16_f32 v5, v5, v5
    v_lshlrev_b32 v5, 16, v5
    v_fma_f32 v5, 2.0, v70, v5
    v_lshlrev_b32 v2, 16, v86
    v_fma_f32 v2, v5, v3, v2
    s_mov_b32 s43, 53248
    buffer_store_dword v2, v8, s[56:59], s43 offen
    s_nop 0
    v_cvt_pk_bf16_f32 v2, v55, v55
    v_lshlrev_b32 v2, 16, v2
    v_lshlrev_b32 v3, 16, v119
    v_add_f32 v2, v2, v3
    v_cvt_pk_bf16_f32 v2, v2, v2
    v_lshlrev_b32 v2, 16, v2
    v_mul_f32 v3, s55, v2
    v_exp_f32 v3, v3
    v_lshlrev_b32 v5, 16, v103
    v_add_f32 v3, 1.0, v3
    v_rcp_f32 v3, v3
    v_mul_f32 v5, v5, v120
    v_mul_f32 v3, v3, v2
    v_cvt_pk_bf16_f32 v3, v3, v3
    v_lshlrev_b32 v3, 16, v3
    v_cvt_pk_bf16_f32 v5, v5, v5
    v_lshlrev_b32 v5, 16, v5
    v_fma_f32 v5, 2.0, v71, v5
    v_lshlrev_b32 v2, 16, v87
    v_fma_f32 v2, v5, v3, v2
    s_mov_b32 s43, 55296
    buffer_store_dword v2, v8, s[56:59], s43 offen
k3_end:
    s_endpgm
.section .rodata,"a"
.p2align 6
.amdhsa_kernel k3_kernel
  .amdhsa_next_free_vgpr 256
  .amdhsa_next_free_sgpr 102
  .amdhsa_accum_offset 256
  .amdhsa_group_segment_fixed_size 0
  .amdhsa_kernarg_size 136
  .amdhsa_user_sgpr_count 2
  .amdhsa_user_sgpr_kernarg_segment_ptr 1
  .amdhsa_system_sgpr_workgroup_id_x 1
.end_amdhsa_kernel
.text
```
